```python
import torch

def _softmax(x, axis=-1):
    return torch.softmax(x, dim=axis)
def _gelu(x):
    return torch.nn.functional.gelu(x, approximate="tanh")
def _silu(x):
    return torch.nn.functional.silu(x)
def _sigmoid(x):
    return torch.sigmoid(x)
def _layernorm(x, axis=-1, eps=1e-5):
    m = x.mean(dim=axis, keepdim=True)
    v = x.var(dim=axis, keepdim=True, unbiased=False)
    return (x - m) / torch.sqrt(v + eps)
def _scatter_add(tgt, idx, src, axis=0):
    return tgt.clone().index_add_(axis, idx, src)
def _segment_sum(src, seg, n):
    out = torch.zeros((n,) + src.shape[1:], dtype=src.dtype)
    return out.index_add_(0, seg, src)
def _pad(x, pw):
    flat = tuple(v for pair in reversed(pw) for v in pair)
    return torch.nn.functional.pad(x, flat)

kernel_name = 'recurrent_scan__sliding_block__moe_arch_mod__prompt'

def setup_inputs():

    _w = (lambda a: (lambda t: t.to(torch.bfloat16) if t.is_floating_point() else t)(torch.as_tensor(a)))
    def _A_setup():
        B, S, D = 1, 2048, 512
        return {
            "x": _w((lambda *s: torch.randn(*s, dtype=torch.bfloat16) * 0.05)(B, S, D)),
            "wqkv": _w((lambda *s: torch.randn(*s, dtype=torch.bfloat16) * 0.05)(D, 3 * D)),
            "wo": _w((lambda *s: torch.randn(*s, dtype=torch.bfloat16) * 0.05)(D, D)),
        }
    _A_in = _A_setup()

    def _B_setup():
        B, S, D, F, C = 1, 2048, 512, 1792, 8
        return {
            "x": _w((lambda *s: torch.randn(*s, dtype=torch.bfloat16) * 0.05)(B, S, D)),
            "w_r": _w((lambda *s: torch.randn(*s, dtype=torch.bfloat16) * 0.05)(D)),
            "w_gate": _w((lambda *s: torch.randn(*s, dtype=torch.bfloat16) * 0.05)(D, F)),
            "w_up": _w((lambda *s: torch.randn(*s, dtype=torch.bfloat16) * 0.05)(D, F)),
            "w_down": _w((lambda *s: torch.randn(*s, dtype=torch.bfloat16) * 0.05)(F, D)),
        }
    _B_in = _B_setup()

    return {
        "A_x": _A_in["x"],
        "A_wqkv": _A_in["wqkv"],
        "A_wo": _A_in["wo"],
        "B_x": _B_in["x"],
        "B_w_r": _B_in["w_r"],
        "B_w_gate": _B_in["w_gate"],
        "B_w_up": _B_in["w_up"],
        "B_w_down": _B_in["w_down"],
    }

def reference(A_x, A_wqkv, A_wo, B_x, B_w_r, B_w_gate, B_w_up, B_w_down):
    def _A_ref(x, wqkv, wo):
        B, S, D = x.shape
        H = 32; Dh = D // H; W = 256
        qkv = (lambda x, *d: x.permute(*d))((x @ wqkv).reshape(B, S, 3, H, Dh), 2, 0, 3, 1, 4)
        q, k, v = qkv[0], qkv[1], qkv[2]
        scores = torch.einsum("bhqd,bhkd->bhqk", q, k) * (Dh ** -0.5)
        idx = torch.arange(S)
        mask = (idx[:, None] - idx[None, :] >= 0) & (idx[:, None] - idx[None, :] < W)
        scores = torch.where(mask[None, None], scores, -1e9)
        p = _softmax(scores, axis=-1)
        o = torch.einsum("bhqk,bhkd->bhqd", p, v)
        return (lambda x, *d: x.permute(*d))(o, 0, 2, 1, 3).reshape(B, S, D) @ wo

    def _B_ref(x, w_r, w_gate, w_up, w_down):
        B, S, D = x.shape
        C = 8
        r = x @ w_r
        idx = torch.argsort(-r, axis=-1)[:, :C]
        idx_e = (lambda x, n, axis: torch.repeat_interleave(x, n, dim=axis))(idx.reshape(B, C, 1), D, axis=2)
        x_sel = (lambda x, i, axis: torch.take_along_dim(x, i, dim=axis))(x, idx_e, axis=1)
        g = _silu(x_sel @ w_gate)
        u = x_sel @ w_up
        y = (g * u) @ w_down
        r_sel = _sigmoid((lambda x, i, axis: torch.take_along_dim(x, i, dim=axis))(r, idx, axis=1))
        y = y * r_sel.reshape(B, C, 1)
        b_off = (torch.arange(B) * S).reshape(B, 1)
        flat_idx = (idx + b_off).reshape(B * C)
        zero = (x * 0.0).reshape(B * S, D)
        upd = _scatter_add(zero, flat_idx, y.reshape(B * C, D), axis=0)
        return x + upd.reshape(B, S, D)

    x = A_x
    xn = _layernorm(x, axis=-1)
    s = _A_ref(xn, A_wqkv, A_wo)
    g = _silu(_B_ref(xn, B_w_r, B_w_gate, B_w_up, B_w_down))
    return x + s * g
```

```asm
; @launch grid=(256,1,1) block=(512,1,1) lds=163840
.amdgcn_target "amdgcn-amd-amdhsa--gfx950"
.text
.p2align 8
text_start:
.p2align 8
.globl recurrent_scan__sliding_block__moe_arch_mod__prompt_kernel
.type recurrent_scan__sliding_block__moe_arch_mod__prompt_kernel,@function
recurrent_scan__sliding_block__moe_arch_mod__prompt_kernel:
    s_load_dwordx16 s[4:19], s[0:1], 0
    s_load_dwordx4 s[20:23], s[0:1], 64
    s_load_dwordx2 s[24:25], s[0:1], 80
    s_cmp_ge_u32 s2, 256
    s_cbranch_scc1 recurrent_scan__sliding_block__moe_arch_mod__prompt_kernel_end
    s_getpc_b64 s[34:35]
pf_1:
    s_lshr_b32 s30, s2, 3
    v_lshrrev_b32 v2, 6, v0
    v_and_b32 v3, 1, v0
    v_lshl_add_u32 v3, v2, 1, v3
    s_lshl_b32 s31, s30, 4
    v_add_lshl_u32 v3, v3, s31, 7
    v_min_u32 v3, text_end-pf_1-4, v3
    s_mov_b64 exec, 3
    global_load_dword v255, v3, s[34:35]
    s_mov_b64 exec, -1
    v_mov_b32 v1, 155648
    v_lshl_add_u32 v3, v0, 2, v1
    v_mov_b32 v4, 0
    ds_write_b32 v3, v4
    v_mov_b32 v100, 0
    v_mov_b32 v101, 0
    v_mov_b32 v170, 0
    v_mov_b32 v138, 0
    v_readfirstlane_b32 s28, v2
    v_and_b32 v0, 63, v0
    s_and_b32 s26, s2, 1
    s_lshl_b32 s26, s26, 2
    s_add_u32 s31, s30, 0
    s_and_b32 s31, s31, 3
    s_add_u32 s26, s26, s31
    s_bfe_u32 s27, s2, 0x20001
    s_lshl_b32 s27, s27, 3
    s_lshr_b32 s31, s30, 2
    s_add_u32 s27, s27, s31
    s_mov_b32 s42, 0x10000000
    s_mov_b32 s43, 0x00020000
    s_and_b32 s32, s28, 6
    s_cmp_eq_u32 s32, 4
    s_cbranch_scc1 recurrent_scan__sliding_block__moe_arch_mod__prompt_kernel_ld
    s_cmp_eq_u32 s28, 6
    s_cbranch_scc1 recurrent_scan__sliding_block__moe_arch_mod__prompt_kernel_kw
    s_waitcnt lgkmcnt(0)
    s_barrier
    s_mov_b32 s40, s24
    s_mov_b32 s41, s25
    s_cmp_eq_u32 s28, 7
    s_cbranch_scc1 recurrent_scan__sliding_block__moe_arch_mod__prompt_kernel_fw
    s_branch recurrent_scan__sliding_block__moe_arch_mod__prompt_kernel_cw
recurrent_scan__sliding_block__moe_arch_mod__prompt_kernel_ld:
    s_sub_u32 s32, s28, 4
    v_lshrrev_b32 v10, 3, v0
    v_and_b32 v11, 7, v0
    v_lshrrev_b32 v12, 1, v10
    v_xor_b32 v13, v11, v12
    v_lshlrev_b32 v13, 4, v13
    v_lshl_add_u32 v2, v10, 10, v13
    s_lshl_b32 s33, s27, 16
    s_lshl_b32 s34, s32, 15
    s_add_u32 s33, s33, s34
    v_add_u32 v2, s33, v2
    v_xor_b32 v3, 64, v2
    v_add_u32 v3, 8192, v3
    v_and_b32 v12, 1, v12
    v_lshlrev_b32 v12, 2, v12
    v_xor_b32 v13, v11, v12
    v_lshlrev_b32 v13, 4, v13
    v_mul_u32_u24 v4, 3072, v10
    v_add_u32 v4, v4, v13
    s_mul_i32 s33, s32, 98304
    s_lshl_b32 s34, s26, 7
    s_add_u32 s33, s33, s34
    v_add_u32 v4, s33, v4
    s_lshl_b32 s35, s32, 12
    s_lshl_b32 s36, s32, 13
    s_mov_b32 s46, 0x200000
    s_mov_b32 s47, s43
    s_mov_b32 s50, 0x180000
    s_mov_b32 s51, s43
    s_lshl_b32 s37, s32, 2
    v_add_u32 v5, s37, v1
    s_mul_i32 s33, s26, 2
    s_mul_i32 s3, s27, 1
    s_add_u32 s33, s33, s3
    s_add_u32 s33, s33, 0
    s_and_b32 s33, s33, 0
    s_add_u32 s34, s33, 0
    s_and_b32 s34, s34, 7
    s_lshl_b32 s52, s34, 7
    s_mul_i32 s60, s34, 196608
    s_add_u32 s34, s33, 1
    s_and_b32 s34, s34, 7
    s_lshl_b32 s53, s34, 7
    s_mul_i32 s61, s34, 196608
    v_lshlrev_b32 v20, 7, v0
    s_xor_b32 s34, s26, 4
    s_lshl_b32 s34, s34, 13
    s_lshl_b32 s38, s27, 16
    s_add_u32 s34, s34, s38
    v_add_u32 v20, s34, v20
    v_mul_u32_u24 v21, 3072, v10
    v_bfe_u32 v22, v0, 2, 1
    v_lshl_add_u32 v21, v22, 10, v21
    v_and_b32 v22, 3, v0
    v_lshl_add_u32 v21, v22, 7, v21
    s_lshr_b32 s34, s2, 3
    s_mul_i32 s34, s34, 24576
    s_and_b32 s38, s26, 4
    s_lshl_b32 s38, s38, 7
    s_add_u32 s34, s34, s38
    s_add_u32 s34, s34, 1024
    v_add_u32 v21, s34, v21
    v_add_u32 v22, 786432, v21
    v_lshrrev_b32 v24, 2, v0
    v_mul_u32_u24 v24, 3072, v24
    v_and_b32 v25, 3, v0
    v_lshl_add_u32 v24, v25, 7, v24
    s_lshr_b32 s34, s2, 3
    s_mul_i32 s34, s34, 49152
    s_add_u32 s34, s34, s38
    v_add_u32 v24, s34, v24
    s_cmp_eq_u32 s32, 0
    s_cselect_b64 vcc, -1, 0
    v_cndmask_b32 v24, v24, v22, vcc
    s_waitcnt lgkmcnt(0)
    s_mov_b32 s44, s4
    s_mov_b32 s45, s5
    s_mov_b32 s48, s6
    s_mov_b32 s49, s7
    s_cmp_lg_u32 s32, 0
    s_cbranch_scc1 e0_2
    s_branch e1_3
e0_2:
    global_load_dword v23, v21, s[6:7]
e1_3:
    s_barrier
    s_add_u32 s38, s52, 0
    s_add_u32 m0, s35, 0
    s_nop 0
    buffer_load_dwordx4 v2, s[44:47], s38 offen lds
    s_add_u32 m0, s35, 1024
    s_nop 0
    buffer_load_dwordx4 v3, s[44:47], s38 offen lds
    s_add_u32 s38, s52, 16384
    s_add_u32 m0, s35, 2048
    s_nop 0
    buffer_load_dwordx4 v2, s[44:47], s38 offen lds
    s_add_u32 m0, s35, 3072
    s_nop 0
    buffer_load_dwordx4 v3, s[44:47], s38 offen lds
    s_add_u32 m0, s36, 64512
    s_add_u32 s39, s60, 0
    buffer_load_dwordx4 v4, s[48:51], s39 offen offset:1024 lds
    buffer_load_dwordx4 v4, s[48:51], s39 offen offset:2048 lds
    s_add_u32 m0, s36, 66560
    s_add_u32 s39, s60, 24576
    buffer_load_dwordx4 v4, s[48:51], s39 offen offset:1024 lds
    buffer_load_dwordx4 v4, s[48:51], s39 offen offset:2048 lds
    s_add_u32 m0, s36, 68608
    s_add_u32 s39, s60, 49152
    buffer_load_dwordx4 v4, s[48:51], s39 offen offset:1024 lds
    buffer_load_dwordx4 v4, s[48:51], s39 offen offset:2048 lds
    s_add_u32 m0, s36, 70656
    s_add_u32 s39, s60, 73728
    buffer_load_dwordx4 v4, s[48:51], s39 offen offset:1024 lds
    buffer_load_dwordx4 v4, s[48:51], s39 offen offset:2048 lds
    s_add_u32 s34, s33, 2
    s_and_b32 s34, s34, 7
    s_lshl_b32 s54, s34, 7
    s_mul_i32 s62, s34, 196608
    s_add_u32 s34, s33, 3
    s_and_b32 s34, s34, 7
    s_lshl_b32 s55, s34, 7
    s_mul_i32 s63, s34, 196608
    s_add_u32 s34, s33, 4
    s_and_b32 s34, s34, 7
    s_lshl_b32 s56, s34, 7
    s_mul_i32 s64, s34, 196608
    s_add_u32 s34, s33, 5
    s_and_b32 s34, s34, 7
    s_lshl_b32 s57, s34, 7
    s_mul_i32 s65, s34, 196608
    s_add_u32 s34, s33, 6
    s_and_b32 s34, s34, 7
    s_lshl_b32 s58, s34, 7
    s_mul_i32 s66, s34, 196608
    s_add_u32 s34, s33, 7
    s_and_b32 s34, s34, 7
    s_lshl_b32 s59, s34, 7
    s_mul_i32 s67, s34, 196608
    s_add_u32 s38, s53, 0
    s_add_u32 m0, s35, 8192
    s_nop 0
    buffer_load_dwordx4 v2, s[44:47], s38 offen lds
    s_add_u32 m0, s35, 9216
    s_nop 0
    buffer_load_dwordx4 v3, s[44:47], s38 offen lds
    s_add_u32 s38, s53, 16384
    s_add_u32 m0, s35, 10240
    s_nop 0
    buffer_load_dwordx4 v2, s[44:47], s38 offen lds
    s_add_u32 m0, s35, 11264
    s_nop 0
    buffer_load_dwordx4 v3, s[44:47], s38 offen lds
    s_add_u32 m0, s36, 80896
    s_add_u32 s39, s61, 0
    buffer_load_dwordx4 v4, s[48:51], s39 offen offset:1024 lds
    buffer_load_dwordx4 v4, s[48:51], s39 offen offset:2048 lds
    s_add_u32 m0, s36, 82944
    s_add_u32 s39, s61, 24576
    buffer_load_dwordx4 v4, s[48:51], s39 offen offset:1024 lds
    buffer_load_dwordx4 v4, s[48:51], s39 offen offset:2048 lds
    s_add_u32 m0, s36, 84992
    s_add_u32 s39, s61, 49152
    buffer_load_dwordx4 v4, s[48:51], s39 offen offset:1024 lds
    buffer_load_dwordx4 v4, s[48:51], s39 offen offset:2048 lds
    s_add_u32 m0, s36, 87040
    s_add_u32 s39, s61, 73728
    buffer_load_dwordx4 v4, s[48:51], s39 offen offset:1024 lds
    buffer_load_dwordx4 v4, s[48:51], s39 offen offset:2048 lds
    s_add_u32 s38, s54, 0
    s_add_u32 m0, s35, 16384
    s_nop 0
    buffer_load_dwordx4 v2, s[44:47], s38 offen lds
    s_add_u32 m0, s35, 17408
    s_nop 0
    buffer_load_dwordx4 v3, s[44:47], s38 offen lds
    s_add_u32 s38, s54, 16384
    s_add_u32 m0, s35, 18432
    s_nop 0
    buffer_load_dwordx4 v2, s[44:47], s38 offen lds
    s_add_u32 m0, s35, 19456
    s_nop 0
    buffer_load_dwordx4 v3, s[44:47], s38 offen lds
    s_add_u32 m0, s36, 97280
    s_add_u32 s39, s62, 0
    buffer_load_dwordx4 v4, s[48:51], s39 offen offset:1024 lds
    buffer_load_dwordx4 v4, s[48:51], s39 offen offset:2048 lds
    s_add_u32 m0, s36, 99328
    s_add_u32 s39, s62, 24576
    buffer_load_dwordx4 v4, s[48:51], s39 offen offset:1024 lds
    buffer_load_dwordx4 v4, s[48:51], s39 offen offset:2048 lds
    s_add_u32 m0, s36, 101376
    s_add_u32 s39, s62, 49152
    buffer_load_dwordx4 v4, s[48:51], s39 offen offset:1024 lds
    buffer_load_dwordx4 v4, s[48:51], s39 offen offset:2048 lds
    s_add_u32 m0, s36, 103424
    s_add_u32 s39, s62, 73728
    buffer_load_dwordx4 v4, s[48:51], s39 offen offset:1024 lds
    buffer_load_dwordx4 v4, s[48:51], s39 offen offset:2048 lds
    s_waitcnt vmcnt(24)
    v_mov_b32 v6, 1
    ds_write_b32 v5, v6 offset:0
    s_add_u32 s38, s55, 0
    s_add_u32 m0, s35, 24576
    s_nop 0
    buffer_load_dwordx4 v2, s[44:47], s38 offen lds
    s_add_u32 m0, s35, 25600
    s_nop 0
    buffer_load_dwordx4 v3, s[44:47], s38 offen lds
    s_add_u32 s38, s55, 16384
    s_add_u32 m0, s35, 26624
    s_nop 0
    buffer_load_dwordx4 v2, s[44:47], s38 offen lds
    s_add_u32 m0, s35, 27648
    s_nop 0
    buffer_load_dwordx4 v3, s[44:47], s38 offen lds
    s_add_u32 m0, s36, 113664
    s_add_u32 s39, s63, 0
    buffer_load_dwordx4 v4, s[48:51], s39 offen offset:1024 lds
    buffer_load_dwordx4 v4, s[48:51], s39 offen offset:2048 lds
    s_add_u32 m0, s36, 115712
    s_add_u32 s39, s63, 24576
    buffer_load_dwordx4 v4, s[48:51], s39 offen offset:1024 lds
    buffer_load_dwordx4 v4, s[48:51], s39 offen offset:2048 lds
    s_add_u32 m0, s36, 117760
    s_add_u32 s39, s63, 49152
    buffer_load_dwordx4 v4, s[48:51], s39 offen offset:1024 lds
    buffer_load_dwordx4 v4, s[48:51], s39 offen offset:2048 lds
    s_add_u32 m0, s36, 119808
    s_add_u32 s39, s63, 73728
    buffer_load_dwordx4 v4, s[48:51], s39 offen offset:1024 lds
    buffer_load_dwordx4 v4, s[48:51], s39 offen offset:2048 lds
    global_load_dword v23, v24, s[6:7]
    s_waitcnt vmcnt(25)
    v_mov_b32 v6, 2
    ds_write_b32 v5, v6 offset:0
    s_add_u32 s38, s56, 0
    s_add_u32 m0, s35, 32768
    s_nop 0
    buffer_load_dwordx4 v2, s[44:47], s38 offen lds
    s_add_u32 m0, s35, 33792
    s_nop 0
    buffer_load_dwordx4 v3, s[44:47], s38 offen lds
    s_add_u32 s38, s56, 16384
    s_add_u32 m0, s35, 34816
    s_nop 0
    buffer_load_dwordx4 v2, s[44:47], s38 offen lds
    s_add_u32 m0, s35, 35840
    s_nop 0
    buffer_load_dwordx4 v3, s[44:47], s38 offen lds
    s_add_u32 m0, s36, 130048
    s_add_u32 s39, s64, 0
    buffer_load_dwordx4 v4, s[48:51], s39 offen offset:1024 lds
    buffer_load_dwordx4 v4, s[48:51], s39 offen offset:2048 lds
    s_add_u32 m0, s36, 132096
    s_add_u32 s39, s64, 24576
    buffer_load_dwordx4 v4, s[48:51], s39 offen offset:1024 lds
    buffer_load_dwordx4 v4, s[48:51], s39 offen offset:2048 lds
    s_add_u32 m0, s36, 134144
    s_add_u32 s39, s64, 49152
    buffer_load_dwordx4 v4, s[48:51], s39 offen offset:1024 lds
    buffer_load_dwordx4 v4, s[48:51], s39 offen offset:2048 lds
    s_add_u32 m0, s36, 136192
    s_add_u32 s39, s64, 73728
    buffer_load_dwordx4 v4, s[48:51], s39 offen offset:1024 lds
    buffer_load_dwordx4 v4, s[48:51], s39 offen offset:2048 lds
    s_waitcnt vmcnt(25)
    v_mov_b32 v6, 3
    ds_write_b32 v5, v6 offset:0
    s_add_u32 s38, s57, 0
    s_add_u32 m0, s35, 40960
    s_nop 0
    buffer_load_dwordx4 v2, s[44:47], s38 offen lds
    s_add_u32 m0, s35, 41984
    s_nop 0
    buffer_load_dwordx4 v3, s[44:47], s38 offen lds
    s_add_u32 s38, s57, 16384
    s_add_u32 m0, s35, 43008
    s_nop 0
    buffer_load_dwordx4 v2, s[44:47], s38 offen lds
    s_add_u32 m0, s35, 44032
    s_nop 0
    buffer_load_dwordx4 v3, s[44:47], s38 offen lds
    s_add_u32 s38, s58, 0
    s_add_u32 m0, s35, 49152
    s_nop 0
    buffer_load_dwordx4 v2, s[44:47], s38 offen lds
    s_add_u32 m0, s35, 50176
    s_nop 0
    buffer_load_dwordx4 v3, s[44:47], s38 offen lds
    s_add_u32 s38, s58, 16384
    s_add_u32 m0, s35, 51200
    s_nop 0
    buffer_load_dwordx4 v2, s[44:47], s38 offen lds
    s_add_u32 m0, s35, 52224
    s_nop 0
    buffer_load_dwordx4 v3, s[44:47], s38 offen lds
    s_add_u32 s38, s59, 0
    s_add_u32 m0, s35, 57344
    s_nop 0
    buffer_load_dwordx4 v2, s[44:47], s38 offen lds
    s_add_u32 m0, s35, 58368
    s_nop 0
    buffer_load_dwordx4 v3, s[44:47], s38 offen lds
    s_add_u32 s38, s59, 16384
    s_add_u32 m0, s35, 59392
    s_nop 0
    buffer_load_dwordx4 v2, s[44:47], s38 offen lds
    s_add_u32 m0, s35, 60416
    s_nop 0
    buffer_load_dwordx4 v3, s[44:47], s38 offen lds
    s_waitcnt vmcnt(25)
    v_mov_b32 v6, 4
    ds_write_b32 v5, v6 offset:0
    s_mov_b32 s3, 0x10000
wl_4:
    ds_read_b128 v[12:15], v1 offset:16
    s_waitcnt lgkmcnt(0)
    v_min_u32 v12, v12, v13
    v_min3_u32 v12, v12, v14, v15
    s_nop 0
    v_readfirstlane_b32 s30, v12
    s_cmp_ge_u32 s30, 1
    s_nop 3
    s_cbranch_scc1 wl_4d
    s_sub_u32 s3, s3, 1
    s_cbranch_scc0 wl_4
wl_4d:
    s_add_u32 m0, s36, 64512
    s_add_u32 s39, s65, 0
    buffer_load_dwordx4 v4, s[48:51], s39 offen offset:1024 lds
    buffer_load_dwordx4 v4, s[48:51], s39 offen offset:2048 lds
    s_add_u32 m0, s36, 66560
    s_add_u32 s39, s65, 24576
    buffer_load_dwordx4 v4, s[48:51], s39 offen offset:1024 lds
    buffer_load_dwordx4 v4, s[48:51], s39 offen offset:2048 lds
    s_add_u32 m0, s36, 68608
    s_add_u32 s39, s65, 49152
    buffer_load_dwordx4 v4, s[48:51], s39 offen offset:1024 lds
    buffer_load_dwordx4 v4, s[48:51], s39 offen offset:2048 lds
    s_add_u32 m0, s36, 70656
    s_add_u32 s39, s65, 73728
    buffer_load_dwordx4 v4, s[48:51], s39 offen offset:1024 lds
    buffer_load_dwordx4 v4, s[48:51], s39 offen offset:2048 lds
    s_waitcnt vmcnt(20)
    v_mov_b32 v6, 5
    ds_write_b32 v5, v6 offset:0
    s_mov_b32 s3, 0x10000
wl_5:
    ds_read_b128 v[12:15], v1 offset:16
    s_waitcnt lgkmcnt(0)
    v_min_u32 v12, v12, v13
    v_min3_u32 v12, v12, v14, v15
    s_nop 0
    v_readfirstlane_b32 s30, v12
    s_cmp_ge_u32 s30, 2
    s_nop 3
    s_cbranch_scc1 wl_5d
    s_sub_u32 s3, s3, 1
    s_cbranch_scc0 wl_5
wl_5d:
    s_add_u32 m0, s36, 80896
    s_add_u32 s39, s66, 0
    buffer_load_dwordx4 v4, s[48:51], s39 offen offset:1024 lds
    buffer_load_dwordx4 v4, s[48:51], s39 offen offset:2048 lds
    s_add_u32 m0, s36, 82944
    s_add_u32 s39, s66, 24576
    buffer_load_dwordx4 v4, s[48:51], s39 offen offset:1024 lds
    buffer_load_dwordx4 v4, s[48:51], s39 offen offset:2048 lds
    s_add_u32 m0, s36, 84992
    s_add_u32 s39, s66, 49152
    buffer_load_dwordx4 v4, s[48:51], s39 offen offset:1024 lds
    buffer_load_dwordx4 v4, s[48:51], s39 offen offset:2048 lds
    s_add_u32 m0, s36, 87040
    s_add_u32 s39, s66, 73728
    buffer_load_dwordx4 v4, s[48:51], s39 offen offset:1024 lds
    buffer_load_dwordx4 v4, s[48:51], s39 offen offset:2048 lds
    s_waitcnt vmcnt(8)
    v_mov_b32 v6, 6
    ds_write_b32 v5, v6 offset:0
    s_mov_b32 s3, 0x10000
wl_6:
    ds_read_b128 v[12:15], v1 offset:16
    s_waitcnt lgkmcnt(0)
    v_min_u32 v12, v12, v13
    v_min3_u32 v12, v12, v14, v15
    s_nop 0
    v_readfirstlane_b32 s30, v12
    s_cmp_ge_u32 s30, 3
    s_nop 3
    s_cbranch_scc1 wl_6d
    s_sub_u32 s3, s3, 1
    s_cbranch_scc0 wl_6
wl_6d:
    s_add_u32 m0, s36, 97280
    s_add_u32 s39, s67, 0
    buffer_load_dwordx4 v4, s[48:51], s39 offen offset:1024 lds
    buffer_load_dwordx4 v4, s[48:51], s39 offen offset:2048 lds
    s_add_u32 m0, s36, 99328
    s_add_u32 s39, s67, 24576
    buffer_load_dwordx4 v4, s[48:51], s39 offen offset:1024 lds
    buffer_load_dwordx4 v4, s[48:51], s39 offen offset:2048 lds
    s_add_u32 m0, s36, 101376
    s_add_u32 s39, s67, 49152
    buffer_load_dwordx4 v4, s[48:51], s39 offen offset:1024 lds
    buffer_load_dwordx4 v4, s[48:51], s39 offen offset:2048 lds
    s_add_u32 m0, s36, 103424
    s_add_u32 s39, s67, 73728
    buffer_load_dwordx4 v4, s[48:51], s39 offen offset:1024 lds
    buffer_load_dwordx4 v4, s[48:51], s39 offen offset:2048 lds
    s_waitcnt vmcnt(8)
    v_mov_b32 v6, 7
    ds_write_b32 v5, v6 offset:0
    s_mov_b32 s3, 0x10000
wl_7:
    ds_read_b128 v[12:15], v1 offset:16
    s_waitcnt lgkmcnt(0)
    v_min_u32 v12, v12, v13
    v_min3_u32 v12, v12, v14, v15
    s_nop 0
    v_readfirstlane_b32 s30, v12
    s_cmp_ge_u32 s30, 4
    s_nop 3
    s_cbranch_scc1 wl_7d
    s_sub_u32 s3, s3, 1
    s_cbranch_scc0 wl_7
wl_7d:
    s_add_u32 m0, s35, 114688
    s_add_u32 s39, s60, 0
    buffer_load_dwordx4 v4, s[48:51], s39 offen lds
    s_add_u32 m0, s35, 115712
    s_add_u32 s39, s60, 24576
    buffer_load_dwordx4 v4, s[48:51], s39 offen lds
    s_add_u32 m0, s35, 116736
    s_add_u32 s39, s60, 49152
    buffer_load_dwordx4 v4, s[48:51], s39 offen lds
    s_add_u32 m0, s35, 117760
    s_add_u32 s39, s60, 73728
    buffer_load_dwordx4 v4, s[48:51], s39 offen lds
    s_add_u32 m0, s35, 122880
    s_add_u32 s39, s61, 0
    buffer_load_dwordx4 v4, s[48:51], s39 offen lds
    s_add_u32 m0, s35, 123904
    s_add_u32 s39, s61, 24576
    buffer_load_dwordx4 v4, s[48:51], s39 offen lds
    s_add_u32 m0, s35, 124928
    s_add_u32 s39, s61, 49152
    buffer_load_dwordx4 v4, s[48:51], s39 offen lds
    s_add_u32 m0, s35, 125952
    s_add_u32 s39, s61, 73728
    buffer_load_dwordx4 v4, s[48:51], s39 offen lds
    s_waitcnt vmcnt(8)
    v_mov_b32 v6, 8
    ds_write_b32 v5, v6 offset:0
    s_mov_b32 s3, 0x10000
wl_8:
    ds_read_b128 v[12:15], v1 offset:16
    s_waitcnt lgkmcnt(0)
    v_min_u32 v12, v12, v13
    v_min3_u32 v12, v12, v14, v15
    s_nop 0
    v_readfirstlane_b32 s30, v12
    s_cmp_ge_u32 s30, 5
    s_nop 3
    s_cbranch_scc1 wl_8d
    s_sub_u32 s3, s3, 1
    s_cbranch_scc0 wl_8
wl_8d:
    s_add_u32 m0, s35, 131072
    s_add_u32 s39, s62, 0
    buffer_load_dwordx4 v4, s[48:51], s39 offen lds
    s_add_u32 m0, s35, 132096
    s_add_u32 s39, s62, 24576
    buffer_load_dwordx4 v4, s[48:51], s39 offen lds
    s_add_u32 m0, s35, 133120
    s_add_u32 s39, s62, 49152
    buffer_load_dwordx4 v4, s[48:51], s39 offen lds
    s_add_u32 m0, s35, 134144
    s_add_u32 s39, s62, 73728
    buffer_load_dwordx4 v4, s[48:51], s39 offen lds
    s_add_u32 m0, s35, 139264
    s_add_u32 s39, s63, 0
    buffer_load_dwordx4 v4, s[48:51], s39 offen lds
    s_add_u32 m0, s35, 140288
    s_add_u32 s39, s63, 24576
    buffer_load_dwordx4 v4, s[48:51], s39 offen lds
    s_add_u32 m0, s35, 141312
    s_add_u32 s39, s63, 49152
    buffer_load_dwordx4 v4, s[48:51], s39 offen lds
    s_add_u32 m0, s35, 142336
    s_add_u32 s39, s63, 73728
    buffer_load_dwordx4 v4, s[48:51], s39 offen lds
    s_waitcnt vmcnt(8)
    v_mov_b32 v6, 9
    ds_write_b32 v5, v6 offset:0
    s_mov_b32 s3, 0x10000
wl_9:
    ds_read_b128 v[12:15], v1 offset:16
    s_waitcnt lgkmcnt(0)
    v_min_u32 v12, v12, v13
    v_min3_u32 v12, v12, v14, v15
    s_nop 0
    v_readfirstlane_b32 s30, v12
    s_cmp_ge_u32 s30, 6
    s_nop 3
    s_cbranch_scc1 wl_9d
    s_sub_u32 s3, s3, 1
    s_cbranch_scc0 wl_9
wl_9d:
    s_add_u32 m0, s35, 65536
    s_add_u32 s39, s64, 0
    buffer_load_dwordx4 v4, s[48:51], s39 offen lds
    s_add_u32 m0, s35, 66560
    s_add_u32 s39, s64, 24576
    buffer_load_dwordx4 v4, s[48:51], s39 offen lds
    s_add_u32 m0, s35, 67584
    s_add_u32 s39, s64, 49152
    buffer_load_dwordx4 v4, s[48:51], s39 offen lds
    s_add_u32 m0, s35, 68608
    s_add_u32 s39, s64, 73728
    buffer_load_dwordx4 v4, s[48:51], s39 offen lds
    s_add_u32 m0, s35, 73728
    s_add_u32 s39, s65, 0
    buffer_load_dwordx4 v4, s[48:51], s39 offen lds
    s_add_u32 m0, s35, 74752
    s_add_u32 s39, s65, 24576
    buffer_load_dwordx4 v4, s[48:51], s39 offen lds
    s_add_u32 m0, s35, 75776
    s_add_u32 s39, s65, 49152
    buffer_load_dwordx4 v4, s[48:51], s39 offen lds
    s_add_u32 m0, s35, 76800
    s_add_u32 s39, s65, 73728
    buffer_load_dwordx4 v4, s[48:51], s39 offen lds
    s_mov_b32 s68, s8
    s_mov_b32 s69, s9
    s_mov_b32 s70, 0x80000
    s_mov_b32 s71, 0x00020000
    v_bfe_u32 v8, v0, 4, 1
    v_lshlrev_b32 v8, 1, v8
    v_xor_b32 v8, v11, v8
    v_lshlrev_b32 v8, 4, v8
    v_lshl_add_u32 v8, v10, 10, v8
    s_lshl_b32 s38, s26, 7
    s_lshl_b32 s39, s32, 17
    s_add_u32 s38, s38, s39
    v_add_u32 v8, s38, v8
    v_mov_b32 v138, v8
    s_waitcnt vmcnt(8)
    v_mov_b32 v6, 10
    ds_write_b32 v5, v6 offset:0
    s_mov_b32 s3, 0x10000
wl_10:
    ds_read_b128 v[12:15], v1 offset:16
    s_waitcnt lgkmcnt(0)
    v_min_u32 v12, v12, v13
    v_min3_u32 v12, v12, v14, v15
    s_nop 0
    v_readfirstlane_b32 s30, v12
    s_cmp_ge_u32 s30, 7
    s_nop 3
    s_cbranch_scc1 wl_10d
    s_sub_u32 s3, s3, 1
    s_cbranch_scc0 wl_10
wl_10d:
    s_add_u32 m0, s35, 81920
    s_add_u32 s39, s66, 0
    buffer_load_dwordx4 v4, s[48:51], s39 offen lds
    s_add_u32 m0, s35, 82944
    s_add_u32 s39, s66, 24576
    buffer_load_dwordx4 v4, s[48:51], s39 offen lds
    s_add_u32 m0, s35, 83968
    s_add_u32 s39, s66, 49152
    buffer_load_dwordx4 v4, s[48:51], s39 offen lds
    s_add_u32 m0, s35, 84992
    s_add_u32 s39, s66, 73728
    buffer_load_dwordx4 v4, s[48:51], s39 offen lds
    s_add_u32 m0, s35, 90112
    s_add_u32 s39, s67, 0
    buffer_load_dwordx4 v4, s[48:51], s39 offen lds
    s_add_u32 m0, s35, 91136
    s_add_u32 s39, s67, 24576
    buffer_load_dwordx4 v4, s[48:51], s39 offen lds
    s_add_u32 m0, s35, 92160
    s_add_u32 s39, s67, 49152
    buffer_load_dwordx4 v4, s[48:51], s39 offen lds
    s_add_u32 m0, s35, 93184
    s_add_u32 s39, s67, 73728
    buffer_load_dwordx4 v4, s[48:51], s39 offen lds
    s_waitcnt vmcnt(8)
    v_mov_b32 v6, 11
    ds_write_b32 v5, v6 offset:0
    s_waitcnt vmcnt(0)
    v_mov_b32 v6, 12
    ds_write_b32 v5, v6 offset:0
    s_mov_b32 s40, s24
    s_mov_b32 s41, s25
    s_mov_b32 s3, 0x10000
wl_11:
    ds_read_b32 v12, v1 offset:32
    s_waitcnt lgkmcnt(0)
    v_readfirstlane_b32 s29, v12
    s_cmp_ge_u32 s29, 1
    s_nop 3
    s_cbranch_scc1 wl_11d
    s_sleep 1
    s_sub_u32 s3, s3, 1
    s_cbranch_scc0 wl_11
wl_11d:
    s_cmp_eq_u32 s28, 5
    s_cbranch_scc1 recurrent_scan__sliding_block__moe_arch_mod__prompt_kernel_sv
    s_lshl_b32 s35, s26, 7
    s_mov_b32 s3, 0x10000
wl_12:
    ds_read_b128 v[12:15], v1 offset:16
    s_waitcnt lgkmcnt(0)
    v_min_u32 v12, v12, v13
    v_min3_u32 v12, v12, v14, v15
    s_nop 0
    v_readfirstlane_b32 s30, v12
    s_cmp_ge_u32 s30, 9
    s_nop 3
    s_cbranch_scc1 wl_12d
    s_sleep 1
    s_sub_u32 s3, s3, 1
    s_cbranch_scc0 wl_12
wl_12d:
    s_mov_b32 m0, 122880
    s_add_u32 s36, s35, 0
    buffer_load_dwordx4 v2, s[44:47], s36 offen lds
    s_mov_b32 m0, 123904
    s_add_u32 s36, s35, 0
    buffer_load_dwordx4 v3, s[44:47], s36 offen lds
    s_mov_b32 m0, 124928
    s_add_u32 s36, s35, 16384
    buffer_load_dwordx4 v2, s[44:47], s36 offen lds
    s_mov_b32 m0, 125952
    s_add_u32 s36, s35, 16384
    buffer_load_dwordx4 v3, s[44:47], s36 offen lds
    s_mov_b32 m0, 126976
    s_add_u32 s36, s35, 32768
    buffer_load_dwordx4 v2, s[44:47], s36 offen lds
    s_mov_b32 m0, 128000
    s_add_u32 s36, s35, 32768
    buffer_load_dwordx4 v3, s[44:47], s36 offen lds
    s_mov_b32 m0, 129024
    s_add_u32 s36, s35, 49152
    buffer_load_dwordx4 v2, s[44:47], s36 offen lds
    s_mov_b32 m0, 130048
    s_add_u32 s36, s35, 49152
    buffer_load_dwordx4 v3, s[44:47], s36 offen lds
    v_mov_b32 v6, 1
    s_waitcnt vmcnt(0)
    ds_write_b32 v1, v6 offset:164
    s_branch recurrent_scan__sliding_block__moe_arch_mod__prompt_kernel_sv
recurrent_scan__sliding_block__moe_arch_mod__prompt_kernel_kw:
    s_memrealtime s[36:37]
    v_lshrrev_b32 v10, 3, v0
    v_and_b32 v11, 7, v0
    v_lshlrev_b32 v11, 4, v11
    s_lshl_b32 s33, s27, 6
    s_lshl_b32 s34, s26, 3
    s_add_u32 s33, s33, s34
    v_add_u32 v9, s33, v10
    v_lshl_add_u32 v12, v9, 10, v11
    v_mov_b32 v13, 0
    s_waitcnt lgkmcnt(0)
    s_cmp_lg_u32 s2, 0
    s_cbranch_scc1 recurrent_scan__sliding_block__moe_arch_mod__prompt_kernel_ep_n
    s_or_b32 s36, s36, 1
    v_mov_b32 v14, s36
    global_store_dword v13, v14, s[22:23] sc1
    global_store_dword v13, v14, s[22:23] offset:128 sc1
recurrent_scan__sliding_block__moe_arch_mod__prompt_kernel_ep_n:
    global_load_dwordx4 v[16:19], v12, s[4:5] offset:0
    global_load_dwordx4 v[20:23], v12, s[4:5] offset:128
    global_load_dwordx4 v[24:27], v12, s[4:5] offset:256
    global_load_dwordx4 v[28:31], v12, s[4:5] offset:384
    global_load_dwordx4 v[32:35], v12, s[4:5] offset:512
    global_load_dwordx4 v[36:39], v12, s[4:5] offset:640
    global_load_dwordx4 v[40:43], v12, s[4:5] offset:768
    global_load_dwordx4 v[44:47], v12, s[4:5] offset:896
    global_load_dwordx4 v[48:51], v11, s[12:13] offset:0
    global_load_dwordx4 v[52:55], v11, s[12:13] offset:128
    global_load_dwordx4 v[56:59], v11, s[12:13] offset:256
    global_load_dwordx4 v[60:63], v11, s[12:13] offset:384
    global_load_dwordx4 v[64:67], v11, s[12:13] offset:512
    global_load_dwordx4 v[68:71], v11, s[12:13] offset:640
    global_load_dwordx4 v[72:75], v11, s[12:13] offset:768
    global_load_dwordx4 v[76:79], v11, s[12:13] offset:896
    s_barrier
    s_mov_b32 s40, s24
    s_mov_b32 s41, s25
    s_mov_b32 s39, 0x3f803f80
    s_sleep 30
    s_load_dword s29, s[22:23], 128
    s_waitcnt vmcnt(0)
    v_mov_b32 v80, 0
    v_mov_b32 v81, 0
    v_mov_b32 v82, 0
    v_mov_b32 v83, 0
    v_mov_b32 v84, 0
    v_mov_b32 v85, 0
    v_mov_b32 v86, 0
    v_mov_b32 v87, 0
    v_dot2_f32_bf16 v80, v16, s39, v80
    v_dot2_f32_bf16 v82, v16, v16, v82
    v_dot2_f32_bf16 v84, v16, v48, v84
    v_dot2_f32_bf16 v86, v48, s39, v86
    v_dot2_f32_bf16 v81, v17, s39, v81
    v_dot2_f32_bf16 v83, v17, v17, v83
    v_dot2_f32_bf16 v85, v17, v49, v85
    v_dot2_f32_bf16 v87, v49, s39, v87
    v_dot2_f32_bf16 v80, v18, s39, v80
    v_dot2_f32_bf16 v82, v18, v18, v82
    v_dot2_f32_bf16 v84, v18, v50, v84
    v_dot2_f32_bf16 v86, v50, s39, v86
    v_dot2_f32_bf16 v81, v19, s39, v81
    v_dot2_f32_bf16 v83, v19, v19, v83
    v_dot2_f32_bf16 v85, v19, v51, v85
    v_dot2_f32_bf16 v87, v51, s39, v87
    v_dot2_f32_bf16 v80, v20, s39, v80
    v_dot2_f32_bf16 v82, v20, v20, v82
    v_dot2_f32_bf16 v84, v20, v52, v84
    v_dot2_f32_bf16 v86, v52, s39, v86
    v_dot2_f32_bf16 v81, v21, s39, v81
    v_dot2_f32_bf16 v83, v21, v21, v83
    v_dot2_f32_bf16 v85, v21, v53, v85
    v_dot2_f32_bf16 v87, v53, s39, v87
    v_dot2_f32_bf16 v80, v22, s39, v80
    v_dot2_f32_bf16 v82, v22, v22, v82
    v_dot2_f32_bf16 v84, v22, v54, v84
    v_dot2_f32_bf16 v86, v54, s39, v86
    v_dot2_f32_bf16 v81, v23, s39, v81
    v_dot2_f32_bf16 v83, v23, v23, v83
    v_dot2_f32_bf16 v85, v23, v55, v85
    v_dot2_f32_bf16 v87, v55, s39, v87
    v_dot2_f32_bf16 v80, v24, s39, v80
    v_dot2_f32_bf16 v82, v24, v24, v82
    v_dot2_f32_bf16 v84, v24, v56, v84
    v_dot2_f32_bf16 v86, v56, s39, v86
    v_dot2_f32_bf16 v81, v25, s39, v81
    v_dot2_f32_bf16 v83, v25, v25, v83
    v_dot2_f32_bf16 v85, v25, v57, v85
    v_dot2_f32_bf16 v87, v57, s39, v87
    v_dot2_f32_bf16 v80, v26, s39, v80
    v_dot2_f32_bf16 v82, v26, v26, v82
    v_dot2_f32_bf16 v84, v26, v58, v84
    v_dot2_f32_bf16 v86, v58, s39, v86
    v_dot2_f32_bf16 v81, v27, s39, v81
    v_dot2_f32_bf16 v83, v27, v27, v83
    v_dot2_f32_bf16 v85, v27, v59, v85
    v_dot2_f32_bf16 v87, v59, s39, v87
    v_dot2_f32_bf16 v80, v28, s39, v80
    v_dot2_f32_bf16 v82, v28, v28, v82
    v_dot2_f32_bf16 v84, v28, v60, v84
    v_dot2_f32_bf16 v86, v60, s39, v86
    v_dot2_f32_bf16 v81, v29, s39, v81
    v_dot2_f32_bf16 v83, v29, v29, v83
    v_dot2_f32_bf16 v85, v29, v61, v85
    v_dot2_f32_bf16 v87, v61, s39, v87
    v_dot2_f32_bf16 v80, v30, s39, v80
    v_dot2_f32_bf16 v82, v30, v30, v82
    v_dot2_f32_bf16 v84, v30, v62, v84
    v_dot2_f32_bf16 v86, v62, s39, v86
    v_dot2_f32_bf16 v81, v31, s39, v81
    v_dot2_f32_bf16 v83, v31, v31, v83
    v_dot2_f32_bf16 v85, v31, v63, v85
    v_dot2_f32_bf16 v87, v63, s39, v87
    v_dot2_f32_bf16 v80, v32, s39, v80
    v_dot2_f32_bf16 v82, v32, v32, v82
    v_dot2_f32_bf16 v84, v32, v64, v84
    v_dot2_f32_bf16 v86, v64, s39, v86
    v_dot2_f32_bf16 v81, v33, s39, v81
    v_dot2_f32_bf16 v83, v33, v33, v83
    v_dot2_f32_bf16 v85, v33, v65, v85
    v_dot2_f32_bf16 v87, v65, s39, v87
    v_dot2_f32_bf16 v80, v34, s39, v80
    v_dot2_f32_bf16 v82, v34, v34, v82
    v_dot2_f32_bf16 v84, v34, v66, v84
    v_dot2_f32_bf16 v86, v66, s39, v86
    v_dot2_f32_bf16 v81, v35, s39, v81
    v_dot2_f32_bf16 v83, v35, v35, v83
    v_dot2_f32_bf16 v85, v35, v67, v85
    v_dot2_f32_bf16 v87, v67, s39, v87
    v_dot2_f32_bf16 v80, v36, s39, v80
    v_dot2_f32_bf16 v82, v36, v36, v82
    v_dot2_f32_bf16 v84, v36, v68, v84
    v_dot2_f32_bf16 v86, v68, s39, v86
    v_dot2_f32_bf16 v81, v37, s39, v81
    v_dot2_f32_bf16 v83, v37, v37, v83
    v_dot2_f32_bf16 v85, v37, v69, v85
    v_dot2_f32_bf16 v87, v69, s39, v87
    v_dot2_f32_bf16 v80, v38, s39, v80
    v_dot2_f32_bf16 v82, v38, v38, v82
    v_dot2_f32_bf16 v84, v38, v70, v84
    v_dot2_f32_bf16 v86, v70, s39, v86
    v_dot2_f32_bf16 v81, v39, s39, v81
    v_dot2_f32_bf16 v83, v39, v39, v83
    v_dot2_f32_bf16 v85, v39, v71, v85
    v_dot2_f32_bf16 v87, v71, s39, v87
    v_dot2_f32_bf16 v80, v40, s39, v80
    v_dot2_f32_bf16 v82, v40, v40, v82
    v_dot2_f32_bf16 v84, v40, v72, v84
    v_dot2_f32_bf16 v86, v72, s39, v86
    v_dot2_f32_bf16 v81, v41, s39, v81
    v_dot2_f32_bf16 v83, v41, v41, v83
    v_dot2_f32_bf16 v85, v41, v73, v85
    v_dot2_f32_bf16 v87, v73, s39, v87
    v_dot2_f32_bf16 v80, v42, s39, v80
    v_dot2_f32_bf16 v82, v42, v42, v82
    v_dot2_f32_bf16 v84, v42, v74, v84
    v_dot2_f32_bf16 v86, v74, s39, v86
    v_dot2_f32_bf16 v81, v43, s39, v81
    v_dot2_f32_bf16 v83, v43, v43, v83
    v_dot2_f32_bf16 v85, v43, v75, v85
    v_dot2_f32_bf16 v87, v75, s39, v87
    v_dot2_f32_bf16 v80, v44, s39, v80
    v_dot2_f32_bf16 v82, v44, v44, v82
    v_dot2_f32_bf16 v84, v44, v76, v84
    v_dot2_f32_bf16 v86, v76, s39, v86
    v_dot2_f32_bf16 v81, v45, s39, v81
    v_dot2_f32_bf16 v83, v45, v45, v83
    v_dot2_f32_bf16 v85, v45, v77, v85
    v_dot2_f32_bf16 v87, v77, s39, v87
    v_dot2_f32_bf16 v80, v46, s39, v80
    v_dot2_f32_bf16 v82, v46, v46, v82
    v_dot2_f32_bf16 v84, v46, v78, v84
    v_dot2_f32_bf16 v86, v78, s39, v86
    v_dot2_f32_bf16 v81, v47, s39, v81
    v_dot2_f32_bf16 v83, v47, v47, v83
    v_dot2_f32_bf16 v85, v47, v79, v85
    v_dot2_f32_bf16 v87, v79, s39, v87
    v_add_f32 v80, v80, v81
    v_add_f32 v82, v82, v83
    v_add_f32 v84, v84, v85
    v_add_f32 v86, v86, v87
    v_add_f32_dpp v80, v80, v80 quad_perm:[1,0,3,2] row_mask:0xf bank_mask:0xf
    v_add_f32_dpp v82, v82, v82 quad_perm:[1,0,3,2] row_mask:0xf bank_mask:0xf
    v_add_f32_dpp v84, v84, v84 quad_perm:[1,0,3,2] row_mask:0xf bank_mask:0xf
    v_add_f32_dpp v86, v86, v86 quad_perm:[1,0,3,2] row_mask:0xf bank_mask:0xf
    v_add_f32_dpp v80, v80, v80 quad_perm:[2,3,0,1] row_mask:0xf bank_mask:0xf
    v_add_f32_dpp v82, v82, v82 quad_perm:[2,3,0,1] row_mask:0xf bank_mask:0xf
    v_add_f32_dpp v84, v84, v84 quad_perm:[2,3,0,1] row_mask:0xf bank_mask:0xf
    v_add_f32_dpp v86, v86, v86 quad_perm:[2,3,0,1] row_mask:0xf bank_mask:0xf
    v_add_f32_dpp v80, v80, v80 row_half_mirror row_mask:0xf bank_mask:0xf
    v_add_f32_dpp v82, v82, v82 row_half_mirror row_mask:0xf bank_mask:0xf
    v_add_f32_dpp v84, v84, v84 row_half_mirror row_mask:0xf bank_mask:0xf
    v_add_f32_dpp v86, v86, v86 row_half_mirror row_mask:0xf bank_mask:0xf
    v_mul_f32 v16, 0x3b000000, v80
    v_mul_f32 v17, 0x3b000000, v82
    v_fma_f32 v17, -v16, v16, v17
    v_max_f32 v17, 0, v17
    v_cvt_pk_bf16_f32 v18, v16, v17
    v_lshlrev_b32 v16, 16, v18
    v_and_b32 v17, 0xffff0000, v18
    v_add_f32 v17, 0x3727c5ac, v17
    v_cvt_pk_bf16_f32 v17, v17, v17
    v_lshlrev_b32 v17, 16, v17
    v_sqrt_f32 v17, v17
    v_xor_b32 v16, 0x80000000, v16
    v_cvt_pk_bf16_f32 v17, v17, v17
    v_lshlrev_b32 v19, 16, v17
    v_rcp_f32 v17, v19
    s_waitcnt lgkmcnt(0)
    s_cmp_lg_u32 s29, 0
    s_cbranch_scc1 recurrent_scan__sliding_block__moe_arch_mod__prompt_kernel_ep_done
    s_load_dword s29, s[22:23], 0
    s_waitcnt lgkmcnt(0)
    s_cmp_lg_u32 s29, 0
    s_cbranch_scc1 recurrent_scan__sliding_block__moe_arch_mod__prompt_kernel_ep_done
    s_mov_b32 s3, 0x8000
recurrent_scan__sliding_block__moe_arch_mod__prompt_kernel_ep_l:
    global_load_dword v14, v13, s[22:23] sc1
    s_waitcnt vmcnt(0)
    v_readfirstlane_b32 s29, v14
    s_cmp_lg_u32 s29, 0
    s_nop 3
    s_cbranch_scc1 recurrent_scan__sliding_block__moe_arch_mod__prompt_kernel_ep_done
    s_sleep 8
    s_sub_u32 s3, s3, 1
    s_cbranch_scc0 recurrent_scan__sliding_block__moe_arch_mod__prompt_kernel_ep_l
    s_mov_b32 s29, 1
recurrent_scan__sliding_block__moe_arch_mod__prompt_kernel_ep_done:
    v_mov_b32 v14, s29
    ds_write_b32 v1, v14 offset:32
    v_fma_f32 v18, v16, v86, v84
    v_mul_f32 v18, v18, v17
    v_lshrrev_b32 v19, 16, v19
    v_and_b32 v16, 0xffff0000, v16
    v_or_b32 v20, v16, v19
    v_mov_b32 v21, s29
    v_ashrrev_i32 v19, 31, v18
    v_or_b32 v19, 0x80000000, v19
    v_xor_b32 v18, v18, v19
    v_and_b32 v18, 0xfffff800, v18
    v_sub_u32 v19, 2047, v9
    v_or_b32 v18, v18, v19
    v_lshl_add_u32 v12, v10, 2, v1
    ds_write_b32 v12, v18 offset:384
    v_lshlrev_b32 v9, 3, v9
    s_mov_b32 s34, 7684096
    s_mov_b32 s36, 0x01010101
    s_mov_b32 s37, 0x01010101
    s_waitcnt lgkmcnt(0)
    ds_read_b128 v[24:27], v1 offset:384
    ds_read_b128 v[28:31], v1 offset:400
    s_mov_b64 exec, s[36:37]
    buffer_store_dwordx2 v[20:21], v9, s[40:43], s34 offen sc1
    v_mov_b32 v22, 0
    s_lshl_b32 s33, s27, 3
    s_add_u32 s33, s33, s26
    s_lshr_b32 s34, s33, 6
    s_lshl_b32 s34, s34, 12
    s_and_b32 s33, s33, 63
    s_lshl_b32 s33, s33, 4
    s_add_u32 s34, s34, s33
    s_add_u32 s34, s34, 7667712
    v_mov_b32 v19, s29
    s_waitcnt lgkmcnt(0)
    v_cmp_gt_u32 vcc, v24, v18
    s_nop 1
    v_addc_co_u32 v22, vcc, 0, v22, vcc
    v_cmp_gt_u32 vcc, v25, v18
    s_nop 1
    v_addc_co_u32 v22, vcc, 0, v22, vcc
    v_cmp_gt_u32 vcc, v26, v18
    s_nop 1
    v_addc_co_u32 v22, vcc, 0, v22, vcc
    v_cmp_gt_u32 vcc, v27, v18
    s_nop 1
    v_addc_co_u32 v22, vcc, 0, v22, vcc
    v_cmp_gt_u32 vcc, v28, v18
    s_nop 1
    v_addc_co_u32 v22, vcc, 0, v22, vcc
    v_cmp_gt_u32 vcc, v29, v18
    s_nop 1
    v_addc_co_u32 v22, vcc, 0, v22, vcc
    v_cmp_gt_u32 vcc, v30, v18
    s_nop 1
    v_addc_co_u32 v22, vcc, 0, v22, vcc
    v_cmp_gt_u32 vcc, v31, v18
    s_nop 1
    v_addc_co_u32 v22, vcc, 0, v22, vcc
    v_lshrrev_b32 v23, 1, v22
    v_lshlrev_b32 v23, 10, v23
    v_and_b32 v22, 1, v22
    v_lshl_add_u32 v23, v22, 3, v23
    buffer_store_dwordx2 v[18:19], v23, s[40:43], s34 offen sc1
    s_mov_b64 exec, -1
    s_cmp_eq_u32 s2, 24
    s_cbranch_scc1 recurrent_scan__sliding_block__moe_arch_mod__prompt_kernel_sel
    s_lshr_b32 s35, s2, 3
    v_lshrrev_b32 v209, 2, v0
    v_lshlrev_b32 v209, 10, v209
    v_and_b32 v7, 3, v0
    v_lshl_add_u32 v209, v7, 7, v209
    s_lshl_b32 s34, s35, 14
    s_and_b32 s36, s2, 1
    s_lshl_b32 s36, s36, 9
    s_add_u32 s34, s34, s36
    v_add_u32 v209, s34, v209
    s_cmp_gt_u32 s26, 3
    s_subb_u32 s35, s26, 0
    s_mul_i32 s3, s27, 7
    s_add_u32 s35, s35, s3
    s_lshr_b32 s34, s35, 2
    s_lshl_b32 s34, s34, 15
    s_and_b32 s33, s35, 3
    s_lshl_b32 s33, s33, 8
    s_add_u32 s34, s34, s33
    v_lshrrev_b32 v208, 1, v0
    v_lshlrev_b32 v208, 10, v208
    v_and_b32 v7, 1, v0
    v_lshl_add_u32 v208, v7, 7, v208
    v_add_u32 v208, s34, v208
    s_and_b32 s33, s35, 7
    s_lshr_b32 s35, s35, 3
    s_mul_i32 s34, s33, 229376
    s_lshl_b32 s35, s35, 7
    s_add_u32 s34, s34, s35
    v_mul_u32_u24 v211, 3584, v0
    v_add_u32 v211, s34, v211
    s_cmp_eq_u32 s26, 3
    s_nop 0
    s_cbranch_scc1 tr_13
    s_mov_b32 exec_lo, 0xffffffff
    s_mov_b32 exec_hi, 0xffffffff
    global_load_dword v210, v211, s[14:15]
    s_sleep 1
tr_13:
    s_cmp_eq_u32 s26, 3
    s_cbranch_scc1 tr_14
    s_mov_b32 exec_lo, 0xffffffff
    s_mov_b32 exec_hi, 0xffffffff
    global_load_dword v210, v211, s[16:17]
    s_sleep 1
tr_14:
    s_mov_b64 exec, -1
    s_branch recurrent_scan__sliding_block__moe_arch_mod__prompt_kernel_s1
recurrent_scan__sliding_block__moe_arch_mod__prompt_kernel_sel:
    v_lshlrev_b32 v2, 4, v0
    ds_write_b32 v1, v1 offset:168
    s_mov_b32 s3, 0x10000
wl_15:
    ds_read_b64 v[12:13], v1 offset:0
    s_waitcnt lgkmcnt(0)
    v_min_u32 v12, v12, v13
    s_nop 0
    v_readfirstlane_b32 s30, v12
    s_cmp_ge_u32 s30, 4
    s_nop 3
    s_cbranch_scc1 wl_15d
    s_sleep 2
    s_sub_u32 s3, s3, 1
    s_cbranch_scc0 wl_15
wl_15d:
    s_setprio 3
    s_mov_b32 s3, 0x4000
    s_mov_b32 s46, 0x02020202
    s_mov_b32 s47, 0x02020202
    s_mov_b32 s48, 0x04040404
    s_mov_b32 s49, 0x04040404
    s_mov_b32 s50, 0x08080808
    s_mov_b32 s51, 0x08080808
    s_mov_b32 s52, 0x10101010
    s_mov_b32 s53, 0x10101010
    s_mov_b32 s54, 0x20202020
    s_mov_b32 s55, 0x20202020
    s_mov_b32 s56, 0x40404040
    s_mov_b32 s57, 0x40404040
    s_mov_b32 s58, 0x80808080
    s_mov_b32 s59, 0x80808080
recurrent_scan__sliding_block__moe_arch_mod__prompt_kernel_fsw:
    s_mov_b32 s34, 7667712
    buffer_load_dwordx4 v[96:99], v2, s[40:43], s34 offen offset:0 sc1
    s_mov_b32 s34, 7671808
    buffer_load_dwordx4 v[100:103], v2, s[40:43], s34 offen offset:0 sc1
    s_mov_b32 s34, 7675904
    buffer_load_dwordx4 v[104:107], v2, s[40:43], s34 offen offset:0 sc1
    s_mov_b32 s34, 7680000
    buffer_load_dwordx4 v[108:111], v2, s[40:43], s34 offen offset:0 sc1
    s_mov_b32 s34, 7667712
    buffer_load_dwordx4 v[112:115], v2, s[40:43], s34 offen offset:1024 sc1
    s_mov_b32 s34, 7671808
    buffer_load_dwordx4 v[116:119], v2, s[40:43], s34 offen offset:1024 sc1
    s_mov_b32 s34, 7675904
    buffer_load_dwordx4 v[120:123], v2, s[40:43], s34 offen offset:1024 sc1
    s_mov_b32 s34, 7680000
    buffer_load_dwordx4 v[124:127], v2, s[40:43], s34 offen offset:1024 sc1
    v_mov_b32 v4, s29
    v_mov_b32 v5, s29
    s_waitcnt vmcnt(4)
    v_min3_u32 v4, v4, v97, v99
    v_max3_u32 v5, v5, v97, v99
    v_min3_u32 v4, v4, v101, v103
    v_max3_u32 v5, v5, v101, v103
    v_min3_u32 v4, v4, v105, v107
    v_max3_u32 v5, v5, v105, v107
    v_min3_u32 v4, v4, v109, v111
    v_max3_u32 v5, v5, v109, v111
    v_cmp_ne_u32 vcc, v4, v5
    s_nop 4
    s_cbranch_vccz recurrent_scan__sliding_block__moe_arch_mod__prompt_kernel_fsd
    s_sub_u32 s3, s3, 1
    s_cbranch_scc0 recurrent_scan__sliding_block__moe_arch_mod__prompt_kernel_fsw
recurrent_scan__sliding_block__moe_arch_mod__prompt_kernel_fsd:
    ds_write_b32 v1, v1 offset:144
    v_max_u32 v16, v96, v100
    v_min_u32 v25, v96, v100
    v_max3_u32 v18, v25, v98, v102
    v_med3_u32 v17, v25, v98, v102
    v_max_u32 v20, v104, v108
    v_min_u32 v27, v104, v108
    v_max3_u32 v22, v27, v106, v110
    v_med3_u32 v19, v27, v106, v110
    v_max_u32 v32, v16, v20
    v_min_u32 v25, v16, v20
    v_max3_u32 v34, v25, v18, v22
    v_med3_u32 v21, v25, v18, v22
    v_max3_u32 v17, v17, v19, v21
    v_max_u32_dpp v16, v34, v32 quad_perm:[1,0,3,2] row_mask:0xf bank_mask:0xf
    v_min_u32_dpp v20, v34, v32 quad_perm:[1,0,3,2] row_mask:0xf bank_mask:0xf
    v_max_u32_dpp v18, v32, v34 quad_perm:[1,0,3,2] row_mask:0xf bank_mask:0xf
    v_min_u32_dpp v22, v32, v34 quad_perm:[1,0,3,2] row_mask:0xf bank_mask:0xf
    v_max_u32 v32, v16, v18
    v_min_u32 v34, v16, v18
    v_max_u32 v36, v20, v22
    v_min_u32 v38, v20, v22
    s_nop 1
    v_max_u32_dpp v16, v38, v32 quad_perm:[2,3,0,1] row_mask:0xf bank_mask:0xf
    v_min_u32_dpp v24, v38, v32 quad_perm:[2,3,0,1] row_mask:0xf bank_mask:0xf
    v_max_u32_dpp v18, v36, v34 quad_perm:[2,3,0,1] row_mask:0xf bank_mask:0xf
    v_min_u32_dpp v26, v36, v34 quad_perm:[2,3,0,1] row_mask:0xf bank_mask:0xf
    v_max_u32_dpp v20, v34, v36 quad_perm:[2,3,0,1] row_mask:0xf bank_mask:0xf
    v_min_u32_dpp v28, v34, v36 quad_perm:[2,3,0,1] row_mask:0xf bank_mask:0xf
    v_max_u32_dpp v22, v32, v38 quad_perm:[2,3,0,1] row_mask:0xf bank_mask:0xf
    v_min_u32_dpp v30, v32, v38 quad_perm:[2,3,0,1] row_mask:0xf bank_mask:0xf
    v_max_u32 v32, v16, v20
    v_min_u32 v36, v16, v20
    v_max_u32 v34, v18, v22
    v_min_u32 v38, v18, v22
    v_max_u32 v40, v24, v28
    v_min_u32 v44, v24, v28
    v_max_u32 v42, v26, v30
    v_min_u32 v46, v26, v30
    v_max_u32 v16, v32, v34
    v_min_u32 v18, v32, v34
    v_max_u32 v20, v36, v38
    v_min_u32 v22, v36, v38
    v_max_u32 v24, v40, v42
    v_min_u32 v26, v40, v42
    v_max_u32 v28, v44, v46
    v_min_u32 v30, v44, v46
    s_nop 1
    v_max_u32_dpp v32, v30, v16 row_half_mirror row_mask:0xf bank_mask:0xf
    v_max_u32_dpp v34, v28, v18 row_half_mirror row_mask:0xf bank_mask:0xf
    v_max_u32_dpp v36, v26, v20 row_half_mirror row_mask:0xf bank_mask:0xf
    v_max_u32_dpp v38, v24, v22 row_half_mirror row_mask:0xf bank_mask:0xf
    v_max_u32_dpp v40, v22, v24 row_half_mirror row_mask:0xf bank_mask:0xf
    v_max_u32_dpp v42, v20, v26 row_half_mirror row_mask:0xf bank_mask:0xf
    v_max_u32_dpp v44, v18, v28 row_half_mirror row_mask:0xf bank_mask:0xf
    v_max_u32_dpp v46, v16, v30 row_half_mirror row_mask:0xf bank_mask:0xf
    v_max_u32 v16, v32, v40
    v_min_u32 v24, v32, v40
    v_max_u32 v18, v34, v42
    v_min_u32 v26, v34, v42
    v_max_u32 v20, v36, v44
    v_min_u32 v28, v36, v44
    v_max_u32 v22, v38, v46
    v_min_u32 v30, v38, v46
    v_max_u32 v32, v16, v20
    v_min_u32 v36, v16, v20
    v_max_u32 v34, v18, v22
    v_min_u32 v38, v18, v22
    v_max_u32 v40, v24, v28
    v_min_u32 v44, v24, v28
    v_max_u32 v42, v26, v30
    v_min_u32 v46, v26, v30
    v_max_u32 v16, v32, v34
    v_min_u32 v18, v32, v34
    v_max_u32 v20, v36, v38
    v_min_u32 v22, v36, v38
    v_max_u32 v24, v40, v42
    v_min_u32 v26, v40, v42
    v_max_u32 v28, v44, v46
    v_min_u32 v30, v44, v46
    s_nop 1
    v_max_u32_dpp v32, v30, v16 row_mirror row_mask:0xf bank_mask:0xf
    v_max_u32_dpp v34, v28, v18 row_mirror row_mask:0xf bank_mask:0xf
    v_max_u32_dpp v36, v26, v20 row_mirror row_mask:0xf bank_mask:0xf
    v_max_u32_dpp v38, v24, v22 row_mirror row_mask:0xf bank_mask:0xf
    v_max_u32_dpp v40, v22, v24 row_mirror row_mask:0xf bank_mask:0xf
    v_max_u32_dpp v42, v20, v26 row_mirror row_mask:0xf bank_mask:0xf
    v_max_u32_dpp v44, v18, v28 row_mirror row_mask:0xf bank_mask:0xf
    v_max_u32_dpp v46, v16, v30 row_mirror row_mask:0xf bank_mask:0xf
    v_max_u32 v16, v32, v40
    v_min_u32 v24, v32, v40
    v_max_u32 v18, v34, v42
    v_min_u32 v26, v34, v42
    v_max_u32 v20, v36, v44
    v_min_u32 v28, v36, v44
    v_max_u32 v22, v38, v46
    v_min_u32 v30, v38, v46
    v_max_u32 v32, v16, v20
    v_min_u32 v36, v16, v20
    v_max_u32 v34, v18, v22
    v_min_u32 v38, v18, v22
    v_max_u32 v40, v24, v28
    v_min_u32 v44, v24, v28
    v_max_u32 v42, v26, v30
    v_min_u32 v46, v26, v30
    v_max_u32 v16, v32, v34
    v_min_u32 v18, v32, v34
    v_max_u32 v20, v36, v38
    v_min_u32 v22, v36, v38
    v_max_u32 v24, v40, v42
    v_min_u32 v26, v40, v42
    v_max_u32 v28, v44, v46
    v_min_u32 v30, v44, v46
    v_mov_b32 v32, v16
    v_mov_b32 v34, v18
    v_mov_b32 v36, v20
    v_mov_b32 v38, v22
    v_mov_b32 v40, v24
    v_mov_b32 v42, v26
    v_mov_b32 v44, v28
    v_mov_b32 v46, v30
    v_permlane16_swap_b32 v16, v32
    v_permlane16_swap_b32 v18, v34
    v_permlane16_swap_b32 v20, v36
    v_permlane16_swap_b32 v22, v38
    v_permlane16_swap_b32 v24, v40
    v_permlane16_swap_b32 v26, v42
    v_permlane16_swap_b32 v28, v44
    v_permlane16_swap_b32 v30, v46
    v_max_u32 v48, v16, v46
    v_max_u32 v50, v18, v44
    v_max_u32 v52, v20, v42
    v_max_u32 v54, v22, v40
    v_max_u32 v56, v24, v38
    v_max_u32 v58, v26, v36
    v_max_u32 v60, v28, v34
    v_max_u32 v62, v30, v32
    v_max_u32 v16, v48, v56
    v_min_u32 v24, v48, v56
    v_max_u32 v18, v50, v58
    v_min_u32 v26, v50, v58
    v_max_u32 v20, v52, v60
    v_min_u32 v28, v52, v60
    v_max_u32 v22, v54, v62
    v_min_u32 v30, v54, v62
    v_max_u32 v48, v16, v20
    v_min_u32 v52, v16, v20
    v_max_u32 v50, v18, v22
    v_min_u32 v54, v18, v22
    v_max_u32 v56, v24, v28
    v_min_u32 v60, v24, v28
    v_max_u32 v58, v26, v30
    v_min_u32 v62, v26, v30
    v_max_u32 v16, v48, v50
    v_min_u32 v18, v48, v50
    v_max_u32 v20, v52, v54
    v_min_u32 v22, v52, v54
    v_max_u32 v24, v56, v58
    v_min_u32 v26, v56, v58
    v_max_u32 v28, v60, v62
    v_min_u32 v30, v60, v62
    v_mov_b32 v32, v16
    v_mov_b32 v34, v18
    v_mov_b32 v36, v20
    v_mov_b32 v38, v22
    v_mov_b32 v40, v24
    v_mov_b32 v42, v26
    v_mov_b32 v44, v28
    v_mov_b32 v46, v30
    v_permlane32_swap_b32 v16, v32
    v_permlane32_swap_b32 v18, v34
    v_permlane32_swap_b32 v20, v36
    v_permlane32_swap_b32 v22, v38
    v_permlane32_swap_b32 v24, v40
    v_permlane32_swap_b32 v26, v42
    v_permlane32_swap_b32 v28, v44
    v_permlane32_swap_b32 v30, v46
    v_max_u32 v48, v16, v46
    v_max_u32 v50, v18, v44
    v_max_u32 v52, v20, v42
    v_max_u32 v54, v22, v40
    v_max_u32 v56, v24, v38
    v_max_u32 v58, v26, v36
    v_max_u32 v60, v28, v34
    v_max_u32 v62, v30, v32
    s_waitcnt vmcnt(0)
    v_min3_u32 v25, v48, v50, v52
    v_max3_u32 v17, v17, v112, v116
    v_min3_u32 v25, v25, v54, v56
    v_max3_u32 v17, v17, v120, v124
    v_min3_u32 v25, v25, v58, v60
    v_min3_u32 v4, v4, v113, v117
    v_max3_u32 v5, v5, v113, v117
    v_min_u32 v25, v25, v62
    v_min3_u32 v4, v4, v121, v125
    v_max3_u32 v5, v5, v121, v125
    v_cmp_ge_u32 vcc, v17, v25
    v_cmp_ne_u32 s[34:35], v4, v5
    s_or_b64 vcc, vcc, s[34:35]
    s_nop 3
    s_cbranch_vccz recurrent_scan__sliding_block__moe_arch_mod__prompt_kernel_seld
    s_mov_b32 s3, 0x4000
recurrent_scan__sliding_block__moe_arch_mod__prompt_kernel_sweep:
    s_mov_b32 s34, 7667712
    buffer_load_dwordx4 v[16:19], v2, s[40:43], s34 offen offset:0 sc1
    buffer_load_dwordx4 v[20:23], v2, s[40:43], s34 offen offset:1024 sc1
    buffer_load_dwordx4 v[24:27], v2, s[40:43], s34 offen offset:2048 sc1
    buffer_load_dwordx4 v[28:31], v2, s[40:43], s34 offen offset:3072 sc1
    s_mov_b32 s34, 7671808
    buffer_load_dwordx4 v[32:35], v2, s[40:43], s34 offen offset:0 sc1
    buffer_load_dwordx4 v[36:39], v2, s[40:43], s34 offen offset:1024 sc1
    buffer_load_dwordx4 v[40:43], v2, s[40:43], s34 offen offset:2048 sc1
    buffer_load_dwordx4 v[44:47], v2, s[40:43], s34 offen offset:3072 sc1
    s_mov_b32 s34, 7675904
    buffer_load_dwordx4 v[48:51], v2, s[40:43], s34 offen offset:0 sc1
    buffer_load_dwordx4 v[52:55], v2, s[40:43], s34 offen offset:1024 sc1
    buffer_load_dwordx4 v[56:59], v2, s[40:43], s34 offen offset:2048 sc1
    buffer_load_dwordx4 v[60:63], v2, s[40:43], s34 offen offset:3072 sc1
    s_mov_b32 s34, 7680000
    buffer_load_dwordx4 v[64:67], v2, s[40:43], s34 offen offset:0 sc1
    buffer_load_dwordx4 v[68:71], v2, s[40:43], s34 offen offset:1024 sc1
    buffer_load_dwordx4 v[72:75], v2, s[40:43], s34 offen offset:2048 sc1
    buffer_load_dwordx4 v[76:79], v2, s[40:43], s34 offen offset:3072 sc1
    v_mov_b32 v4, s29
    v_mov_b32 v5, s29
    s_waitcnt vmcnt(0)
    v_min3_u32 v4, v4, v17, v19
    v_max3_u32 v5, v5, v17, v19
    v_min3_u32 v4, v4, v21, v23
    v_max3_u32 v5, v5, v21, v23
    v_min3_u32 v4, v4, v25, v27
    v_max3_u32 v5, v5, v25, v27
    v_min3_u32 v4, v4, v29, v31
    v_max3_u32 v5, v5, v29, v31
    v_min3_u32 v4, v4, v33, v35
    v_max3_u32 v5, v5, v33, v35
    v_min3_u32 v4, v4, v37, v39
    v_max3_u32 v5, v5, v37, v39
    v_min3_u32 v4, v4, v41, v43
    v_max3_u32 v5, v5, v41, v43
    v_min3_u32 v4, v4, v45, v47
    v_max3_u32 v5, v5, v45, v47
    v_min3_u32 v4, v4, v49, v51
    v_max3_u32 v5, v5, v49, v51
    v_min3_u32 v4, v4, v53, v55
    v_max3_u32 v5, v5, v53, v55
    v_min3_u32 v4, v4, v57, v59
    v_max3_u32 v5, v5, v57, v59
    v_min3_u32 v4, v4, v61, v63
    v_max3_u32 v5, v5, v61, v63
    v_min3_u32 v4, v4, v65, v67
    v_max3_u32 v5, v5, v65, v67
    v_min3_u32 v4, v4, v69, v71
    v_max3_u32 v5, v5, v69, v71
    v_min3_u32 v4, v4, v73, v75
    v_max3_u32 v5, v5, v73, v75
    v_min3_u32 v4, v4, v77, v79
    v_max3_u32 v5, v5, v77, v79
    v_cmp_ne_u32 vcc, v4, v5
    s_nop 4
    s_cbranch_vccz recurrent_scan__sliding_block__moe_arch_mod__prompt_kernel_swept
    s_sleep 4
    s_sub_u32 s3, s3, 1
    s_cbranch_scc0 recurrent_scan__sliding_block__moe_arch_mod__prompt_kernel_sweep
recurrent_scan__sliding_block__moe_arch_mod__prompt_kernel_swept:
    ds_write_b32 v1, v1 offset:144
    v_max_u32 v17, v16, v46
    v_max_u32 v19, v18, v44
    v_max_u32 v21, v20, v42
    v_max_u32 v23, v22, v40
    v_max_u32 v25, v24, v38
    v_max_u32 v27, v26, v36
    v_max_u32 v29, v28, v34
    v_max_u32 v31, v30, v32
    v_max_u32 v33, v17, v25
    v_min_u32 v41, v17, v25
    v_max_u32 v35, v19, v27
    v_min_u32 v43, v19, v27
    v_max_u32 v37, v21, v29
    v_min_u32 v45, v21, v29
    v_max_u32 v39, v23, v31
    v_min_u32 v47, v23, v31
    v_max_u32 v17, v33, v37
    v_min_u32 v21, v33, v37
    v_max_u32 v19, v35, v39
    v_min_u32 v23, v35, v39
    v_max_u32 v25, v41, v45
    v_min_u32 v29, v41, v45
    v_max_u32 v27, v43, v47
    v_min_u32 v31, v43, v47
    v_max_u32 v33, v17, v19
    v_min_u32 v35, v17, v19
    v_max_u32 v37, v21, v23
    v_min_u32 v39, v21, v23
    v_max_u32 v41, v25, v27
    v_min_u32 v43, v25, v27
    v_max_u32 v45, v29, v31
    v_min_u32 v47, v29, v31
    v_max_u32 v49, v48, v78
    v_max_u32 v51, v50, v76
    v_max_u32 v53, v52, v74
    v_max_u32 v55, v54, v72
    v_max_u32 v57, v56, v70
    v_max_u32 v59, v58, v68
    v_max_u32 v61, v60, v66
    v_max_u32 v63, v62, v64
    v_max_u32 v65, v49, v57
    v_min_u32 v73, v49, v57
    v_max_u32 v67, v51, v59
    v_min_u32 v75, v51, v59
    v_max_u32 v69, v53, v61
    v_min_u32 v77, v53, v61
    v_max_u32 v71, v55, v63
    v_min_u32 v79, v55, v63
    v_max_u32 v49, v65, v69
    v_min_u32 v53, v65, v69
    v_max_u32 v51, v67, v71
    v_min_u32 v55, v67, v71
    v_max_u32 v57, v73, v77
    v_min_u32 v61, v73, v77
    v_max_u32 v59, v75, v79
    v_min_u32 v63, v75, v79
    v_max_u32 v65, v49, v51
    v_min_u32 v67, v49, v51
    v_max_u32 v69, v53, v55
    v_min_u32 v71, v53, v55
    v_max_u32 v73, v57, v59
    v_min_u32 v75, v57, v59
    v_max_u32 v77, v61, v63
    v_min_u32 v79, v61, v63
    v_max_u32 v16, v33, v79
    v_max_u32 v18, v35, v77
    v_max_u32 v20, v37, v75
    v_max_u32 v22, v39, v73
    v_max_u32 v24, v41, v71
    v_max_u32 v26, v43, v69
    v_max_u32 v28, v45, v67
    v_max_u32 v30, v47, v65
    v_max_u32 v32, v16, v24
    v_min_u32 v40, v16, v24
    v_max_u32 v34, v18, v26
    v_min_u32 v42, v18, v26
    v_max_u32 v36, v20, v28
    v_min_u32 v44, v20, v28
    v_max_u32 v38, v22, v30
    v_min_u32 v46, v22, v30
    v_max_u32 v16, v32, v36
    v_min_u32 v20, v32, v36
    v_max_u32 v18, v34, v38
    v_min_u32 v22, v34, v38
    v_max_u32 v24, v40, v44
    v_min_u32 v28, v40, v44
    v_max_u32 v26, v42, v46
    v_min_u32 v30, v42, v46
    v_max_u32 v32, v16, v18
    v_min_u32 v34, v16, v18
    v_max_u32 v36, v20, v22
    v_min_u32 v38, v20, v22
    v_max_u32 v40, v24, v26
    v_min_u32 v42, v24, v26
    v_max_u32 v44, v28, v30
    v_min_u32 v46, v28, v30
    s_nop 1
    v_max_u32_dpp v16, v46, v32 quad_perm:[1,0,3,2] row_mask:0xf bank_mask:0xf
    v_max_u32_dpp v18, v44, v34 quad_perm:[1,0,3,2] row_mask:0xf bank_mask:0xf
    v_max_u32_dpp v20, v42, v36 quad_perm:[1,0,3,2] row_mask:0xf bank_mask:0xf
    v_max_u32_dpp v22, v40, v38 quad_perm:[1,0,3,2] row_mask:0xf bank_mask:0xf
    v_max_u32_dpp v24, v38, v40 quad_perm:[1,0,3,2] row_mask:0xf bank_mask:0xf
    v_max_u32_dpp v26, v36, v42 quad_perm:[1,0,3,2] row_mask:0xf bank_mask:0xf
    v_max_u32_dpp v28, v34, v44 quad_perm:[1,0,3,2] row_mask:0xf bank_mask:0xf
    v_max_u32_dpp v30, v32, v46 quad_perm:[1,0,3,2] row_mask:0xf bank_mask:0xf
    v_max_u32 v32, v16, v24
    v_min_u32 v40, v16, v24
    v_max_u32 v34, v18, v26
    v_min_u32 v42, v18, v26
    v_max_u32 v36, v20, v28
    v_min_u32 v44, v20, v28
    v_max_u32 v38, v22, v30
    v_min_u32 v46, v22, v30
    v_max_u32 v16, v32, v36
    v_min_u32 v20, v32, v36
    v_max_u32 v18, v34, v38
    v_min_u32 v22, v34, v38
    v_max_u32 v24, v40, v44
    v_min_u32 v28, v40, v44
    v_max_u32 v26, v42, v46
    v_min_u32 v30, v42, v46
    v_max_u32 v32, v16, v18
    v_min_u32 v34, v16, v18
    v_max_u32 v36, v20, v22
    v_min_u32 v38, v20, v22
    v_max_u32 v40, v24, v26
    v_min_u32 v42, v24, v26
    v_max_u32 v44, v28, v30
    v_min_u32 v46, v28, v30
    s_nop 1
    v_max_u32_dpp v16, v46, v32 quad_perm:[2,3,0,1] row_mask:0xf bank_mask:0xf
    v_max_u32_dpp v18, v44, v34 quad_perm:[2,3,0,1] row_mask:0xf bank_mask:0xf
    v_max_u32_dpp v20, v42, v36 quad_perm:[2,3,0,1] row_mask:0xf bank_mask:0xf
    v_max_u32_dpp v22, v40, v38 quad_perm:[2,3,0,1] row_mask:0xf bank_mask:0xf
    v_max_u32_dpp v24, v38, v40 quad_perm:[2,3,0,1] row_mask:0xf bank_mask:0xf
    v_max_u32_dpp v26, v36, v42 quad_perm:[2,3,0,1] row_mask:0xf bank_mask:0xf
    v_max_u32_dpp v28, v34, v44 quad_perm:[2,3,0,1] row_mask:0xf bank_mask:0xf
    v_max_u32_dpp v30, v32, v46 quad_perm:[2,3,0,1] row_mask:0xf bank_mask:0xf
    v_max_u32 v32, v16, v24
    v_min_u32 v40, v16, v24
    v_max_u32 v34, v18, v26
    v_min_u32 v42, v18, v26
    v_max_u32 v36, v20, v28
    v_min_u32 v44, v20, v28
    v_max_u32 v38, v22, v30
    v_min_u32 v46, v22, v30
    v_max_u32 v16, v32, v36
    v_min_u32 v20, v32, v36
    v_max_u32 v18, v34, v38
    v_min_u32 v22, v34, v38
    v_max_u32 v24, v40, v44
    v_min_u32 v28, v40, v44
    v_max_u32 v26, v42, v46
    v_min_u32 v30, v42, v46
    v_max_u32 v32, v16, v18
    v_min_u32 v34, v16, v18
    v_max_u32 v36, v20, v22
    v_min_u32 v38, v20, v22
    v_max_u32 v40, v24, v26
    v_min_u32 v42, v24, v26
    v_max_u32 v44, v28, v30
    v_min_u32 v46, v28, v30
    s_nop 1
    v_max_u32_dpp v16, v46, v32 row_half_mirror row_mask:0xf bank_mask:0xf
    v_max_u32_dpp v18, v44, v34 row_half_mirror row_mask:0xf bank_mask:0xf
    v_max_u32_dpp v20, v42, v36 row_half_mirror row_mask:0xf bank_mask:0xf
    v_max_u32_dpp v22, v40, v38 row_half_mirror row_mask:0xf bank_mask:0xf
    v_max_u32_dpp v24, v38, v40 row_half_mirror row_mask:0xf bank_mask:0xf
    v_max_u32_dpp v26, v36, v42 row_half_mirror row_mask:0xf bank_mask:0xf
    v_max_u32_dpp v28, v34, v44 row_half_mirror row_mask:0xf bank_mask:0xf
    v_max_u32_dpp v30, v32, v46 row_half_mirror row_mask:0xf bank_mask:0xf
    v_max_u32 v32, v16, v24
    v_min_u32 v40, v16, v24
    v_max_u32 v34, v18, v26
    v_min_u32 v42, v18, v26
    v_max_u32 v36, v20, v28
    v_min_u32 v44, v20, v28
    v_max_u32 v38, v22, v30
    v_min_u32 v46, v22, v30
    v_max_u32 v16, v32, v36
    v_min_u32 v20, v32, v36
    v_max_u32 v18, v34, v38
    v_min_u32 v22, v34, v38
    v_max_u32 v24, v40, v44
    v_min_u32 v28, v40, v44
    v_max_u32 v26, v42, v46
    v_min_u32 v30, v42, v46
    v_max_u32 v32, v16, v18
    v_min_u32 v34, v16, v18
    v_max_u32 v36, v20, v22
    v_min_u32 v38, v20, v22
    v_max_u32 v40, v24, v26
    v_min_u32 v42, v24, v26
    v_max_u32 v44, v28, v30
    v_min_u32 v46, v28, v30
    s_nop 1
    v_max_u32_dpp v16, v46, v32 row_mirror row_mask:0xf bank_mask:0xf
    v_max_u32_dpp v18, v44, v34 row_mirror row_mask:0xf bank_mask:0xf
    v_max_u32_dpp v20, v42, v36 row_mirror row_mask:0xf bank_mask:0xf
    v_max_u32_dpp v22, v40, v38 row_mirror row_mask:0xf bank_mask:0xf
    v_max_u32_dpp v24, v38, v40 row_mirror row_mask:0xf bank_mask:0xf
    v_max_u32_dpp v26, v36, v42 row_mirror row_mask:0xf bank_mask:0xf
    v_max_u32_dpp v28, v34, v44 row_mirror row_mask:0xf bank_mask:0xf
    v_max_u32_dpp v30, v32, v46 row_mirror row_mask:0xf bank_mask:0xf
    v_max_u32 v32, v16, v24
    v_min_u32 v40, v16, v24
    v_max_u32 v34, v18, v26
    v_min_u32 v42, v18, v26
    v_max_u32 v36, v20, v28
    v_min_u32 v44, v20, v28
    v_max_u32 v38, v22, v30
    v_min_u32 v46, v22, v30
    v_max_u32 v16, v32, v36
    v_min_u32 v20, v32, v36
    v_max_u32 v18, v34, v38
    v_min_u32 v22, v34, v38
    v_max_u32 v24, v40, v44
    v_min_u32 v28, v40, v44
    v_max_u32 v26, v42, v46
    v_min_u32 v30, v42, v46
    v_max_u32 v32, v16, v18
    v_min_u32 v34, v16, v18
    v_max_u32 v36, v20, v22
    v_min_u32 v38, v20, v22
    v_max_u32 v40, v24, v26
    v_min_u32 v42, v24, v26
    v_max_u32 v44, v28, v30
    v_min_u32 v46, v28, v30
    v_mov_b32 v16, v32
    v_mov_b32 v18, v34
    v_mov_b32 v20, v36
    v_mov_b32 v22, v38
    v_mov_b32 v24, v40
    v_mov_b32 v26, v42
    v_mov_b32 v28, v44
    v_mov_b32 v30, v46
    v_permlane16_swap_b32 v32, v16
    v_permlane16_swap_b32 v34, v18
    v_permlane16_swap_b32 v36, v20
    v_permlane16_swap_b32 v38, v22
    v_permlane16_swap_b32 v40, v24
    v_permlane16_swap_b32 v42, v26
    v_permlane16_swap_b32 v44, v28
    v_permlane16_swap_b32 v46, v30
    v_max_u32 v48, v32, v30
    v_max_u32 v50, v34, v28
    v_max_u32 v52, v36, v26
    v_max_u32 v54, v38, v24
    v_max_u32 v56, v40, v22
    v_max_u32 v58, v42, v20
    v_max_u32 v60, v44, v18
    v_max_u32 v62, v46, v16
    v_max_u32 v32, v48, v56
    v_min_u32 v40, v48, v56
    v_max_u32 v34, v50, v58
    v_min_u32 v42, v50, v58
    v_max_u32 v36, v52, v60
    v_min_u32 v44, v52, v60
    v_max_u32 v38, v54, v62
    v_min_u32 v46, v54, v62
    v_max_u32 v48, v32, v36
    v_min_u32 v52, v32, v36
    v_max_u32 v50, v34, v38
    v_min_u32 v54, v34, v38
    v_max_u32 v56, v40, v44
    v_min_u32 v60, v40, v44
    v_max_u32 v58, v42, v46
    v_min_u32 v62, v42, v46
    v_max_u32 v32, v48, v50
    v_min_u32 v34, v48, v50
    v_max_u32 v36, v52, v54
    v_min_u32 v38, v52, v54
    v_max_u32 v40, v56, v58
    v_min_u32 v42, v56, v58
    v_max_u32 v44, v60, v62
    v_min_u32 v46, v60, v62
    v_mov_b32 v16, v32
    v_mov_b32 v18, v34
    v_mov_b32 v20, v36
    v_mov_b32 v22, v38
    v_mov_b32 v24, v40
    v_mov_b32 v26, v42
    v_mov_b32 v28, v44
    v_mov_b32 v30, v46
    v_permlane32_swap_b32 v32, v16
    v_permlane32_swap_b32 v34, v18
    v_permlane32_swap_b32 v36, v20
    v_permlane32_swap_b32 v38, v22
    v_permlane32_swap_b32 v40, v24
    v_permlane32_swap_b32 v42, v26
    v_permlane32_swap_b32 v44, v28
    v_permlane32_swap_b32 v46, v30
    v_max_u32 v48, v32, v30
    v_max_u32 v50, v34, v28
    v_max_u32 v52, v36, v26
    v_max_u32 v54, v38, v24
    v_max_u32 v56, v40, v22
    v_max_u32 v58, v42, v20
    v_max_u32 v60, v44, v18
    v_max_u32 v62, v46, v16
    s_nop 1
recurrent_scan__sliding_block__moe_arch_mod__prompt_kernel_seld:
    v_cndmask_b32_e64 v48, v48, v50, s[46:47]
    v_cndmask_b32_e64 v48, v48, v52, s[48:49]
    v_cndmask_b32_e64 v48, v48, v54, s[50:51]
    v_cndmask_b32_e64 v48, v48, v56, s[52:53]
    v_cndmask_b32_e64 v48, v48, v58, s[54:55]
    v_cndmask_b32_e64 v48, v48, v60, s[56:57]
    v_cndmask_b32_e64 v48, v48, v62, s[58:59]
    v_and_b32 v10, 2047, v48
    v_sub_u32 v10, 2047, v10
    v_ashrrev_i32 v11, 31, v48
    v_not_b32 v11, v11
    v_or_b32 v11, 0x80000000, v11
    v_xor_b32 v11, v11, v48
    v_cvt_pk_bf16_f32 v11, v11, v11
    v_and_b32 v11, 0xffff0000, v11
    v_mul_f32 v11, 0xbfb8aa3b, v11
    v_exp_f32 v11, v11
    v_and_b32 v13, 7, v0
    v_lshlrev_b32 v13, 3, v13
    v_add_f32 v11, 1.0, v11
    v_rcp_f32 v11, v11
    v_lshrrev_b32 v12, 3, v0
    v_lshl_add_u32 v13, v12, 7, v13
    s_mov_b32 s33, 7700480
    v_cvt_pk_bf16_f32 v11, v11, v11
    v_and_b32 v11, 0xffff0000, v11
    v_or_b32 v10, v10, v11
    v_mov_b32 v11, s29
    buffer_store_dwordx2 v[10:11], v13, s[40:43], s33 offen sc1
    buffer_store_dwordx2 v[10:11], v13, s[40:43], s33 offen offset:1024 sc1
    buffer_store_dwordx2 v[10:11], v13, s[40:43], s33 offen offset:2048 sc1
    buffer_store_dwordx2 v[10:11], v13, s[40:43], s33 offen offset:3072 sc1
    v_mov_b32 v12, 0
    s_mov_b64 exec, 1
    global_store_dword v12, v12, s[22:23] sc1
    global_store_dword v12, v12, s[22:23] offset:128 sc1
    s_mov_b64 exec, -1
    s_setprio 0
recurrent_scan__sliding_block__moe_arch_mod__prompt_kernel_s1:
    s_mov_b32 s44, s14
    s_mov_b32 s45, s15
    s_mov_b32 s46, 0x1c0000
    s_mov_b32 s47, 0x00020000
    s_mov_b32 s48, s16
    s_mov_b32 s49, s17
    s_mov_b32 s50, 0x1c0000
    s_mov_b32 s51, 0x00020000
    s_mov_b32 s52, s4
    s_mov_b32 s53, s5
    s_mov_b32 s54, 0x200000
    s_mov_b32 s55, 0x00020000
    s_lshr_b32 s35, s2, 3
    v_lshrrev_b32 v209, 2, v0
    v_lshlrev_b32 v209, 10, v209
    v_and_b32 v7, 3, v0
    v_lshl_add_u32 v209, v7, 7, v209
    s_lshl_b32 s34, s35, 14
    s_and_b32 s36, s2, 1
    s_lshl_b32 s36, s36, 9
    s_add_u32 s34, s34, s36
    v_add_u32 v209, s34, v209
    s_cmp_gt_u32 s26, 3
    s_subb_u32 s35, s26, 0
    s_mul_i32 s3, s27, 7
    s_add_u32 s35, s35, s3
    s_lshr_b32 s34, s35, 2
    s_lshl_b32 s34, s34, 15
    s_and_b32 s33, s35, 3
    s_lshl_b32 s33, s33, 8
    s_add_u32 s34, s34, s33
    v_lshrrev_b32 v208, 1, v0
    v_lshlrev_b32 v208, 10, v208
    v_and_b32 v7, 1, v0
    v_lshl_add_u32 v208, v7, 7, v208
    v_add_u32 v208, s34, v208
    s_and_b32 s33, s35, 7
    s_lshr_b32 s35, s35, 3
    s_mul_i32 s34, s33, 229376
    s_lshl_b32 s35, s35, 7
    s_add_u32 s34, s34, s35
    v_mul_u32_u24 v211, 3584, v0
    v_add_u32 v211, s34, v211
    v_and_b32 v6, 7, v0
    v_lshlrev_b32 v6, 3, v6
    s_and_b32 s37, s2, 31
    s_lshl_b32 s37, s37, 7
    s_add_u32 s37, s37, 7700480
    v_mov_b32 v212, 1
    s_cmp_eq_u32 s26, 3
    s_nop 0
    s_cbranch_scc0 recurrent_scan__sliding_block__moe_arch_mod__prompt_kernel_s1u
    ds_write_b32 v1, v212 offset:168
    s_mov_b32 s3, 0x10000
wl_16:
    ds_read_b128 v[216:219], v1 offset:16
    s_waitcnt lgkmcnt(0)
    v_min_u32 v216, v216, v217
    v_min3_u32 v216, v216, v218, v219
    s_nop 0
    v_readfirstlane_b32 s30, v216
    s_cmp_ge_u32 s30, 9
    s_nop 3
    s_cbranch_scc1 wl_16d
    s_sleep 2
    s_sub_u32 s3, s3, 1
    s_cbranch_scc0 wl_16
wl_16d:
    s_mov_b32 s3, 0x8000
sp_17:
    buffer_load_dwordx2 v[4:5], v6, s[40:43], s37 offen sc1
    s_waitcnt vmcnt(0)
    v_cmp_ne_u32 vcc, s29, v5
    s_nop 4
    s_cbranch_vccz sp_17d
    s_sleep 4
    s_sub_u32 s3, s3, 1
    s_cbranch_scc0 sp_17
sp_17d:
    v_lshrrev_b32 v3, 1, v6
    v_add_u32 v3, v3, v1
    ds_write_b32 v3, v4 offset:320
    v_bfe_u32 v5, v4, 6, 5
    v_cmp_eq_u32 vcc, s27, v5
    s_and_b32 s36, vcc_lo, 0xff
    s_lshl_b32 s36, s36, 1
    s_or_b32 s36, s36, 1
    v_mov_b32 v5, s36
    ds_write_b32 v1, v5 offset:112
    s_nop 0
    s_branch recurrent_scan__sliding_block__moe_arch_mod__prompt_kernel_sv
recurrent_scan__sliding_block__moe_arch_mod__prompt_kernel_s1u:
    v_lshrrev_b32 v7, 4, v0
    v_mul_u32_u24 v8, 28672, v7
    v_lshl_add_u32 v8, v6, 1, v8
    v_add_u32 v8, s34, v8
    s_lshl_b32 s33, s33, 7
    v_lshlrev_b32 v9, 4, v7
    v_and_b32 v10, 1, v7
    v_lshlrev_b32 v10, 11, v10
    v_bfe_u32 v11, v0, 3, 1
    v_lshl_add_u32 v10, v11, 10, v10
    v_lshrrev_b32 v11, 5, v0
    v_lshl_add_u32 v10, v11, 7, v10
    v_lshl_add_u32 v10, v6, 1, v10
    s_cmp_gt_u32 s26, 3
    s_subb_u32 s38, s26, 0
    s_mul_i32 s3, s27, 7
    s_add_u32 s38, s38, s3
    s_lshl_b32 s38, s38, 12
    s_add_u32 s38, s38, 9437184
    s_mov_b32 s10, 0x00ff00ff
    s_mov_b32 s11, 0x00ff00ff
    s_mov_b32 s34, 0x05040100
    s_mov_b32 s35, 0x07060302
    v_mov_b32 v193, s29
    v_mov_b32 v195, s29
    v_mov_b32 v197, s29
    v_mov_b32 v199, s29
    v_mov_b32 v201, s29
    v_mov_b32 v203, s29
    v_mov_b32 v205, s29
    v_mov_b32 v207, s29
    ds_write_b32 v1, v212 offset:168
    s_waitcnt vmcnt(0)
    buffer_load_dwordx2 v[4:5], v6, s[40:43], s37 offen sc1
    s_mov_b64 exec, s[10:11]
    s_mov_b32 s36, 0
    buffer_load_dwordx4 v[16:19], v8, s[44:47], s36 offen
    s_mov_b32 s36, 3584
    buffer_load_dwordx4 v[20:23], v8, s[44:47], s36 offen
    s_mov_b32 s36, 7168
    buffer_load_dwordx4 v[24:27], v8, s[44:47], s36 offen
    s_mov_b32 s36, 10752
    buffer_load_dwordx4 v[28:31], v8, s[44:47], s36 offen
    s_mov_b32 s36, 14336
    buffer_load_dwordx4 v[32:35], v8, s[44:47], s36 offen
    s_mov_b32 s36, 17920
    buffer_load_dwordx4 v[36:39], v8, s[44:47], s36 offen
    s_mov_b32 s36, 21504
    buffer_load_dwordx4 v[40:43], v8, s[44:47], s36 offen
    s_mov_b32 s36, 25088
    buffer_load_dwordx4 v[44:47], v8, s[44:47], s36 offen
    s_mov_b32 s36, 114688
    buffer_load_dwordx4 v[48:51], v8, s[44:47], s36 offen
    s_mov_b32 s36, 118272
    buffer_load_dwordx4 v[52:55], v8, s[44:47], s36 offen
    s_mov_b32 s36, 121856
    buffer_load_dwordx4 v[56:59], v8, s[44:47], s36 offen
    s_mov_b32 s36, 125440
    buffer_load_dwordx4 v[60:63], v8, s[44:47], s36 offen
    s_mov_b32 s36, 129024
    buffer_load_dwordx4 v[64:67], v8, s[44:47], s36 offen
    s_mov_b32 s36, 132608
    buffer_load_dwordx4 v[68:71], v8, s[44:47], s36 offen
    s_mov_b32 s36, 136192
    buffer_load_dwordx4 v[72:75], v8, s[44:47], s36 offen
    s_mov_b32 s36, 139776
    buffer_load_dwordx4 v[76:79], v8, s[44:47], s36 offen
    s_not_b64 exec, s[10:11]
    s_mov_b32 s36, 0
    buffer_load_dwordx4 v[16:19], v8, s[48:51], s36 offen
    s_mov_b32 s36, 3584
    buffer_load_dwordx4 v[20:23], v8, s[48:51], s36 offen
    s_mov_b32 s36, 7168
    buffer_load_dwordx4 v[24:27], v8, s[48:51], s36 offen
    s_mov_b32 s36, 10752
    buffer_load_dwordx4 v[28:31], v8, s[48:51], s36 offen
    s_mov_b32 s36, 14336
    buffer_load_dwordx4 v[32:35], v8, s[48:51], s36 offen
    s_mov_b32 s36, 17920
    buffer_load_dwordx4 v[36:39], v8, s[48:51], s36 offen
    s_mov_b32 s36, 21504
    buffer_load_dwordx4 v[40:43], v8, s[48:51], s36 offen
    s_mov_b32 s36, 25088
    buffer_load_dwordx4 v[44:47], v8, s[48:51], s36 offen
    s_mov_b32 s36, 114688
    buffer_load_dwordx4 v[48:51], v8, s[48:51], s36 offen
    s_mov_b32 s36, 118272
    buffer_load_dwordx4 v[52:55], v8, s[48:51], s36 offen
    s_mov_b32 s36, 121856
    buffer_load_dwordx4 v[56:59], v8, s[48:51], s36 offen
    s_mov_b32 s36, 125440
    buffer_load_dwordx4 v[60:63], v8, s[48:51], s36 offen
    s_mov_b32 s36, 129024
    buffer_load_dwordx4 v[64:67], v8, s[48:51], s36 offen
    s_mov_b32 s36, 132608
    buffer_load_dwordx4 v[68:71], v8, s[48:51], s36 offen
    s_mov_b32 s36, 136192
    buffer_load_dwordx4 v[72:75], v8, s[48:51], s36 offen
    s_mov_b32 s36, 139776
    buffer_load_dwordx4 v[76:79], v8, s[48:51], s36 offen
    s_mov_b64 exec, -1
    s_waitcnt vmcnt(32)
    v_cmp_ne_u32 vcc, s29, v5
    s_nop 4
    s_cbranch_vccnz recurrent_scan__sliding_block__moe_arch_mod__prompt_kernel_s1n
    s_setprio 3
    v_and_b32 v12, 2047, v4
    v_lshlrev_b32 v13, 3, v12
    v_lshl_add_u32 v12, v12, 10, v9
    s_mov_b32 s36, 7684096
    buffer_load_dwordx4 v[144:147], v12, s[52:55], s33 offen
    buffer_load_dwordx4 v[148:151], v12, s[52:55], s33 offen offset:64
    buffer_load_dwordx2 v[14:15], v13, s[40:43], s36 offen sc1
    v_lshrrev_b32 v3, 1, v6
    v_add_u32 v3, v3, v1
    ds_write_b32 v3, v4 offset:320
    v_bfe_u32 v5, v4, 6, 5
    v_cmp_eq_u32 vcc, s27, v5
    s_and_b32 s36, vcc_lo, 0xff
    s_lshl_b32 s36, s36, 1
    s_or_b32 s36, s36, 1
    v_mov_b32 v5, s36
    ds_write_b32 v1, v5 offset:112
    s_waitcnt vmcnt(11)
    v_perm_b32 v80, v20, v16, s34
    v_perm_b32 v81, v28, v24, s34
    v_perm_b32 v82, v36, v32, s34
    v_perm_b32 v83, v44, v40, s34
    v_perm_b32 v84, v20, v16, s35
    v_perm_b32 v85, v28, v24, s35
    v_perm_b32 v86, v36, v32, s35
    v_perm_b32 v87, v44, v40, s35
    v_perm_b32 v88, v21, v17, s34
    v_perm_b32 v89, v29, v25, s34
    v_perm_b32 v90, v37, v33, s34
    v_perm_b32 v91, v45, v41, s34
    v_perm_b32 v92, v21, v17, s35
    v_perm_b32 v93, v29, v25, s35
    v_perm_b32 v94, v37, v33, s35
    v_perm_b32 v95, v45, v41, s35
    v_perm_b32 v96, v22, v18, s34
    v_perm_b32 v97, v30, v26, s34
    v_perm_b32 v98, v38, v34, s34
    v_perm_b32 v99, v46, v42, s34
    v_perm_b32 v100, v22, v18, s35
    v_perm_b32 v101, v30, v26, s35
    v_perm_b32 v102, v38, v34, s35
    v_perm_b32 v103, v46, v42, s35
    v_perm_b32 v104, v23, v19, s34
    v_perm_b32 v105, v31, v27, s34
    v_perm_b32 v106, v39, v35, s34
    v_perm_b32 v107, v47, v43, s34
    v_perm_b32 v108, v23, v19, s35
    v_perm_b32 v109, v31, v27, s35
    v_perm_b32 v110, v39, v35, s35
    v_perm_b32 v111, v47, v43, s35
    s_mov_b32 s56, s18
    s_mov_b32 s57, s19
    s_mov_b32 s58, 0x1c0000
    s_mov_b32 s59, 0x00020000
    s_cmp_gt_u32 s26, 3
    s_subb_u32 s30, s26, 0
    s_mul_i32 s3, s27, 7
    s_add_u32 s30, s30, s3
    s_lshr_b32 s31, s30, 2
    s_and_b32 s30, s30, 3
    v_and_b32 v11, 15, v0
    v_lshlrev_b32 v11, 4, v11
    v_lshl_add_u32 v11, v7, 11, v11
    s_lshl_b32 s31, s31, 15
    s_lshl_b32 s30, s30, 8
    s_add_u32 s30, s30, s31
    v_add_u32 v11, s30, v11
    s_mov_b32 s30, 0
    buffer_load_dwordx4 v[16:19], v11, s[56:59], s30 offen offset:0
    s_mov_b32 s30, 8192
    buffer_load_dwordx4 v[20:23], v11, s[56:59], s30 offen offset:0
    s_mov_b32 s30, 16384
    buffer_load_dwordx4 v[24:27], v11, s[56:59], s30 offen offset:0
    s_mov_b32 s30, 24576
    buffer_load_dwordx4 v[28:31], v11, s[56:59], s30 offen offset:0
    s_mov_b32 s30, 0
    buffer_load_dwordx4 v[32:35], v11, s[56:59], s30 offen offset:1024
    s_mov_b32 s30, 8192
    buffer_load_dwordx4 v[36:39], v11, s[56:59], s30 offen offset:1024
    s_mov_b32 s30, 16384
    buffer_load_dwordx4 v[40:43], v11, s[56:59], s30 offen offset:1024
    s_mov_b32 s30, 24576
    buffer_load_dwordx4 v[44:47], v11, s[56:59], s30 offen offset:1024
    s_waitcnt vmcnt(11)
    v_perm_b32 v112, v52, v48, s34
    v_perm_b32 v113, v60, v56, s34
    v_perm_b32 v114, v68, v64, s34
    v_perm_b32 v115, v76, v72, s34
    v_perm_b32 v116, v52, v48, s35
    v_perm_b32 v117, v60, v56, s35
    v_perm_b32 v118, v68, v64, s35
    v_perm_b32 v119, v76, v72, s35
    v_perm_b32 v120, v53, v49, s34
    v_perm_b32 v121, v61, v57, s34
    v_perm_b32 v122, v69, v65, s34
    v_perm_b32 v123, v77, v73, s34
    v_perm_b32 v124, v53, v49, s35
    v_perm_b32 v125, v61, v57, s35
    v_perm_b32 v126, v69, v65, s35
    v_perm_b32 v127, v77, v73, s35
    v_perm_b32 v128, v54, v50, s34
    v_perm_b32 v129, v62, v58, s34
    v_perm_b32 v130, v70, v66, s34
    v_perm_b32 v131, v78, v74, s34
    v_perm_b32 v132, v54, v50, s35
    v_perm_b32 v133, v62, v58, s35
    v_perm_b32 v134, v70, v66, s35
    v_perm_b32 v135, v78, v74, s35
    v_perm_b32 v136, v55, v51, s34
    v_perm_b32 v137, v63, v59, s34
    v_perm_b32 v138, v71, v67, s34
    v_perm_b32 v139, v79, v75, s34
    v_perm_b32 v140, v55, v51, s35
    v_perm_b32 v141, v63, v59, s35
    v_perm_b32 v142, v71, v67, s35
    v_perm_b32 v143, v79, v75, s35
    s_nop 1
    s_branch recurrent_scan__sliding_block__moe_arch_mod__prompt_kernel_s1x
recurrent_scan__sliding_block__moe_arch_mod__prompt_kernel_s1n:
    buffer_load_dwordx2 v[4:5], v6, s[40:43], s37 offen sc1
    s_waitcnt vmcnt(9)
    v_perm_b32 v80, v20, v16, s34
    v_perm_b32 v81, v28, v24, s34
    v_perm_b32 v82, v36, v32, s34
    v_perm_b32 v83, v44, v40, s34
    v_perm_b32 v84, v20, v16, s35
    v_perm_b32 v85, v28, v24, s35
    v_perm_b32 v86, v36, v32, s35
    v_perm_b32 v87, v44, v40, s35
    v_perm_b32 v88, v21, v17, s34
    v_perm_b32 v89, v29, v25, s34
    v_perm_b32 v90, v37, v33, s34
    v_perm_b32 v91, v45, v41, s34
    v_perm_b32 v92, v21, v17, s35
    v_perm_b32 v93, v29, v25, s35
    v_perm_b32 v94, v37, v33, s35
    v_perm_b32 v95, v45, v41, s35
    v_perm_b32 v96, v22, v18, s34
    v_perm_b32 v97, v30, v26, s34
    v_perm_b32 v98, v38, v34, s34
    v_perm_b32 v99, v46, v42, s34
    v_perm_b32 v100, v22, v18, s35
    v_perm_b32 v101, v30, v26, s35
    v_perm_b32 v102, v38, v34, s35
    v_perm_b32 v103, v46, v42, s35
    v_perm_b32 v104, v23, v19, s34
    v_perm_b32 v105, v31, v27, s34
    v_perm_b32 v106, v39, v35, s34
    v_perm_b32 v107, v47, v43, s34
    v_perm_b32 v108, v23, v19, s35
    v_perm_b32 v109, v31, v27, s35
    v_perm_b32 v110, v39, v35, s35
    v_perm_b32 v111, v47, v43, s35
    s_mov_b32 s56, s18
    s_mov_b32 s57, s19
    s_mov_b32 s58, 0x1c0000
    s_mov_b32 s59, 0x00020000
    s_cmp_gt_u32 s26, 3
    s_subb_u32 s30, s26, 0
    s_mul_i32 s3, s27, 7
    s_add_u32 s30, s30, s3
    s_lshr_b32 s31, s30, 2
    s_and_b32 s30, s30, 3
    v_and_b32 v11, 15, v0
    v_lshlrev_b32 v11, 4, v11
    v_lshl_add_u32 v11, v7, 11, v11
    s_lshl_b32 s31, s31, 15
    s_lshl_b32 s30, s30, 8
    s_add_u32 s30, s30, s31
    v_add_u32 v11, s30, v11
    s_mov_b32 s30, 0
    buffer_load_dwordx4 v[16:19], v11, s[56:59], s30 offen offset:0
    s_mov_b32 s30, 8192
    buffer_load_dwordx4 v[20:23], v11, s[56:59], s30 offen offset:0
    s_mov_b32 s30, 16384
    buffer_load_dwordx4 v[24:27], v11, s[56:59], s30 offen offset:0
    s_mov_b32 s30, 24576
    buffer_load_dwordx4 v[28:31], v11, s[56:59], s30 offen offset:0
    s_mov_b32 s30, 0
    buffer_load_dwordx4 v[32:35], v11, s[56:59], s30 offen offset:1024
    s_mov_b32 s30, 8192
    buffer_load_dwordx4 v[36:39], v11, s[56:59], s30 offen offset:1024
    s_mov_b32 s30, 16384
    buffer_load_dwordx4 v[40:43], v11, s[56:59], s30 offen offset:1024
    s_mov_b32 s30, 24576
    buffer_load_dwordx4 v[44:47], v11, s[56:59], s30 offen offset:1024
    s_waitcnt vmcnt(9)
    v_perm_b32 v112, v52, v48, s34
    v_perm_b32 v113, v60, v56, s34
    v_perm_b32 v114, v68, v64, s34
    v_perm_b32 v115, v76, v72, s34
    v_perm_b32 v116, v52, v48, s35
    v_perm_b32 v117, v60, v56, s35
    v_perm_b32 v118, v68, v64, s35
    v_perm_b32 v119, v76, v72, s35
    v_perm_b32 v120, v53, v49, s34
    v_perm_b32 v121, v61, v57, s34
    v_perm_b32 v122, v69, v65, s34
    v_perm_b32 v123, v77, v73, s34
    v_perm_b32 v124, v53, v49, s35
    v_perm_b32 v125, v61, v57, s35
    v_perm_b32 v126, v69, v65, s35
    v_perm_b32 v127, v77, v73, s35
    v_perm_b32 v128, v54, v50, s34
    v_perm_b32 v129, v62, v58, s34
    v_perm_b32 v130, v70, v66, s34
    v_perm_b32 v131, v78, v74, s34
    v_perm_b32 v132, v54, v50, s35
    v_perm_b32 v133, v62, v58, s35
    v_perm_b32 v134, v70, v66, s35
    v_perm_b32 v135, v78, v74, s35
    v_perm_b32 v136, v55, v51, s34
    v_perm_b32 v137, v63, v59, s34
    v_perm_b32 v138, v71, v67, s34
    v_perm_b32 v139, v79, v75, s34
    v_perm_b32 v140, v55, v51, s35
    v_perm_b32 v141, v63, v59, s35
    v_perm_b32 v142, v71, v67, s35
    v_perm_b32 v143, v79, v75, s35
    s_waitcnt vmcnt(8)
    v_cmp_ne_u32 vcc, s29, v5
    s_nop 4
    s_cbranch_vccz recurrent_scan__sliding_block__moe_arch_mod__prompt_kernel_s1y
    s_mov_b32 s3, 0x8000
sp_18:
    buffer_load_dwordx2 v[4:5], v6, s[40:43], s37 offen sc1
    s_waitcnt vmcnt(0)
    v_cmp_ne_u32 vcc, s29, v5
    s_nop 4
    s_cbranch_vccz sp_18d
    s_sleep 4
    s_sub_u32 s3, s3, 1
    s_cbranch_scc0 sp_18
sp_18d:
recurrent_scan__sliding_block__moe_arch_mod__prompt_kernel_s1y:
    s_setprio 3
    v_and_b32 v12, 2047, v4
    v_lshlrev_b32 v13, 3, v12
    v_lshl_add_u32 v12, v12, 10, v9
    s_mov_b32 s36, 7684096
    buffer_load_dwordx4 v[144:147], v12, s[52:55], s33 offen
    buffer_load_dwordx4 v[148:151], v12, s[52:55], s33 offen offset:64
    buffer_load_dwordx2 v[14:15], v13, s[40:43], s36 offen sc1
    v_lshrrev_b32 v3, 1, v6
    v_add_u32 v3, v3, v1
    ds_write_b32 v3, v4 offset:320
    v_bfe_u32 v5, v4, 6, 5
    v_cmp_eq_u32 vcc, s27, v5
    s_and_b32 s36, vcc_lo, 0xff
    s_lshl_b32 s36, s36, 1
    s_or_b32 s36, s36, 1
    v_mov_b32 v5, s36
    ds_write_b32 v1, v5 offset:112
    s_nop 0
recurrent_scan__sliding_block__moe_arch_mod__prompt_kernel_s1x:
    s_waitcnt vmcnt(0)
    s_mov_b32 s3, 0x8000
    s_mov_b32 s36, 7684096
kb_19:
    v_cmp_ne_u32 vcc, s29, v15
    s_nop 4
    s_cbranch_vccz kb_19d
    buffer_load_dwordx2 v[14:15], v13, s[40:43], s36 offen sc1
    s_waitcnt vmcnt(0)
    s_sub_u32 s3, s3, 1
    s_cbranch_scc0 kb_19
kb_19d:
    v_lshlrev_b32 v15, 16, v14
    v_rcp_f32 v15, v15
    v_and_b32 v14, 0xffff0000, v14
    v_lshlrev_b32 v176, 16, v144
    v_and_b32 v177, 0xffff0000, v144
    v_add_f32 v176, v176, v14
    v_add_f32 v177, v177, v14
    v_cvt_pk_bf16_f32 v178, v176, v177
    v_lshlrev_b32 v176, 16, v178
    v_and_b32 v177, 0xffff0000, v178
    v_mul_f32 v176, v176, v15
    v_mul_f32 v177, v177, v15
    v_cvt_pk_bf16_f32 v178, v176, v177
    v_cndmask_b32_e64 v160, 0, v178, s[10:11]
    v_cndmask_b32_e64 v168, v178, 0, s[10:11]
    v_lshlrev_b32 v176, 16, v145
    v_and_b32 v177, 0xffff0000, v145
    v_add_f32 v176, v176, v14
    v_add_f32 v177, v177, v14
    v_cvt_pk_bf16_f32 v178, v176, v177
    v_lshlrev_b32 v176, 16, v178
    v_and_b32 v177, 0xffff0000, v178
    v_mul_f32 v176, v176, v15
    v_mul_f32 v177, v177, v15
    v_cvt_pk_bf16_f32 v178, v176, v177
    v_cndmask_b32_e64 v161, 0, v178, s[10:11]
    v_cndmask_b32_e64 v169, v178, 0, s[10:11]
    v_lshlrev_b32 v176, 16, v146
    v_and_b32 v177, 0xffff0000, v146
    v_add_f32 v176, v176, v14
    v_add_f32 v177, v177, v14
    v_cvt_pk_bf16_f32 v178, v176, v177
    v_lshlrev_b32 v176, 16, v178
    v_and_b32 v177, 0xffff0000, v178
    v_mul_f32 v176, v176, v15
    v_mul_f32 v177, v177, v15
    v_cvt_pk_bf16_f32 v178, v176, v177
    v_cndmask_b32_e64 v162, 0, v178, s[10:11]
    v_cndmask_b32_e64 v170, v178, 0, s[10:11]
    v_lshlrev_b32 v176, 16, v147
    v_and_b32 v177, 0xffff0000, v147
    v_add_f32 v176, v176, v14
    v_add_f32 v177, v177, v14
    v_cvt_pk_bf16_f32 v178, v176, v177
    v_lshlrev_b32 v176, 16, v178
    v_and_b32 v177, 0xffff0000, v178
    v_mul_f32 v176, v176, v15
    v_mul_f32 v177, v177, v15
    v_cvt_pk_bf16_f32 v178, v176, v177
    v_cndmask_b32_e64 v163, 0, v178, s[10:11]
    v_cndmask_b32_e64 v171, v178, 0, s[10:11]
    v_lshlrev_b32 v176, 16, v148
    v_and_b32 v177, 0xffff0000, v148
    v_add_f32 v176, v176, v14
    v_add_f32 v177, v177, v14
    v_cvt_pk_bf16_f32 v178, v176, v177
    v_lshlrev_b32 v176, 16, v178
    v_and_b32 v177, 0xffff0000, v178
    v_mul_f32 v176, v176, v15
    v_mul_f32 v177, v177, v15
    v_cvt_pk_bf16_f32 v178, v176, v177
    v_cndmask_b32_e64 v164, 0, v178, s[10:11]
    v_cndmask_b32_e64 v172, v178, 0, s[10:11]
    v_lshlrev_b32 v176, 16, v149
    v_and_b32 v177, 0xffff0000, v149
    v_add_f32 v176, v176, v14
    v_add_f32 v177, v177, v14
    v_cvt_pk_bf16_f32 v178, v176, v177
    v_lshlrev_b32 v176, 16, v178
    v_and_b32 v177, 0xffff0000, v178
    v_mul_f32 v176, v176, v15
    v_mul_f32 v177, v177, v15
    v_cvt_pk_bf16_f32 v178, v176, v177
    v_cndmask_b32_e64 v165, 0, v178, s[10:11]
    v_cndmask_b32_e64 v173, v178, 0, s[10:11]
    v_lshlrev_b32 v176, 16, v150
    v_and_b32 v177, 0xffff0000, v150
    v_add_f32 v176, v176, v14
    v_add_f32 v177, v177, v14
    v_cvt_pk_bf16_f32 v178, v176, v177
    v_lshlrev_b32 v176, 16, v178
    v_and_b32 v177, 0xffff0000, v178
    v_mul_f32 v176, v176, v15
    v_mul_f32 v177, v177, v15
    v_cvt_pk_bf16_f32 v178, v176, v177
    v_cndmask_b32_e64 v166, 0, v178, s[10:11]
    v_cndmask_b32_e64 v174, v178, 0, s[10:11]
    v_lshlrev_b32 v176, 16, v151
    v_and_b32 v177, 0xffff0000, v151
    v_add_f32 v176, v176, v14
    v_add_f32 v177, v177, v14
    v_cvt_pk_bf16_f32 v178, v176, v177
    v_lshlrev_b32 v176, 16, v178
    v_and_b32 v177, 0xffff0000, v178
    v_mul_f32 v176, v176, v15
    v_mul_f32 v177, v177, v15
    v_cvt_pk_bf16_f32 v178, v176, v177
    v_cndmask_b32_e64 v167, 0, v178, s[10:11]
    v_cndmask_b32_e64 v175, v178, 0, s[10:11]
    v_mfma_f32_16x16x32_bf16 v[176:179], v[80:83], v[160:163], 0
    v_mfma_f32_16x16x32_bf16 v[180:183], v[88:91], v[160:163], 0
    v_mfma_f32_16x16x32_bf16 v[184:187], v[96:99], v[160:163], 0
    v_mfma_f32_16x16x32_bf16 v[188:191], v[104:107], v[160:163], 0
    v_mfma_f32_16x16x32_bf16 v[176:179], v[84:87], v[168:171], v[176:179]
    v_mfma_f32_16x16x32_bf16 v[180:183], v[92:95], v[168:171], v[180:183]
    v_mfma_f32_16x16x32_bf16 v[184:187], v[100:103], v[168:171], v[184:187]
    v_mfma_f32_16x16x32_bf16 v[188:191], v[108:111], v[168:171], v[188:191]
    v_mfma_f32_16x16x32_bf16 v[176:179], v[112:115], v[164:167], v[176:179]
    v_mfma_f32_16x16x32_bf16 v[180:183], v[120:123], v[164:167], v[180:183]
    v_mfma_f32_16x16x32_bf16 v[184:187], v[128:131], v[164:167], v[184:187]
    v_mfma_f32_16x16x32_bf16 v[188:191], v[136:139], v[164:167], v[188:191]
    v_mfma_f32_16x16x32_bf16 v[176:179], v[116:119], v[172:175], v[176:179]
    v_mfma_f32_16x16x32_bf16 v[180:183], v[124:127], v[172:175], v[180:183]
    v_mfma_f32_16x16x32_bf16 v[184:187], v[132:135], v[172:175], v[184:187]
    v_mfma_f32_16x16x32_bf16 v[188:191], v[140:143], v[172:175], v[188:191]
    s_nop 4
    v_cvt_pk_bf16_f32 v192, v176, v177
    v_cvt_pk_bf16_f32 v194, v178, v179
    buffer_store_dwordx4 v[192:195], v10, s[40:43], s38 offen offset:0 sc1
    v_cvt_pk_bf16_f32 v196, v180, v181
    v_cvt_pk_bf16_f32 v198, v182, v183
    buffer_store_dwordx4 v[196:199], v10, s[40:43], s38 offen offset:256 sc1
    v_cvt_pk_bf16_f32 v200, v184, v185
    v_cvt_pk_bf16_f32 v202, v186, v187
    buffer_store_dwordx4 v[200:203], v10, s[40:43], s38 offen offset:512 sc1
    v_cvt_pk_bf16_f32 v204, v188, v189
    v_cvt_pk_bf16_f32 v206, v190, v191
    buffer_store_dwordx4 v[204:207], v10, s[40:43], s38 offen offset:768 sc1
    s_setprio 0
    s_nop 0
    s_branch recurrent_scan__sliding_block__moe_arch_mod__prompt_kernel_s2
recurrent_scan__sliding_block__moe_arch_mod__prompt_kernel_fw:
    v_min_u32 v6, 4, v0
    v_lshlrev_b32 v6, 21, v6
    v_add_u32 v6, 2097024, v6
    v_mov_b32 v7, 0
    s_mov_b64 exec, 31
    buffer_load_dword v210, v6, s[40:43], 0 offen
    s_mov_b64 exec, 1
    global_load_dword v210, v7, s[14:15]
    global_load_dword v210, v7, s[16:17]
    global_load_dword v210, v7, s[18:19]
    global_load_dword v210, v7, s[8:9]
    global_load_dword v210, v7, s[20:21]
    s_mov_b64 exec, -1
tl_20:
    s_lshr_b32 s35, s2, 3
    v_lshrrev_b32 v209, 2, v0
    v_lshlrev_b32 v209, 10, v209
    v_and_b32 v7, 3, v0
    v_lshl_add_u32 v209, v7, 7, v209
    s_lshl_b32 s34, s35, 14
    s_and_b32 s36, s2, 1
    s_lshl_b32 s36, s36, 9
    s_add_u32 s34, s34, s36
    v_add_u32 v209, s34, v209
    s_cmp_gt_u32 s26, 3
    s_subb_u32 s35, s26, 0
    s_mul_i32 s3, s27, 7
    s_add_u32 s35, s35, s3
    s_lshr_b32 s34, s35, 2
    s_lshl_b32 s34, s34, 15
    s_and_b32 s33, s35, 3
    s_lshl_b32 s33, s33, 8
    s_add_u32 s34, s34, s33
    v_lshrrev_b32 v208, 1, v0
    v_lshlrev_b32 v208, 10, v208
    v_and_b32 v7, 1, v0
    v_lshl_add_u32 v208, v7, 7, v208
    v_add_u32 v208, s34, v208
    s_and_b32 s33, s35, 7
    s_lshr_b32 s35, s35, 3
    s_mul_i32 s34, s33, 229376
    s_lshl_b32 s35, s35, 7
    s_add_u32 s34, s34, s35
    v_mul_u32_u24 v211, 3584, v0
    v_add_u32 v211, s34, v211
    s_mov_b32 s3, 0x10000
    s_nop 0
wl_21:
    ds_read_b32 v12, v1 offset:32
    s_waitcnt lgkmcnt(0)
    v_readfirstlane_b32 s29, v12
    s_cmp_ge_u32 s29, 1
    s_nop 3
    s_cbranch_scc1 wl_21d
    s_sleep 4
    s_sub_u32 s3, s3, 1
    s_cbranch_scc0 wl_21
wl_21d:
    v_lshlrev_b32 v2, 3, v0
    s_lshl_b32 s33, s27, 9
    s_add_u32 s33, s33, 7684096
    v_lshl_add_u32 v3, v0, 2, v1
    v_mov_b32 v6, 5
    s_mov_b32 s3, 0x10000
    s_nop 0
wl_22:
    ds_read_b128 v[12:15], v1 offset:16
    s_waitcnt lgkmcnt(0)
    v_min_u32 v12, v12, v13
    v_min3_u32 v12, v12, v14, v15
    s_nop 0
    v_readfirstlane_b32 s30, v12
    s_cmp_ge_u32 s30, 3
    s_nop 3
    s_cbranch_scc1 wl_22d
    s_sleep 2
    s_sub_u32 s3, s3, 1
    s_cbranch_scc0 wl_22
wl_22d:
    s_sleep 4
    s_mov_b32 s3, 0x8000
st_23:
    buffer_load_dwordx2 v[4:5], v2, s[40:43], s33 offen sc1
    s_waitcnt vmcnt(0)
    v_cmp_ne_u32 vcc, s29, v5
    s_nop 4
    s_cbranch_vccz st_23d
    s_sleep 2
    s_sub_u32 s3, s3, 1
    s_cbranch_scc0 st_23
st_23d:
    v_lshlrev_b32 v5, 16, v4
    v_rcp_f32 v5, v5
    v_and_b32 v4, 0xffff0000, v4
    ds_write_b32 v3, v4 offset:768
    ds_write_b32 v3, v5 offset:512
    ds_write_b32 v1, v6 offset:172
    s_cmp_lg_u32 s2, 24
    s_cbranch_scc1 sw_24
    s_mov_b32 s3, 0x10000
wl_25:
    ds_read_b32 v12, v1 offset:144
    s_waitcnt lgkmcnt(0)
    v_readfirstlane_b32 s30, v12
    s_cmp_ge_u32 s30, 1
    s_nop 3
    s_cbranch_scc1 wl_25d
    s_sleep 2
    s_sub_u32 s3, s3, 1
    s_cbranch_scc0 wl_25
wl_25d:
sw_24:
    s_mov_b32 s3, 0x10000
wl_26:
    ds_read_b128 v[12:15], v1 offset:16
    s_waitcnt lgkmcnt(0)
    v_min_u32 v12, v12, v13
    v_min3_u32 v12, v12, v14, v15
    s_nop 0
    v_readfirstlane_b32 s30, v12
    s_cmp_ge_u32 s30, 4
    s_nop 3
    s_cbranch_scc1 wl_26d
    s_sleep 2
    s_sub_u32 s3, s3, 1
    s_cbranch_scc0 wl_26
wl_26d:
    s_sleep 3
    s_cmp_eq_u32 s26, 3
    s_cbranch_scc1 recurrent_scan__sliding_block__moe_arch_mod__prompt_kernel_ta0
    global_load_dword v210, v208, s[18:19]
recurrent_scan__sliding_block__moe_arch_mod__prompt_kernel_ta0:
    v_lshrrev_b32 v6, 2, v0
    v_and_b32 v7, 3, v0
    v_lshlrev_b32 v2, 6, v6
    v_lshl_add_u32 v2, v7, 3, v2
    v_lshl_add_u32 v8, v6, 11, v2
    v_lshl_add_u32 v9, v7, 2, v1
    v_lshl_add_u32 v10, v7, 3, v1
    s_lshl_b32 s34, s27, 3
    s_add_u32 s34, s34, s26
    s_lshl_b32 s34, s34, 8
    s_add_u32 s33, s34, 7340032
    s_add_u32 s34, s33, 2048
    s_min_u32 s35, s27, 4
    s_lshl_b32 s35, s35, 2
    s_bfm_b64 s[10:11], s35, 0
    s_sub_u32 s35, 31, s27
    s_min_u32 s35, s35, 4
    s_lshl_b32 s35, s35, 2
    s_bfm_b64 s[36:37], s35, 0
    v_mov_b32 v14, 0
    v_mov_b32 v6, 1
    v_mov_b32 v5, s29
    s_mov_b32 s3, 0x10000
    s_nop 0
wl_27:
    ds_read_b32 v12, v1 offset:160
    s_waitcnt lgkmcnt(0)
    v_readfirstlane_b32 s30, v12
    s_cmp_ge_u32 s30, 4
    s_nop 3
    s_cbranch_scc1 wl_27d
    s_sleep 1
    s_sub_u32 s3, s3, 1
    s_cbranch_scc0 wl_27
wl_27d:
    ds_read_b32 v4, v9 offset:192
    s_cmp_eq_u32 s27, 31
    s_cbranch_scc1 recurrent_scan__sliding_block__moe_arch_mod__prompt_kernel_nmb
    s_mov_b64 exec, s[36:37]
    s_waitcnt lgkmcnt(0)
    buffer_store_dwordx2 v[4:5], v8, s[40:43], s34 offen sc1
recurrent_scan__sliding_block__moe_arch_mod__prompt_kernel_nmb:
    s_sleep 8
    s_cmp_eq_u32 s27, 0
    s_cbranch_scc1 recurrent_scan__sliding_block__moe_arch_mod__prompt_kernel_kvr
    s_mov_b64 exec, s[10:11]
    s_mov_b32 s3, 40
recurrent_scan__sliding_block__moe_arch_mod__prompt_kernel_pp:
    buffer_load_dwordx2 v[14:15], v2, s[40:43], s33 offen sc1
    s_sleep 4
    ds_read_b32 v4, v1 offset:168
    s_waitcnt lgkmcnt(0)
    v_readfirstlane_b32 s30, v4
    s_cmp_lg_u32 s30, 0
    s_nop 3
    s_cbranch_scc1 recurrent_scan__sliding_block__moe_arch_mod__prompt_kernel_ppd
    s_sub_u32 s3, s3, 1
    s_cbranch_scc0 recurrent_scan__sliding_block__moe_arch_mod__prompt_kernel_pp
recurrent_scan__sliding_block__moe_arch_mod__prompt_kernel_ppd:
    s_mov_b32 s3, 0x8000
recurrent_scan__sliding_block__moe_arch_mod__prompt_kernel_pq:
    s_waitcnt vmcnt(0)
    v_cmp_ne_u32 vcc, s29, v15
    s_nop 4
    s_cbranch_vccz recurrent_scan__sliding_block__moe_arch_mod__prompt_kernel_kvr
    s_sleep 2
    buffer_load_dwordx2 v[14:15], v2, s[40:43], s33 offen sc1
    s_sub_u32 s3, s3, 1
    s_cbranch_scc0 recurrent_scan__sliding_block__moe_arch_mod__prompt_kernel_pq
    s_waitcnt vmcnt(0)
recurrent_scan__sliding_block__moe_arch_mod__prompt_kernel_kvr:
    s_mov_b64 exec, -1
    v_add_u32_dpp v7, v14, v14 row_ror:4 row_mask:0xf bank_mask:0xf
    s_nop 1
    v_add_u32_dpp v7, v7, v7 row_ror:8 row_mask:0xf bank_mask:0xf
    s_mov_b64 exec, 15
    ds_write_b64 v10, v[6:7] offset:208
    s_mov_b64 exec, -1
recurrent_scan__sliding_block__moe_arch_mod__prompt_kernel_sv:
    s_sub_u32 s33, s28, 4
    s_mov_b32 s32, 0
    s_branch recurrent_scan__sliding_block__moe_arch_mod__prompt_kernel_op
recurrent_scan__sliding_block__moe_arch_mod__prompt_kernel_s2:
    s_mov_b32 s44, s18
    s_mov_b32 s45, s19
    s_mov_b32 s46, 0x1c0000
    s_mov_b32 s47, 0x00020000
    s_cmp_gt_u32 s26, 3
    s_subb_u32 s30, s26, 0
    s_mul_i32 s3, s27, 7
    s_add_u32 s30, s30, s3
    s_lshr_b32 s31, s30, 2
    s_and_b32 s30, s30, 3
    v_lshrrev_b32 v7, 4, v0
    v_and_b32 v11, 15, v0
    v_lshlrev_b32 v11, 4, v11
    v_lshl_add_u32 v11, v7, 11, v11
    s_lshl_b32 s50, s31, 15
    s_lshl_b32 s36, s30, 8
    s_add_u32 s50, s50, s36
    v_add_u32 v11, s50, v11
    v_lshlrev_b32 v2, 12, v0
    v_lshlrev_b32 v3, 4, v0
    s_lshr_b32 s50, s31, 1
    s_lshl_b32 s50, s50, 15
    s_and_b32 s36, s31, 1
    s_lshl_b32 s36, s36, 11
    s_add_u32 s50, s50, s36
    s_add_u32 s50, s50, 9437184
    v_and_b32 v8, 7, v0
    v_lshlrev_b32 v8, 11, v8
    v_lshrrev_b32 v11, 5, v0
    v_lshl_add_u32 v8, v11, 6, v8
    v_bfe_u32 v11, v0, 4, 1
    v_lshl_add_u32 v8, v11, 5, v8
    v_bfe_u32 v11, v0, 3, 1
    v_lshl_add_u32 v8, v11, 4, v8
    s_lshl_b32 s51, s31, 14
    s_lshl_b32 s36, s30, 9
    s_add_u32 s51, s51, s36
    s_add_u32 s51, s51, 6291456
    s_mov_b32 s52, 0x00003f80
    s_mov_b32 s53, 0x3f800000
    v_mov_b32 v113, s29
    v_mov_b32 v115, s29
    v_mov_b32 v117, s29
    v_mov_b32 v119, s29
    v_mov_b32 v121, s29
    v_mov_b32 v123, s29
    v_mov_b32 v125, s29
    v_mov_b32 v127, s29
    v_perm_b32 v48, v20, v16, s34
    v_perm_b32 v49, v28, v24, s34
    v_perm_b32 v50, v36, v32, s34
    v_perm_b32 v51, v44, v40, s34
    v_perm_b32 v52, v20, v16, s35
    v_perm_b32 v53, v28, v24, s35
    v_perm_b32 v54, v36, v32, s35
    v_perm_b32 v55, v44, v40, s35
    v_perm_b32 v56, v21, v17, s34
    v_perm_b32 v57, v29, v25, s34
    v_perm_b32 v58, v37, v33, s34
    v_perm_b32 v59, v45, v41, s34
    v_perm_b32 v60, v21, v17, s35
    v_perm_b32 v61, v29, v25, s35
    v_perm_b32 v62, v37, v33, s35
    v_perm_b32 v63, v45, v41, s35
    v_perm_b32 v64, v22, v18, s34
    v_perm_b32 v65, v30, v26, s34
    v_perm_b32 v66, v38, v34, s34
    v_perm_b32 v67, v46, v42, s34
    v_perm_b32 v68, v22, v18, s35
    v_perm_b32 v69, v30, v26, s35
    v_perm_b32 v70, v38, v34, s35
    v_perm_b32 v71, v46, v42, s35
    v_perm_b32 v72, v23, v19, s34
    v_perm_b32 v73, v31, v27, s34
    v_perm_b32 v74, v39, v35, s34
    v_perm_b32 v75, v47, v43, s34
    v_perm_b32 v76, v23, v19, s35
    v_perm_b32 v77, v31, v27, s35
    v_perm_b32 v78, v39, v35, s35
    v_perm_b32 v79, v47, v43, s35
    s_mov_b64 exec, 0xff
    s_mov_b32 s3, 0x8000
pl_28:
    buffer_load_dword v4, v2, s[40:43], s50 offen offset:2044 sc1
    s_waitcnt vmcnt(0)
    v_cmp_ne_u32 vcc, s29, v4
    s_nop 4
    s_cbranch_vccz pl_28d
    s_sleep 2
    s_sub_u32 s3, s3, 1
    s_cbranch_scc0 pl_28
pl_28d:
    s_mov_b64 exec, -1
    s_setprio 3
    s_mov_b32 s3, 0x2000
gl_29:
    s_mov_b32 s36, s50
    v_mov_b32 v4, s29
    v_mov_b32 v5, s29
    buffer_load_dwordx4 v[176:179], v3, s[40:43], s36 offen offset:0 sc1
    buffer_load_dwordx4 v[180:183], v3, s[40:43], s36 offen offset:1024 sc1
    s_add_u32 s36, s36, 4096
    buffer_load_dwordx4 v[184:187], v3, s[40:43], s36 offen offset:0 sc1
    buffer_load_dwordx4 v[188:191], v3, s[40:43], s36 offen offset:1024 sc1
    s_add_u32 s36, s36, 4096
    buffer_load_dwordx4 v[192:195], v3, s[40:43], s36 offen offset:0 sc1
    buffer_load_dwordx4 v[196:199], v3, s[40:43], s36 offen offset:1024 sc1
    s_add_u32 s36, s36, 4096
    buffer_load_dwordx4 v[200:203], v3, s[40:43], s36 offen offset:0 sc1
    buffer_load_dwordx4 v[204:207], v3, s[40:43], s36 offen offset:1024 sc1
    s_add_u32 s36, s36, 4096
    buffer_load_dwordx4 v[208:211], v3, s[40:43], s36 offen offset:0 sc1
    buffer_load_dwordx4 v[212:215], v3, s[40:43], s36 offen offset:1024 sc1
    s_add_u32 s36, s36, 4096
    buffer_load_dwordx4 v[216:219], v3, s[40:43], s36 offen offset:0 sc1
    buffer_load_dwordx4 v[220:223], v3, s[40:43], s36 offen offset:1024 sc1
    s_add_u32 s36, s36, 4096
    buffer_load_dwordx4 v[224:227], v3, s[40:43], s36 offen offset:0 sc1
    buffer_load_dwordx4 v[228:231], v3, s[40:43], s36 offen offset:1024 sc1
    s_add_u32 s36, s36, 4096
    buffer_load_dwordx4 v[232:235], v3, s[40:43], s36 offen offset:0 sc1
    buffer_load_dwordx4 v[236:239], v3, s[40:43], s36 offen offset:1024 sc1
    s_waitcnt vmcnt(15)
    v_min3_u32 v4, v4, v177, v179
    v_max3_u32 v5, v5, v177, v179
    v_dot2_f32_bf16 v240, v176, s52, 0
    v_dot2_f32_bf16 v241, v176, s53, 0
    v_dot2_f32_bf16 v242, v178, s52, 0
    v_dot2_f32_bf16 v243, v178, s53, 0
    s_waitcnt vmcnt(14)
    v_min3_u32 v4, v4, v181, v183
    v_max3_u32 v5, v5, v181, v183
    v_dot2_f32_bf16 v244, v180, s52, 0
    v_dot2_f32_bf16 v245, v180, s53, 0
    v_dot2_f32_bf16 v246, v182, s52, 0
    v_dot2_f32_bf16 v247, v182, s53, 0
    s_waitcnt vmcnt(13)
    v_min3_u32 v4, v4, v185, v187
    v_max3_u32 v5, v5, v185, v187
    v_dot2_f32_bf16 v240, v184, s52, v240
    v_dot2_f32_bf16 v241, v184, s53, v241
    v_dot2_f32_bf16 v242, v186, s52, v242
    v_dot2_f32_bf16 v243, v186, s53, v243
    s_waitcnt vmcnt(12)
    v_min3_u32 v4, v4, v189, v191
    v_max3_u32 v5, v5, v189, v191
    v_dot2_f32_bf16 v244, v188, s52, v244
    v_dot2_f32_bf16 v245, v188, s53, v245
    v_dot2_f32_bf16 v246, v190, s52, v246
    v_dot2_f32_bf16 v247, v190, s53, v247
    s_waitcnt vmcnt(11)
    v_min3_u32 v4, v4, v193, v195
    v_max3_u32 v5, v5, v193, v195
    v_dot2_f32_bf16 v240, v192, s52, v240
    v_dot2_f32_bf16 v241, v192, s53, v241
    v_dot2_f32_bf16 v242, v194, s52, v242
    v_dot2_f32_bf16 v243, v194, s53, v243
    s_waitcnt vmcnt(10)
    v_min3_u32 v4, v4, v197, v199
    v_max3_u32 v5, v5, v197, v199
    v_dot2_f32_bf16 v244, v196, s52, v244
    v_dot2_f32_bf16 v245, v196, s53, v245
    v_dot2_f32_bf16 v246, v198, s52, v246
    v_dot2_f32_bf16 v247, v198, s53, v247
    s_waitcnt vmcnt(9)
    v_min3_u32 v4, v4, v201, v203
    v_max3_u32 v5, v5, v201, v203
    v_dot2_f32_bf16 v240, v200, s52, v240
    v_dot2_f32_bf16 v241, v200, s53, v241
    v_dot2_f32_bf16 v242, v202, s52, v242
    v_dot2_f32_bf16 v243, v202, s53, v243
    s_waitcnt vmcnt(8)
    v_min3_u32 v4, v4, v205, v207
    v_max3_u32 v5, v5, v205, v207
    v_dot2_f32_bf16 v244, v204, s52, v244
    v_dot2_f32_bf16 v245, v204, s53, v245
    v_dot2_f32_bf16 v246, v206, s52, v246
    v_dot2_f32_bf16 v247, v206, s53, v247
    s_waitcnt vmcnt(7)
    v_min3_u32 v4, v4, v209, v211
    v_max3_u32 v5, v5, v209, v211
    v_dot2_f32_bf16 v240, v208, s52, v240
    v_dot2_f32_bf16 v241, v208, s53, v241
    v_dot2_f32_bf16 v242, v210, s52, v242
    v_dot2_f32_bf16 v243, v210, s53, v243
    s_waitcnt vmcnt(6)
    v_min3_u32 v4, v4, v213, v215
    v_max3_u32 v5, v5, v213, v215
    v_dot2_f32_bf16 v244, v212, s52, v244
    v_dot2_f32_bf16 v245, v212, s53, v245
    v_dot2_f32_bf16 v246, v214, s52, v246
    v_dot2_f32_bf16 v247, v214, s53, v247
    s_waitcnt vmcnt(5)
    v_min3_u32 v4, v4, v217, v219
    v_max3_u32 v5, v5, v217, v219
    v_dot2_f32_bf16 v240, v216, s52, v240
    v_dot2_f32_bf16 v241, v216, s53, v241
    v_dot2_f32_bf16 v242, v218, s52, v242
    v_dot2_f32_bf16 v243, v218, s53, v243
    s_waitcnt vmcnt(4)
    v_min3_u32 v4, v4, v221, v223
    v_max3_u32 v5, v5, v221, v223
    v_dot2_f32_bf16 v244, v220, s52, v244
    v_dot2_f32_bf16 v245, v220, s53, v245
    v_dot2_f32_bf16 v246, v222, s52, v246
    v_dot2_f32_bf16 v247, v222, s53, v247
    s_waitcnt vmcnt(3)
    v_min3_u32 v4, v4, v225, v227
    v_max3_u32 v5, v5, v225, v227
    v_dot2_f32_bf16 v240, v224, s52, v240
    v_dot2_f32_bf16 v241, v224, s53, v241
    v_dot2_f32_bf16 v242, v226, s52, v242
    v_dot2_f32_bf16 v243, v226, s53, v243
    s_waitcnt vmcnt(2)
    v_min3_u32 v4, v4, v229, v231
    v_max3_u32 v5, v5, v229, v231
    v_dot2_f32_bf16 v244, v228, s52, v244
    v_dot2_f32_bf16 v245, v228, s53, v245
    v_dot2_f32_bf16 v246, v230, s52, v246
    v_dot2_f32_bf16 v247, v230, s53, v247
    s_waitcnt vmcnt(1)
    v_min3_u32 v4, v4, v233, v235
    v_max3_u32 v5, v5, v233, v235
    v_dot2_f32_bf16 v240, v232, s52, v240
    v_dot2_f32_bf16 v241, v232, s53, v241
    v_dot2_f32_bf16 v242, v234, s52, v242
    v_dot2_f32_bf16 v243, v234, s53, v243
    s_waitcnt vmcnt(0)
    v_min3_u32 v4, v4, v237, v239
    v_max3_u32 v5, v5, v237, v239
    v_dot2_f32_bf16 v244, v236, s52, v244
    v_dot2_f32_bf16 v245, v236, s53, v245
    v_dot2_f32_bf16 v246, v238, s52, v246
    v_dot2_f32_bf16 v247, v238, s53, v247
    v_cmp_ne_u32 vcc, v4, v5
    s_nop 4
    s_cbranch_vccz gl_29g
    s_sub_u32 s3, s3, 1
    s_cbranch_scc0 gl_29
gl_29g:
    v_mul_f32 v248, 0xbfb8aa3b, v240
    v_mul_f32 v249, 0xbfb8aa3b, v241
    v_mul_f32 v250, 0xbfb8aa3b, v242
    v_mul_f32 v251, 0xbfb8aa3b, v243
    v_mul_f32 v252, 0xbfb8aa3b, v244
    v_mul_f32 v253, 0xbfb8aa3b, v245
    v_mul_f32 v254, 0xbfb8aa3b, v246
    v_mul_f32 v255, 0xbfb8aa3b, v247
    v_exp_f32 v248, v248
    v_exp_f32 v249, v249
    v_exp_f32 v250, v250
    v_exp_f32 v251, v251
    v_exp_f32 v252, v252
    v_exp_f32 v253, v253
    v_exp_f32 v254, v254
    v_exp_f32 v255, v255
    v_mul_f32_dpp v176, v240, v240 row_ror:8 row_mask:0xf bank_mask:0xf
    v_mul_f32_dpp v177, v241, v241 row_ror:8 row_mask:0xf bank_mask:0xf
    v_mul_f32_dpp v178, v242, v242 row_ror:8 row_mask:0xf bank_mask:0xf
    v_mul_f32_dpp v179, v243, v243 row_ror:8 row_mask:0xf bank_mask:0xf
    v_mul_f32_dpp v180, v244, v244 row_ror:8 row_mask:0xf bank_mask:0xf
    v_mul_f32_dpp v181, v245, v245 row_ror:8 row_mask:0xf bank_mask:0xf
    v_mul_f32_dpp v182, v246, v246 row_ror:8 row_mask:0xf bank_mask:0xf
    v_mul_f32_dpp v183, v247, v247 row_ror:8 row_mask:0xf bank_mask:0xf
    v_add_f32 v248, 1.0, v248
    v_add_f32 v249, 1.0, v249
    v_add_f32 v250, 1.0, v250
    v_add_f32 v251, 1.0, v251
    v_add_f32 v252, 1.0, v252
    v_add_f32 v253, 1.0, v253
    v_add_f32 v254, 1.0, v254
    v_add_f32 v255, 1.0, v255
    v_rcp_f32 v248, v248
    v_rcp_f32 v249, v249
    v_rcp_f32 v250, v250
    v_rcp_f32 v251, v251
    v_rcp_f32 v252, v252
    v_rcp_f32 v253, v253
    v_rcp_f32 v254, v254
    v_rcp_f32 v255, v255
    v_mul_f32 v176, v176, v248
    v_mul_f32 v177, v177, v249
    v_mul_f32 v178, v178, v250
    v_mul_f32 v179, v179, v251
    v_mul_f32 v180, v180, v252
    v_mul_f32 v181, v181, v253
    v_mul_f32 v182, v182, v254
    v_mul_f32 v183, v183, v255
    v_cvt_pk_bf16_f32 v248, v176, v177
    v_cvt_pk_bf16_f32 v249, v178, v179
    v_cvt_pk_bf16_f32 v250, v180, v181
    v_cvt_pk_bf16_f32 v251, v182, v183
    v_cndmask_b32_e64 v248, 0, v248, s[10:11]
    v_cndmask_b32_e64 v249, 0, v249, s[10:11]
    v_cndmask_b32_e64 v250, 0, v250, s[10:11]
    v_cndmask_b32_e64 v251, 0, v251, s[10:11]
    v_mov_b32_dpp v252, v248 row_ror:8 row_mask:0xf bank_mask:0xf
    v_mov_b32_dpp v253, v249 row_ror:8 row_mask:0xf bank_mask:0xf
    v_mov_b32_dpp v254, v250 row_ror:8 row_mask:0xf bank_mask:0xf
    v_mov_b32_dpp v255, v251 row_ror:8 row_mask:0xf bank_mask:0xf
    v_mfma_f32_16x16x32_bf16 v[192:195], v[48:51], v[248:251], 0
    v_mfma_f32_16x16x32_bf16 v[196:199], v[56:59], v[248:251], 0
    v_mfma_f32_16x16x32_bf16 v[200:203], v[64:67], v[248:251], 0
    v_mfma_f32_16x16x32_bf16 v[204:207], v[72:75], v[248:251], 0
    v_mfma_f32_16x16x32_bf16 v[192:195], v[52:55], v[252:255], v[192:195]
    v_mfma_f32_16x16x32_bf16 v[196:199], v[60:63], v[252:255], v[196:199]
    v_mfma_f32_16x16x32_bf16 v[200:203], v[68:71], v[252:255], v[200:203]
    v_mfma_f32_16x16x32_bf16 v[204:207], v[76:79], v[252:255], v[204:207]
    s_nop 4
    v_cvt_pk_bf16_f32 v112, v192, v193
    v_cvt_pk_bf16_f32 v114, v194, v195
    v_cvt_pk_bf16_f32 v116, v196, v197
    v_cvt_pk_bf16_f32 v118, v198, v199
    s_nop 0
    v_permlane32_swap_b32 v112, v116
    v_permlane32_swap_b32 v114, v118
    buffer_store_dwordx4 v[112:115], v8, s[40:43], s51 offen offset:0 sc1
    buffer_store_dwordx4 v[116:119], v8, s[40:43], s51 offen offset:256 sc1
    v_cvt_pk_bf16_f32 v120, v200, v201
    v_cvt_pk_bf16_f32 v122, v202, v203
    v_cvt_pk_bf16_f32 v124, v204, v205
    v_cvt_pk_bf16_f32 v126, v206, v207
    s_nop 0
    v_permlane32_swap_b32 v120, v124
    v_permlane32_swap_b32 v122, v126
    buffer_store_dwordx4 v[120:123], v8, s[40:43], s51 offen offset:128 sc1
    buffer_store_dwordx4 v[124:127], v8, s[40:43], s51 offen offset:384 sc1
    s_setprio 0
    s_nop 0
    s_branch recurrent_scan__sliding_block__moe_arch_mod__prompt_kernel_sv
recurrent_scan__sliding_block__moe_arch_mod__prompt_kernel_cw:
    s_mov_b32 s39, 0x3f803f80
    s_and_b32 s32, s28, 1
    s_lshr_b32 s33, s28, 1
    v_and_b32 v10, 31, v0
    v_lshrrev_b32 v9, 5, v0
    v_bfe_u32 v8, v0, 1, 3
    v_xor_b32 v8, v8, v9
    s_lshl_b32 s34, s32, 12
    s_lshl_b32 s35, s32, 1
    s_lshl_b32 s36, s35, 5
    v_lshlrev_b32 v8, 4, v8
    v_lshl_add_u32 v8, v10, 7, v8
    v_add_u32 v8, s34, v8
    v_xor_b32 v176, s36, v8
    v_xor_b32 v177, 32, v176
    v_xor_b32 v178, 64, v176
    v_xor_b32 v179, 96, v176
    s_lshl_b32 s36, s33, 13
    v_bfe_u32 v8, v0, 2, 2
    v_lshlrev_b32 v7, 7, v8
    v_lshrrev_b32 v8, 1, v8
    v_xor_b32 v8, s33, v8
    v_lshl_add_u32 v7, v8, 6, v7
    v_bfe_u32 v8, v0, 4, 1
    v_lshl_add_u32 v7, v8, 5, v7
    v_and_b32 v8, 3, v0
    v_lshl_add_u32 v7, v8, 3, v7
    v_add_u32 v7, 65536, v7
    v_lshl_add_u32 v13, v9, 11, v7
    s_lshl_b32 s36, s35, 12
    v_xor_b32 v180, s36, v13
    v_xor_b32 v181, 4096, v180
    v_xor_b32 v182, 8192, v180
    v_xor_b32 v183, 12288, v180
    v_and_b32 v8, 15, v0
    v_bfe_u32 v13, v0, 4, 1
    v_sub_u32 v6, v8, v13
    v_mov_b32 v14, s39
    v_cmp_eq_u32 vcc, 2, v6
    s_nop 1
    v_cndmask_b32 v68, 0, v14, vcc
    v_cndmask_b32 v69, 0, v14, vcc
    v_cndmask_b32 v70, 0, v14, vcc
    v_cndmask_b32 v71, 0, v14, vcc
    v_cmp_eq_u32 vcc, 4, v6
    s_nop 1
    v_cndmask_b32 v72, 0, v14, vcc
    v_cndmask_b32 v73, 0, v14, vcc
    v_cndmask_b32 v74, 0, v14, vcc
    v_cndmask_b32 v75, 0, v14, vcc
    v_lshlrev_b32 v188, 4, v0
    s_lshl_b32 s34, s28, 10
    s_add_u32 s36, s34, 147456
    v_add_u32 v189, s36, v188
    s_add_u32 s36, s34, 151552
    v_lshlrev_b32 v191, 6, v8
    v_lshrrev_b32 v13, 4, v0
    v_lshl_add_u32 v191, v13, 4, v191
    v_add_u32 v191, s36, v191
    v_lshlrev_b32 v13, 4, v9
    v_add_u32 v192, s36, v13
    v_lshlrev_b32 v14, 2, v10
    v_add_u32 v193, s36, v14
    s_lshl_b32 s36, s32, 7
    s_add_u32 s36, s36, 156160
    v_add_u32 v194, s36, v14
    v_add_u32 v195, s36, v13
    v_bfe_u32 v190, v0, 4, 1
    v_lshlrev_b32 v190, 16, v190
    v_lshl_add_u32 v190, v9, 8, v190
    v_lshl_add_u32 v190, v8, 4, v190
    s_lshl_b32 s36, s28, 9
    s_add_u32 s36, s36, 157696
    v_lshlrev_b32 v5, 3, v0
    v_add_u32 v5, s36, v5
    s_lshl_b32 s36, s28, 2
    v_add_u32 v4, s36, v1
    s_lshl_b32 s34, s26, 2
    s_lshl_b32 s36, s33, 1
    s_add_u32 s34, s34, s36
    s_lshl_b32 s34, s34, 16
    s_lshl_b32 s36, s27, 1
    s_add_u32 s36, s36, s32
    s_lshl_b32 s36, s36, 10
    s_add_u32 s36, s34, s36
    s_add_u32 s37, s36, 0x10000
    s_add_u32 s34, s36, 2097152
    s_mov_b32 s10, 0xffff0000
    s_mov_b32 s11, s10
    s_mov_b64 exec, s[10:11]
    s_cmp_ge_u32 s27, 3
    s_cselect_b32 s30, s39, 0
    s_mov_b32 s31, s30
    v_mov_b64 v[200:201], s[30:31]
    v_mov_b64 v[202:203], s[30:31]
    v_mov_b64 v[204:205], s[30:31]
    v_mov_b64 v[206:207], s[30:31]
    s_cmp_ge_u32 s27, 2
    s_cselect_b32 s30, s39, 0
    s_mov_b32 s31, s30
    v_mov_b64 v[208:209], s[30:31]
    v_mov_b64 v[210:211], s[30:31]
    v_mov_b64 v[212:213], s[30:31]
    v_mov_b64 v[214:215], s[30:31]
    v_mov_b64 v[216:217], s[30:31]
    v_mov_b64 v[218:219], s[30:31]
    v_mov_b64 v[220:221], s[30:31]
    v_mov_b64 v[222:223], s[30:31]
    s_cmp_ge_u32 s27, 1
    s_cselect_b32 s30, s39, 0
    s_mov_b32 s31, s30
    v_mov_b64 v[224:225], s[30:31]
    v_mov_b64 v[226:227], s[30:31]
    v_mov_b64 v[228:229], s[30:31]
    v_mov_b64 v[230:231], s[30:31]
    v_mov_b64 v[232:233], s[30:31]
    v_mov_b64 v[234:235], s[30:31]
    v_mov_b64 v[236:237], s[30:31]
    v_mov_b64 v[238:239], s[30:31]
    s_mov_b64 exec, -1
    s_mov_b32 s38, s34
    s_lshl_b32 s44, -1, 0
    s_lshl_b32 s45, -1, 4
    s_lshl_b32 s46, -1, 1
    s_lshl_b32 s47, -1, 5
    s_lshl_b32 s48, -1, 2
    s_lshl_b32 s49, -1, 6
    s_lshl_b32 s50, -1, 3
    s_lshl_b32 s51, -1, 7
    s_lshl_b32 s52, -1, 8
    s_lshl_b32 s53, -1, 12
    s_lshl_b32 s54, -1, 9
    s_lshl_b32 s55, -1, 13
    s_lshl_b32 s56, -1, 10
    s_lshl_b32 s57, -1, 14
    s_lshl_b32 s58, -1, 11
    s_lshl_b32 s59, -1, 15
    s_lshl_b32 s60, -1, 16
    s_lshl_b32 s61, -1, 20
    s_lshl_b32 s62, -1, 17
    s_lshl_b32 s63, -1, 21
    s_lshl_b32 s64, -1, 18
    s_lshl_b32 s65, -1, 22
    s_lshl_b32 s66, -1, 19
    s_lshl_b32 s67, -1, 23
    s_lshl_b32 s68, -1, 24
    s_lshl_b32 s69, -1, 28
    s_lshl_b32 s70, -1, 25
    s_lshl_b32 s71, -1, 29
    s_lshl_b32 s72, -1, 26
    s_lshl_b32 s73, -1, 30
    s_lshl_b32 s74, -1, 27
    s_lshl_b32 s75, -1, 31
    s_mov_b32 s3, 0x10000
wl_30:
    ds_read_b64 v[2:3], v1 offset:0
    s_waitcnt lgkmcnt(0)
    v_min_u32 v2, v2, v3
    s_nop 0
    v_readfirstlane_b32 s30, v2
    s_cmp_ge_u32 s30, 1
    s_nop 3
    s_cbranch_scc1 wl_30d
    s_sub_u32 s3, s3, 1
    s_cbranch_scc0 wl_30
wl_30d:
    ds_read_b128 v[80:83], v176 offset:0
    ds_read_b64_tr_b16 v[112:113], v180 offset:0
    ds_read_b64_tr_b16 v[114:115], v180 offset:512
    ds_read_b64_tr_b16 v[116:117], v180 offset:1024
    ds_read_b64_tr_b16 v[118:119], v180 offset:1536
    ds_read_b128 v[84:87], v177 offset:0
    ds_read_b64_tr_b16 v[120:121], v181 offset:0
    ds_read_b64_tr_b16 v[122:123], v181 offset:512
    ds_read_b64_tr_b16 v[124:125], v181 offset:1024
    ds_read_b64_tr_b16 v[126:127], v181 offset:1536
    ds_read_b128 v[88:91], v178 offset:0
    ds_read_b64_tr_b16 v[128:129], v182 offset:0
    ds_read_b64_tr_b16 v[130:131], v182 offset:512
    ds_read_b64_tr_b16 v[132:133], v182 offset:1024
    ds_read_b64_tr_b16 v[134:135], v182 offset:1536
    ds_read_b64 v[2:3], v1 offset:0
    ds_read_b128 v[92:95], v179 offset:0
    ds_read_b64_tr_b16 v[136:137], v183 offset:0
    ds_read_b64_tr_b16 v[138:139], v183 offset:512
    ds_read_b64_tr_b16 v[140:141], v183 offset:1024
    ds_read_b64_tr_b16 v[142:143], v183 offset:1536
    s_waitcnt lgkmcnt(5)
    v_min_u32 v2, v2, v3
    s_nop 0
    v_readfirstlane_b32 s30, v2
    s_cmp_lt_u32 s30, 2
    s_cbranch_scc1 slw_31
    v_mfma_f32_32x32x16_bf16 v[32:47], v[112:115], v[80:83], 0
    ds_read_b128 v[96:99], v176 offset:8192
    ds_read_b64_tr_b16 v[144:145], v180 offset:16384
    ds_read_b64_tr_b16 v[146:147], v180 offset:16896
    v_mfma_f32_16x16x32_bf16 v[64:67], v[112:115], v[68:71], 0
    ds_read_b64_tr_b16 v[148:149], v180 offset:17408
    v_mfma_f32_32x32x16_bf16 v[48:63], v[80:83], v[116:119], 0
    s_waitcnt lgkmcnt(4)
    v_mov_b32 v6, 1
    ds_write_b32 v4, v6 offset:16
    ds_read_b64_tr_b16 v[150:151], v180 offset:17920
    ds_read_b128 v[100:103], v177 offset:8192
    v_mfma_f32_16x16x32_bf16 v[64:67], v[116:119], v[72:75], v[64:67]
    ds_read_b64_tr_b16 v[152:153], v181 offset:16384
    v_mfma_f32_32x32x16_bf16 v[32:47], v[120:123], v[84:87], v[32:47]
    ds_read_b64_tr_b16 v[154:155], v181 offset:16896
    ds_read_b64_tr_b16 v[156:157], v181 offset:17408
    ds_read_b64_tr_b16 v[158:159], v181 offset:17920
    v_mfma_f32_16x16x32_bf16 v[64:67], v[120:123], v[68:71], v[64:67]
    ds_read_b128 v[104:107], v178 offset:8192
    v_mfma_f32_32x32x16_bf16 v[48:63], v[84:87], v[124:127], v[48:63]
    ds_read_b64_tr_b16 v[160:161], v182 offset:16384
    ds_read_b64_tr_b16 v[162:163], v182 offset:16896
    ds_read_b64_tr_b16 v[164:165], v182 offset:17408
    v_mfma_f32_16x16x32_bf16 v[64:67], v[124:127], v[72:75], v[64:67]
    ds_read_b64_tr_b16 v[166:167], v182 offset:17920
    v_mfma_f32_32x32x16_bf16 v[32:47], v[128:131], v[88:91], v[32:47]
    ds_read_b64 v[2:3], v1 offset:0
    ds_read_b128 v[108:111], v179 offset:8192
    ds_read_b64_tr_b16 v[168:169], v183 offset:16384
    v_mfma_f32_32x32x16_bf16 v[48:63], v[88:91], v[132:135], v[48:63]
    ds_read_b64_tr_b16 v[170:171], v183 offset:16896
    ds_read_b64_tr_b16 v[172:173], v183 offset:17408
    ds_read_b64_tr_b16 v[174:175], v183 offset:17920
    v_mfma_f32_32x32x16_bf16 v[32:47], v[136:139], v[92:95], v[32:47]
    v_mfma_f32_32x32x16_bf16 v[48:63], v[92:95], v[140:143], v[48:63]
mrg_32:
    s_waitcnt lgkmcnt(5)
    v_min_u32 v2, v2, v3
    s_nop 0
    v_readfirstlane_b32 s30, v2
    s_cmp_lt_u32 s30, 3
    s_cbranch_scc1 slw_33
    v_mfma_f32_32x32x16_bf16 v[32:47], v[144:147], v[96:99], v[32:47]
    ds_read_b128 v[80:83], v176 offset:16384
    ds_read_b64_tr_b16 v[112:113], v180 offset:32768
    ds_read_b64_tr_b16 v[114:115], v180 offset:33280
    v_mfma_f32_16x16x32_bf16 v[64:67], v[144:147], v[68:71], v[64:67]
    ds_read_b64_tr_b16 v[116:117], v180 offset:33792
    v_mfma_f32_32x32x16_bf16 v[48:63], v[96:99], v[148:151], v[48:63]
    s_waitcnt lgkmcnt(4)
    v_mov_b32 v6, 2
    ds_write_b32 v4, v6 offset:16
    ds_read_b64_tr_b16 v[118:119], v180 offset:34304
    ds_read_b128 v[84:87], v177 offset:16384
    v_mfma_f32_16x16x32_bf16 v[64:67], v[148:151], v[72:75], v[64:67]
    ds_read_b64_tr_b16 v[120:121], v181 offset:32768
    v_mfma_f32_32x32x16_bf16 v[32:47], v[152:155], v[100:103], v[32:47]
    ds_read_b64_tr_b16 v[122:123], v181 offset:33280
    ds_read_b64_tr_b16 v[124:125], v181 offset:33792
    ds_read_b64_tr_b16 v[126:127], v181 offset:34304
    v_mfma_f32_16x16x32_bf16 v[64:67], v[152:155], v[68:71], v[64:67]
    ds_read_b128 v[88:91], v178 offset:16384
    v_mfma_f32_32x32x16_bf16 v[48:63], v[100:103], v[156:159], v[48:63]
    ds_read_b64_tr_b16 v[128:129], v182 offset:32768
    ds_read_b64_tr_b16 v[130:131], v182 offset:33280
    ds_read_b64_tr_b16 v[132:133], v182 offset:33792
    v_mfma_f32_16x16x32_bf16 v[64:67], v[156:159], v[72:75], v[64:67]
    ds_read_b64_tr_b16 v[134:135], v182 offset:34304
    v_mfma_f32_32x32x16_bf16 v[32:47], v[160:163], v[104:107], v[32:47]
    ds_read_b64 v[2:3], v1 offset:0
    ds_read_b128 v[92:95], v179 offset:16384
    ds_read_b64_tr_b16 v[136:137], v183 offset:32768
    v_mfma_f32_32x32x16_bf16 v[48:63], v[104:107], v[164:167], v[48:63]
    ds_read_b64_tr_b16 v[138:139], v183 offset:33280
    ds_read_b64_tr_b16 v[140:141], v183 offset:33792
    ds_read_b64_tr_b16 v[142:143], v183 offset:34304
    v_mfma_f32_32x32x16_bf16 v[32:47], v[168:171], v[108:111], v[32:47]
    v_mfma_f32_32x32x16_bf16 v[48:63], v[108:111], v[172:175], v[48:63]
mrg_34:
    s_waitcnt lgkmcnt(5)
    v_min_u32 v2, v2, v3
    s_nop 0
    v_readfirstlane_b32 s30, v2
    s_cmp_lt_u32 s30, 4
    s_cbranch_scc1 slw_35
    v_mfma_f32_32x32x16_bf16 v[32:47], v[112:115], v[80:83], v[32:47]
    ds_read_b128 v[96:99], v176 offset:24576
    ds_read_b64_tr_b16 v[144:145], v180 offset:49152
    ds_read_b64_tr_b16 v[146:147], v180 offset:49664
    v_mfma_f32_16x16x32_bf16 v[64:67], v[112:115], v[68:71], v[64:67]
    ds_read_b64_tr_b16 v[148:149], v180 offset:50176
    v_mfma_f32_32x32x16_bf16 v[48:63], v[80:83], v[116:119], v[48:63]
    s_waitcnt lgkmcnt(4)
    v_mov_b32 v6, 3
    ds_write_b32 v4, v6 offset:16
    ds_read_b64_tr_b16 v[150:151], v180 offset:50688
    ds_read_b128 v[100:103], v177 offset:24576
    v_mfma_f32_16x16x32_bf16 v[64:67], v[116:119], v[72:75], v[64:67]
    ds_read_b64_tr_b16 v[152:153], v181 offset:49152
    v_mfma_f32_32x32x16_bf16 v[32:47], v[120:123], v[84:87], v[32:47]
    ds_read_b64_tr_b16 v[154:155], v181 offset:49664
    ds_read_b64_tr_b16 v[156:157], v181 offset:50176
    ds_read_b64_tr_b16 v[158:159], v181 offset:50688
    v_mfma_f32_16x16x32_bf16 v[64:67], v[120:123], v[68:71], v[64:67]
    ds_read_b128 v[104:107], v178 offset:24576
    v_mfma_f32_32x32x16_bf16 v[48:63], v[84:87], v[124:127], v[48:63]
    ds_read_b64_tr_b16 v[160:161], v182 offset:49152
    ds_read_b64_tr_b16 v[162:163], v182 offset:49664
    ds_read_b64_tr_b16 v[164:165], v182 offset:50176
    v_mfma_f32_16x16x32_bf16 v[64:67], v[124:127], v[72:75], v[64:67]
    ds_read_b64_tr_b16 v[166:167], v182 offset:50688
    v_mfma_f32_32x32x16_bf16 v[32:47], v[128:131], v[88:91], v[32:47]
    ds_read_b64 v[2:3], v1 offset:0
    ds_read_b128 v[108:111], v179 offset:24576
    ds_read_b64_tr_b16 v[168:169], v183 offset:49152
    v_mfma_f32_32x32x16_bf16 v[48:63], v[88:91], v[132:135], v[48:63]
    ds_read_b64_tr_b16 v[170:171], v183 offset:49664
    ds_read_b64_tr_b16 v[172:173], v183 offset:50176
    ds_read_b64_tr_b16 v[174:175], v183 offset:50688
    v_mfma_f32_32x32x16_bf16 v[32:47], v[136:139], v[92:95], v[32:47]
    v_add_u32 v180, 65536, v180
    v_add_u32 v181, 65536, v181
    v_add_u32 v182, 65536, v182
    v_mfma_f32_32x32x16_bf16 v[48:63], v[92:95], v[140:143], v[48:63]
    v_add_u32 v183, 65536, v183
mrg_36:
    s_waitcnt lgkmcnt(5)
    v_min_u32 v2, v2, v3
    s_nop 0
    v_readfirstlane_b32 s30, v2
    s_cmp_lt_u32 s30, 5
    s_cbranch_scc1 slw_37
    v_mfma_f32_32x32x16_bf16 v[32:47], v[144:147], v[96:99], v[32:47]
    ds_read_b128 v[80:83], v176 offset:32768
    ds_read_b64_tr_b16 v[112:113], v180 offset:0
    ds_read_b64_tr_b16 v[114:115], v180 offset:512
    v_mfma_f32_16x16x32_bf16 v[64:67], v[144:147], v[68:71], v[64:67]
    ds_read_b64_tr_b16 v[116:117], v180 offset:1024
    v_mfma_f32_32x32x16_bf16 v[48:63], v[96:99], v[148:151], v[48:63]
    s_waitcnt lgkmcnt(4)
    v_mov_b32 v6, 4
    ds_write_b32 v4, v6 offset:16
    ds_read_b64_tr_b16 v[118:119], v180 offset:1536
    ds_read_b128 v[84:87], v177 offset:32768
    v_mfma_f32_16x16x32_bf16 v[64:67], v[148:151], v[72:75], v[64:67]
    ds_read_b64_tr_b16 v[120:121], v181 offset:0
    v_mfma_f32_32x32x16_bf16 v[32:47], v[152:155], v[100:103], v[32:47]
    ds_read_b64_tr_b16 v[122:123], v181 offset:512
    ds_read_b64_tr_b16 v[124:125], v181 offset:1024
    ds_read_b64_tr_b16 v[126:127], v181 offset:1536
    v_mfma_f32_16x16x32_bf16 v[64:67], v[152:155], v[68:71], v[64:67]
    ds_read_b128 v[88:91], v178 offset:32768
    v_mfma_f32_32x32x16_bf16 v[48:63], v[100:103], v[156:159], v[48:63]
    ds_read_b64_tr_b16 v[128:129], v182 offset:0
    ds_read_b64_tr_b16 v[130:131], v182 offset:512
    ds_read_b64_tr_b16 v[132:133], v182 offset:1024
    v_mfma_f32_16x16x32_bf16 v[64:67], v[156:159], v[72:75], v[64:67]
    ds_read_b64_tr_b16 v[134:135], v182 offset:1536
    v_mfma_f32_32x32x16_bf16 v[32:47], v[160:163], v[104:107], v[32:47]
    ds_read_b64 v[2:3], v1 offset:0
    ds_read_b128 v[92:95], v179 offset:32768
    ds_read_b64_tr_b16 v[136:137], v183 offset:0
    v_mfma_f32_32x32x16_bf16 v[48:63], v[104:107], v[164:167], v[48:63]
    ds_read_b64_tr_b16 v[138:139], v183 offset:512
    ds_read_b64_tr_b16 v[140:141], v183 offset:1024
    ds_read_b64_tr_b16 v[142:143], v183 offset:1536
    v_mfma_f32_32x32x16_bf16 v[32:47], v[168:171], v[108:111], v[32:47]
    v_add_u32 v180, -65536, v180
    v_add_u32 v181, -65536, v181
    v_add_u32 v182, -65536, v182
    v_mfma_f32_32x32x16_bf16 v[48:63], v[108:111], v[172:175], v[48:63]
    v_add_u32 v183, -65536, v183
mrg_38:
    s_waitcnt lgkmcnt(5)
    v_min_u32 v2, v2, v3
    s_nop 0
    v_readfirstlane_b32 s30, v2
    s_cmp_lt_u32 s30, 6
    s_cbranch_scc1 slw_39
    v_mfma_f32_32x32x16_bf16 v[32:47], v[112:115], v[80:83], v[32:47]
    ds_read_b128 v[96:99], v176 offset:40960
    ds_read_b64_tr_b16 v[144:145], v180 offset:0
    ds_read_b64_tr_b16 v[146:147], v180 offset:512
    v_mfma_f32_16x16x32_bf16 v[64:67], v[112:115], v[68:71], v[64:67]
    ds_read_b64_tr_b16 v[148:149], v180 offset:1024
    v_mfma_f32_32x32x16_bf16 v[48:63], v[80:83], v[116:119], v[48:63]
    s_waitcnt lgkmcnt(4)
    v_mov_b32 v6, 5
    ds_write_b32 v4, v6 offset:16
    ds_read_b64_tr_b16 v[150:151], v180 offset:1536
    ds_read_b128 v[100:103], v177 offset:40960
    v_mfma_f32_16x16x32_bf16 v[64:67], v[116:119], v[72:75], v[64:67]
    ds_read_b64_tr_b16 v[152:153], v181 offset:0
    v_mfma_f32_32x32x16_bf16 v[32:47], v[120:123], v[84:87], v[32:47]
    ds_read_b64_tr_b16 v[154:155], v181 offset:512
    ds_read_b64_tr_b16 v[156:157], v181 offset:1024
    ds_read_b64_tr_b16 v[158:159], v181 offset:1536
    v_mfma_f32_16x16x32_bf16 v[64:67], v[120:123], v[68:71], v[64:67]
    ds_read_b128 v[104:107], v178 offset:40960
    v_mfma_f32_32x32x16_bf16 v[48:63], v[84:87], v[124:127], v[48:63]
    ds_read_b64_tr_b16 v[160:161], v182 offset:0
    ds_read_b64_tr_b16 v[162:163], v182 offset:512
    ds_read_b64_tr_b16 v[164:165], v182 offset:1024
    v_mfma_f32_16x16x32_bf16 v[64:67], v[124:127], v[72:75], v[64:67]
    ds_read_b64_tr_b16 v[166:167], v182 offset:1536
    v_mfma_f32_32x32x16_bf16 v[32:47], v[128:131], v[88:91], v[32:47]
    ds_read_b64 v[2:3], v1 offset:0
    ds_read_b128 v[108:111], v179 offset:40960
    ds_read_b64_tr_b16 v[168:169], v183 offset:0
    v_mfma_f32_32x32x16_bf16 v[48:63], v[88:91], v[132:135], v[48:63]
    ds_read_b64_tr_b16 v[170:171], v183 offset:512
    ds_read_b64_tr_b16 v[172:173], v183 offset:1024
    ds_read_b64_tr_b16 v[174:175], v183 offset:1536
    v_mfma_f32_32x32x16_bf16 v[32:47], v[136:139], v[92:95], v[32:47]
    v_mfma_f32_32x32x16_bf16 v[48:63], v[92:95], v[140:143], v[48:63]
mrg_40:
    s_waitcnt lgkmcnt(5)
    v_min_u32 v2, v2, v3
    s_nop 0
    v_readfirstlane_b32 s30, v2
    s_cmp_lt_u32 s30, 7
    s_cbranch_scc1 slw_41
    v_mfma_f32_32x32x16_bf16 v[32:47], v[144:147], v[96:99], v[32:47]
    ds_read_b128 v[80:83], v176 offset:49152
    ds_read_b64_tr_b16 v[112:113], v180 offset:16384
    ds_read_b64_tr_b16 v[114:115], v180 offset:16896
    v_mfma_f32_16x16x32_bf16 v[64:67], v[144:147], v[68:71], v[64:67]
    ds_read_b64_tr_b16 v[116:117], v180 offset:17408
    v_mfma_f32_32x32x16_bf16 v[48:63], v[96:99], v[148:151], v[48:63]
    s_waitcnt lgkmcnt(4)
    v_mov_b32 v6, 6
    ds_write_b32 v4, v6 offset:16
    ds_read_b64_tr_b16 v[118:119], v180 offset:17920
    ds_read_b128 v[84:87], v177 offset:49152
    v_mfma_f32_16x16x32_bf16 v[64:67], v[148:151], v[72:75], v[64:67]
    ds_read_b64_tr_b16 v[120:121], v181 offset:16384
    v_mfma_f32_32x32x16_bf16 v[32:47], v[152:155], v[100:103], v[32:47]
    ds_read_b64_tr_b16 v[122:123], v181 offset:16896
    ds_read_b64_tr_b16 v[124:125], v181 offset:17408
    ds_read_b64_tr_b16 v[126:127], v181 offset:17920
    v_mfma_f32_16x16x32_bf16 v[64:67], v[152:155], v[68:71], v[64:67]
    ds_read_b128 v[88:91], v178 offset:49152
    v_mfma_f32_32x32x16_bf16 v[48:63], v[100:103], v[156:159], v[48:63]
    ds_read_b64_tr_b16 v[128:129], v182 offset:16384
    ds_read_b64_tr_b16 v[130:131], v182 offset:16896
    ds_read_b64_tr_b16 v[132:133], v182 offset:17408
    v_mfma_f32_16x16x32_bf16 v[64:67], v[156:159], v[72:75], v[64:67]
    ds_read_b64_tr_b16 v[134:135], v182 offset:17920
    v_mfma_f32_32x32x16_bf16 v[32:47], v[160:163], v[104:107], v[32:47]
    ds_read_b64 v[2:3], v1 offset:0
    ds_read_b128 v[92:95], v179 offset:49152
    ds_read_b64_tr_b16 v[136:137], v183 offset:16384
    v_mfma_f32_32x32x16_bf16 v[48:63], v[104:107], v[164:167], v[48:63]
    ds_read_b64_tr_b16 v[138:139], v183 offset:16896
    ds_read_b64_tr_b16 v[140:141], v183 offset:17408
    ds_read_b64_tr_b16 v[142:143], v183 offset:17920
    v_mfma_f32_32x32x16_bf16 v[32:47], v[168:171], v[108:111], v[32:47]
    v_mfma_f32_32x32x16_bf16 v[48:63], v[108:111], v[172:175], v[48:63]
mrg_42:
    s_waitcnt lgkmcnt(5)
    v_min_u32 v2, v2, v3
    s_nop 0
    v_readfirstlane_b32 s30, v2
    s_cmp_lt_u32 s30, 8
    s_cbranch_scc1 slw_43
    v_mfma_f32_32x32x16_bf16 v[32:47], v[112:115], v[80:83], v[32:47]
    ds_read_b128 v[96:99], v176 offset:57344
    ds_read_b64_tr_b16 v[144:145], v180 offset:32768
    ds_read_b64_tr_b16 v[146:147], v180 offset:33280
    v_mfma_f32_16x16x32_bf16 v[64:67], v[112:115], v[68:71], v[64:67]
    ds_read_b64_tr_b16 v[148:149], v180 offset:33792
    v_mfma_f32_32x32x16_bf16 v[48:63], v[80:83], v[116:119], v[48:63]
    s_waitcnt lgkmcnt(4)
    v_mov_b32 v6, 7
    ds_write_b32 v4, v6 offset:16
    ds_read_b64_tr_b16 v[150:151], v180 offset:34304
    ds_read_b128 v[100:103], v177 offset:57344
    v_mfma_f32_16x16x32_bf16 v[64:67], v[116:119], v[72:75], v[64:67]
    ds_read_b64_tr_b16 v[152:153], v181 offset:32768
    v_mfma_f32_32x32x16_bf16 v[32:47], v[120:123], v[84:87], v[32:47]
    ds_read_b64_tr_b16 v[154:155], v181 offset:33280
    ds_read_b64_tr_b16 v[156:157], v181 offset:33792
    ds_read_b64_tr_b16 v[158:159], v181 offset:34304
    v_mfma_f32_16x16x32_bf16 v[64:67], v[120:123], v[68:71], v[64:67]
    ds_read_b128 v[104:107], v178 offset:57344
    v_mfma_f32_32x32x16_bf16 v[48:63], v[84:87], v[124:127], v[48:63]
    ds_read_b64_tr_b16 v[160:161], v182 offset:32768
    ds_read_b64_tr_b16 v[162:163], v182 offset:33280
    ds_read_b64_tr_b16 v[164:165], v182 offset:33792
    v_mfma_f32_16x16x32_bf16 v[64:67], v[124:127], v[72:75], v[64:67]
    ds_read_b64_tr_b16 v[166:167], v182 offset:34304
    v_mfma_f32_32x32x16_bf16 v[32:47], v[128:131], v[88:91], v[32:47]
    ds_read_b32 v2, v1 offset:172
    ds_read_b128 v[108:111], v179 offset:57344
    ds_read_b64_tr_b16 v[168:169], v183 offset:32768
    v_mfma_f32_32x32x16_bf16 v[48:63], v[88:91], v[132:135], v[48:63]
    s_nop 1
    ds_write_b128 v189, v[64:67]
    v_xor_b32 v78, 4, v4
    v_xor_b32 v5, 1024, v189
    ds_read_b64_tr_b16 v[170:171], v183 offset:33280
    ds_read_b64_tr_b16 v[172:173], v183 offset:33792
    ds_read_b64_tr_b16 v[174:175], v183 offset:34304
    v_mfma_f32_32x32x16_bf16 v[32:47], v[136:139], v[92:95], v[32:47]
    v_mfma_f32_32x32x16_bf16 v[48:63], v[92:95], v[140:143], v[48:63]
mrg_44:
    v_mov_b32 v6, 8
    ds_write_b32 v4, v6 offset:16
    s_waitcnt lgkmcnt(7)
    v_readfirstlane_b32 s30, v2
    v_mfma_f32_16x16x32_bf16 v[64:67], v[144:147], v[68:71], v[64:67]
    v_mfma_f32_16x16x32_bf16 v[64:67], v[148:151], v[72:75], v[64:67]
    s_cmp_lg_u32 s30, 0
    s_cbranch_scc1 sf_45
    s_mov_b32 s3, 0x10000
    s_nop 4
wl_46:
    ds_read_b32 v2, v1 offset:172
    s_waitcnt lgkmcnt(0)
    v_readfirstlane_b32 s30, v2
    s_cmp_ge_u32 s30, 5
    s_nop 3
    s_cbranch_scc1 wl_46d
    s_sub_u32 s3, s3, 1
    s_cbranch_scc0 wl_46
wl_46d:
sf_45:
    ds_read_b32 v10, v194
    ds_read_b32 v8, v194 offset:256
    ds_read_b32 v11, v194
    ds_read_b32 v9, v194 offset:256
    v_mfma_f32_16x16x32_bf16 v[64:67], v[152:155], v[68:71], v[64:67]
    v_mfma_f32_16x16x32_bf16 v[64:67], v[156:159], v[72:75], v[64:67]
    ds_read_b128 v[128:131], v195 offset:256
    ds_read_b128 v[132:135], v195 offset:288
    ds_read_b128 v[136:139], v195 offset:320
    ds_read_b128 v[140:143], v195 offset:352
    v_mfma_f32_16x16x32_bf16 v[64:67], v[160:163], v[68:71], v[64:67]
    v_mfma_f32_16x16x32_bf16 v[64:67], v[164:167], v[72:75], v[64:67]
    s_waitcnt lgkmcnt(9)
    v_mfma_f32_16x16x32_bf16 v[64:67], v[168:171], v[68:71], v[64:67]
    v_mfma_f32_16x16x32_bf16 v[64:67], v[172:175], v[72:75], v[64:67]
    ds_read_b128 v[112:115], v195 offset:0
    ds_read_b128 v[116:119], v195 offset:32
    ds_read_b128 v[120:123], v195 offset:64
    ds_read_b128 v[124:127], v195 offset:96
    v_mfma_f32_32x32x16_bf16 v[32:47], v[144:147], v[96:99], v[32:47]
    s_mov_b32 s3, 0x10000
cs_47:
    ds_read_b32 v2, v78 offset:16
    ds_read_b128 v[12:15], v5
    s_sub_u32 s3, s3, 1
    s_cbranch_scc1 cs_47d
    s_waitcnt lgkmcnt(0)
    v_readfirstlane_b32 s30, v2
    s_cmp_lt_u32 s30, 8
    s_cbranch_scc1 cs_47
cs_47d:
    v_mfma_f32_32x32x16_bf16 v[32:47], v[152:155], v[100:103], v[32:47]
    s_waitcnt lgkmcnt(0)
    v_add_f32 v12, v12, v64
    v_add_f32 v13, v13, v65
    v_add_f32 v14, v14, v66
    v_add_f32 v15, v15, v67
    ds_write_b128 v191, v[12:15]
    v_mfma_f32_32x32x16_bf16 v[32:47], v[160:163], v[104:107], v[32:47]
    ds_read_b128 v[16:19], v192 offset:128
    ds_read_b128 v[20:23], v192 offset:160
    ds_read_b128 v[24:27], v192 offset:192
    ds_read_b128 v[28:31], v192 offset:224
    ds_read_b32 v14, v193 offset:256
    ds_read_b64 v[2:3], v1 offset:0
    v_mfma_f32_32x32x16_bf16 v[32:47], v[168:171], v[108:111], v[32:47]
    v_lshrrev_b32 v13, 5, v0
    v_lshl_add_u32 v13, v13, 10, v7
    s_lshl_b32 s30, s35, 11
    v_xor_b32 v180, s30, v13
    v_xor_b32 v181, 2048, v180
    v_mfma_f32_32x32x16_bf16 v[48:63], v[96:99], v[148:151], v[48:63]
    v_xor_b32 v182, 4096, v180
    v_xor_b32 v183, 6144, v180
    v_and_b32 v12, 15, v0
    v_bfe_u32 v13, v0, 4, 1
    v_cmp_eq_u32 vcc, v12, v13
    v_mov_b32 v15, s39
    s_waitcnt lgkmcnt(0)
    v_mfma_f32_32x32x16_bf16 v[48:63], v[100:103], v[156:159], v[48:63]
    v_fmac_f32 v32, v16, v8
    v_fmac_f32 v33, v17, v8
    v_fmac_f32 v34, v18, v8
    v_fmac_f32 v35, v19, v8
    v_fmac_f32 v36, v20, v8
    v_fmac_f32 v37, v21, v8
    v_fmac_f32 v38, v22, v8
    v_mfma_f32_32x32x16_bf16 v[48:63], v[104:107], v[164:167], v[48:63]
    v_fmac_f32 v39, v23, v8
    v_fmac_f32 v40, v24, v8
    v_fmac_f32 v41, v25, v8
    v_fmac_f32 v42, v26, v8
    v_fmac_f32 v43, v27, v8
    v_fmac_f32 v44, v28, v8
    v_fmac_f32 v45, v29, v8
    v_mfma_f32_32x32x16_bf16 v[48:63], v[108:111], v[172:175], v[48:63]
    v_fmac_f32 v46, v30, v8
    v_fmac_f32 v47, v31, v8
    v_mul_f32 v32, v32, v10
    v_mul_f32 v33, v33, v10
    v_mul_f32 v34, v34, v10
    v_mul_f32 v35, v35, v10
    v_mul_f32 v36, v36, v10
    v_mul_f32 v37, v37, v10
    v_mul_f32 v38, v38, v10
    v_mul_f32 v39, v39, v10
    v_mul_f32 v40, v40, v10
    v_mul_f32 v41, v41, v10
    v_mul_f32 v42, v42, v10
    v_mul_f32 v43, v43, v10
    v_mul_f32 v44, v44, v10
    v_mul_f32 v45, v45, v10
    v_mul_f32 v46, v46, v10
    v_mul_f32 v47, v47, v10
    v_cvt_pk_bf16_f32 v240, v32, v33
    v_cvt_pk_bf16_f32 v241, v34, v35
    v_cvt_pk_bf16_f32 v242, v36, v37
    v_cvt_pk_bf16_f32 v243, v38, v39
    v_cvt_pk_bf16_f32 v244, v40, v41
    v_cvt_pk_bf16_f32 v245, v42, v43
    v_cvt_pk_bf16_f32 v246, v44, v45
    v_cvt_pk_bf16_f32 v247, v46, v47
    buffer_store_dwordx4 v[240:243], v188, s[40:43], s36 offen sc1
    buffer_store_dwordx4 v[244:247], v188, s[40:43], s37 offen sc1
    v_min_u32 v2, v2, v3
    v_cndmask_b32 v68, 0, v15, vcc
    v_cndmask_b32 v69, 0, v15, vcc
    v_cndmask_b32 v70, 0, v15, vcc
    v_cndmask_b32 v71, 0, v15, vcc
    v_readfirstlane_b32 s30, v2
    v_mov_b32 v15, v14
    s_cmp_ge_u32 s30, 9
    s_nop 2
    s_cbranch_scc1 q8_48
    s_mov_b32 s3, 0x10000
wl_49:
    ds_read_b64 v[2:3], v1 offset:0
    s_waitcnt lgkmcnt(0)
    v_min_u32 v2, v2, v3
    s_nop 0
    v_readfirstlane_b32 s30, v2
    s_cmp_ge_u32 s30, 9
    s_nop 3
    s_cbranch_scc1 wl_49d
    s_sub_u32 s3, s3, 1
    s_cbranch_scc0 wl_49
wl_49d:
q8_48:
    ds_read_b128 v[80:83], v176 offset:0
    ds_read_b64_tr_b16 v[144:145], v180 offset:49152
    ds_read_b64_tr_b16 v[146:147], v180 offset:49664
    ds_read_b128 v[84:87], v177 offset:0
    ds_read_b64_tr_b16 v[148:149], v181 offset:49152
    ds_read_b64_tr_b16 v[150:151], v181 offset:49664
    ds_read_b128 v[88:91], v178 offset:0
    ds_read_b64_tr_b16 v[152:153], v182 offset:49152
    ds_read_b64_tr_b16 v[154:155], v182 offset:49664
    ds_read_b128 v[92:95], v179 offset:0
    ds_read_b64_tr_b16 v[156:157], v183 offset:49152
    ds_read_b64_tr_b16 v[158:159], v183 offset:49664
    ds_read_b128 v[96:99], v176 offset:8192
    ds_read_b64_tr_b16 v[160:161], v180 offset:57344
    ds_read_b64_tr_b16 v[162:163], v180 offset:57856
    ds_read_b128 v[100:103], v177 offset:8192
    ds_read_b64_tr_b16 v[164:165], v181 offset:57344
    ds_read_b64_tr_b16 v[166:167], v181 offset:57856
    ds_read_b64 v[2:3], v1 offset:0
    ds_read_b128 v[104:107], v178 offset:8192
    ds_read_b64_tr_b16 v[168:169], v182 offset:57344
    ds_read_b64_tr_b16 v[170:171], v182 offset:57856
    ds_read_b128 v[108:111], v179 offset:8192
    ds_read_b64_tr_b16 v[172:173], v183 offset:57344
    ds_read_b64_tr_b16 v[174:175], v183 offset:57856
    v_add_u32 v180, 65536, v180
    v_add_u32 v181, 65536, v181
    v_add_u32 v182, 65536, v182
    v_add_u32 v183, 65536, v183
    v_pk_fma_f32 v[48:49], v[14:15], v[128:129], v[48:49]
    v_pk_fma_f32 v[50:51], v[14:15], v[130:131], v[50:51]
    v_pk_fma_f32 v[52:53], v[14:15], v[132:133], v[52:53]
    v_pk_fma_f32 v[54:55], v[14:15], v[134:135], v[54:55]
    v_pk_fma_f32 v[56:57], v[14:15], v[136:137], v[56:57]
    v_pk_fma_f32 v[58:59], v[14:15], v[138:139], v[58:59]
    v_pk_fma_f32 v[60:61], v[14:15], v[140:141], v[60:61]
    v_pk_fma_f32 v[62:63], v[14:15], v[142:143], v[62:63]
    v_pk_mul_f32 v[48:49], v[48:49], v[112:113]
    v_pk_mul_f32 v[50:51], v[50:51], v[114:115]
    v_pk_mul_f32 v[52:53], v[52:53], v[116:117]
    v_pk_mul_f32 v[54:55], v[54:55], v[118:119]
    v_pk_mul_f32 v[56:57], v[56:57], v[120:121]
    v_pk_mul_f32 v[58:59], v[58:59], v[122:123]
    v_pk_mul_f32 v[60:61], v[60:61], v[124:125]
    v_pk_mul_f32 v[62:63], v[62:63], v[126:127]
    v_cvt_pk_bf16_f32 v248, v48, v49
    v_cvt_pk_bf16_f32 v249, v50, v51
    v_cvt_pk_bf16_f32 v250, v52, v53
    v_cvt_pk_bf16_f32 v251, v54, v55
    v_cvt_pk_bf16_f32 v252, v56, v57
    v_cvt_pk_bf16_f32 v253, v58, v59
    v_cvt_pk_bf16_f32 v254, v60, v61
    v_cvt_pk_bf16_f32 v255, v62, v63
    buffer_store_dwordx4 v[248:251], v190, s[40:43], s38 offen sc1
    buffer_store_dwordx4 v[252:255], v190, s[40:43], s38 offen offset:512 sc1
    s_lshl_b32 s36, s33, 3
    s_mov_b32 s37, 0x00010001
    s_add_u32 s38, s36, 155840
    s_mov_b32 s36, s37
    s_waitcnt lgkmcnt(6)
    v_min_u32 v2, v2, v3
    s_nop 0
    v_readfirstlane_b32 s30, v2
    s_cmp_lt_u32 s30, 10
    s_cbranch_scc1 slw_50
    v_mfma_f32_32x32x16_bf16 v[16:31], v[144:147], v[80:83], 0
    v_add3_u32 v72, v248, v249, v250
    v_add3_u32 v73, v251, v252, v253
    v_add3_u32 v72, v72, v254, v255
    v_add_u32 v72, v72, v73
    v_lshrrev_b32 v12, 5, v0
    ds_read_b128 v[32:35], v176 offset:16384
    ds_read_b64_tr_b16 v[112:113], v180 offset:0
    ds_read_b64_tr_b16 v[114:115], v180 offset:512
    v_mfma_f32_16x16x32_bf16 v[64:67], v[144:147], v[68:71], 0
    v_cndmask_b32_e64 v73, v72, 0, s[10:11]
    v_cndmask_b32_e64 v72, 0, v72, s[10:11]
    ds_read_b128 v[36:39], v177 offset:16384
    v_mfma_f32_32x32x16_bf16 v[16:31], v[148:151], v[84:87], v[16:31]
    s_waitcnt lgkmcnt(4)
    v_mov_b32 v6, 9
    ds_write_b32 v4, v6 offset:16
    ds_read_b64_tr_b16 v[116:117], v181 offset:0
    ds_read_b64_tr_b16 v[118:119], v181 offset:512
    v_mfma_f32_16x16x32_bf16 v[64:67], v[148:151], v[68:71], v[64:67]
    v_add3_u32 v73, v73, v240, v241
    v_add3_u32 v72, v72, v244, v245
    ds_read_b128 v[40:43], v178 offset:16384
    v_mfma_f32_32x32x16_bf16 v[16:31], v[152:155], v[88:91], v[16:31]
    v_add3_u32 v73, v73, v242, v243
    v_add3_u32 v72, v72, v246, v247
    v_lshl_add_u32 v12, v12, 2, s38
    v_mov_b32 v14, 1
    ds_read_b64_tr_b16 v[120:121], v182 offset:0
    ds_read_b64_tr_b16 v[122:123], v182 offset:512
    ds_read_b128 v[44:47], v179 offset:16384
    v_mfma_f32_32x32x16_bf16 v[16:31], v[156:159], v[92:95], v[16:31]
    v_permlane32_swap_b32 v73, v72
    v_mul_f32 v10, 0x3eb8aa3b, v10
    v_add_u32 v73, v73, v72
    v_mul_f32 v11, 0x3eb8aa3b, v11
    ds_read_b64_tr_b16 v[124:125], v183 offset:0
    ds_read_b64_tr_b16 v[126:127], v183 offset:512
    ds_read_b128 v[48:51], v176 offset:24576
    v_mfma_f32_32x32x16_bf16 v[16:31], v[160:163], v[96:99], v[16:31]
    v_add_u32_dpp v73, v73, v73 quad_perm:[1,0,3,2] row_mask:0xf bank_mask:0xf
    ds_read_b64_tr_b16 v[128:129], v180 offset:8192
    ds_read_b64_tr_b16 v[130:131], v180 offset:8704
    ds_read_b128 v[52:55], v177 offset:24576
    v_mfma_f32_16x16x32_bf16 v[64:67], v[160:163], v[68:71], v[64:67]
    v_add_u32_dpp v73, v73, v73 quad_perm:[2,3,0,1] row_mask:0xf bank_mask:0xf
    ds_read_b64_tr_b16 v[132:133], v181 offset:8192
    v_mfma_f32_32x32x16_bf16 v[16:31], v[164:167], v[100:103], v[16:31]
    v_add_u32_dpp v73, v73, v73 row_half_mirror row_mask:0xf bank_mask:0xf
    ds_read_b64_tr_b16 v[134:135], v181 offset:8704
    ds_read_b64 v[2:3], v1 offset:0
    ds_read_b128 v[56:59], v178 offset:24576
    v_mfma_f32_16x16x32_bf16 v[64:67], v[164:167], v[68:71], v[64:67]
    v_add_u32_dpp v73, v73, v73 row_mirror row_mask:0xf bank_mask:0xf
    ds_read_b64_tr_b16 v[136:137], v182 offset:8192
    v_mfma_f32_32x32x16_bf16 v[16:31], v[168:171], v[104:107], v[16:31]
    s_mov_b64 exec, s[36:37]
    ds_add_u32 v12, v73
    s_mov_b64 exec, 1
    ds_add_u32 v1, v14 offset:160
    s_mov_b64 exec, -1
    ds_read_b64_tr_b16 v[138:139], v182 offset:8704
    ds_read_b128 v[60:63], v179 offset:24576
    ds_read_b64_tr_b16 v[140:141], v183 offset:8192
    v_mfma_f32_32x32x16_bf16 v[16:31], v[172:175], v[108:111], v[16:31]
    ds_read_b64_tr_b16 v[142:143], v183 offset:8704
    v_add_u32 v180, -65536, v180
    v_add_u32 v181, -65536, v181
    v_add_u32 v182, -65536, v182
    v_add_u32 v183, -65536, v183
mrg_51:
    s_waitcnt lgkmcnt(8)
    v_min_u32 v2, v2, v3
    s_nop 0
    v_readfirstlane_b32 s30, v2
    s_cmp_lt_u32 s30, 11
    s_cbranch_scc1 slw_52
    v_mfma_f32_32x32x16_bf16 v[16:31], v[112:115], v[32:35], v[16:31]
    ds_read_b32 v13, v1 offset:32
    ds_read_b128 v[80:83], v176 offset:32768
    ds_read_b64_tr_b16 v[144:145], v180 offset:0
    ds_read_b64_tr_b16 v[146:147], v180 offset:512
    v_mfma_f32_16x16x32_bf16 v[64:67], v[112:115], v[68:71], v[64:67]
    ds_read_b128 v[84:87], v177 offset:32768
    v_mfma_f32_32x32x16_bf16 v[16:31], v[116:119], v[36:39], v[16:31]
    s_waitcnt lgkmcnt(5)
    v_mov_b32 v6, 10
    ds_write_b32 v4, v6 offset:16
    ds_read_b64_tr_b16 v[148:149], v181 offset:0
    ds_read_b64_tr_b16 v[150:151], v181 offset:512
    v_mfma_f32_16x16x32_bf16 v[64:67], v[116:119], v[68:71], v[64:67]
    ds_read_b128 v[88:91], v178 offset:32768
    v_mfma_f32_32x32x16_bf16 v[16:31], v[120:123], v[40:43], v[16:31]
    ds_read_b64_tr_b16 v[152:153], v182 offset:0
    ds_read_b64_tr_b16 v[154:155], v182 offset:512
    ds_read_b128 v[92:95], v179 offset:32768
    v_mfma_f32_32x32x16_bf16 v[16:31], v[124:127], v[44:47], v[16:31]
    ds_read_b64_tr_b16 v[156:157], v183 offset:0
    ds_read_b64_tr_b16 v[158:159], v183 offset:512
    ds_read_b128 v[96:99], v176 offset:40960
    v_mfma_f32_32x32x16_bf16 v[16:31], v[128:131], v[48:51], v[16:31]
    ds_read_b64_tr_b16 v[160:161], v180 offset:8192
    ds_read_b64_tr_b16 v[162:163], v180 offset:8704
    ds_read_b128 v[100:103], v177 offset:40960
    v_mfma_f32_16x16x32_bf16 v[64:67], v[128:131], v[68:71], v[64:67]
    ds_read_b64_tr_b16 v[164:165], v181 offset:8192
    v_mfma_f32_32x32x16_bf16 v[16:31], v[132:135], v[52:55], v[16:31]
    ds_read_b64_tr_b16 v[166:167], v181 offset:8704
    ds_read_b64 v[2:3], v1 offset:0
    ds_read_b128 v[104:107], v178 offset:40960
    v_mfma_f32_16x16x32_bf16 v[64:67], v[132:135], v[68:71], v[64:67]
    ds_read_b64_tr_b16 v[168:169], v182 offset:8192
    v_mfma_f32_32x32x16_bf16 v[16:31], v[136:139], v[56:59], v[16:31]
    ds_read_b64_tr_b16 v[170:171], v182 offset:8704
    ds_read_b128 v[108:111], v179 offset:40960
    ds_read_b64_tr_b16 v[172:173], v183 offset:8192
    v_mfma_f32_32x32x16_bf16 v[16:31], v[140:143], v[60:63], v[16:31]
    ds_read_b64_tr_b16 v[174:175], v183 offset:8704
mrg_53:
    s_waitcnt lgkmcnt(6)
    v_min_u32 v2, v2, v3
    s_nop 0
    v_readfirstlane_b32 s30, v2
    s_cmp_lt_u32 s30, 12
    s_cbranch_scc1 slw_54
    v_mfma_f32_32x32x16_bf16 v[16:31], v[144:147], v[80:83], v[16:31]
    v_readfirstlane_b32 s29, v13
    s_cmp_lg_u32 s29, 0
    s_cbranch_scc1 ep_56
    s_mov_b32 s3, 0x10000
    s_nop 7
wl_57:
    ds_read_b32 v13, v1 offset:32
    s_waitcnt lgkmcnt(0)
    v_readfirstlane_b32 s29, v13
    s_cmp_ge_u32 s29, 1
    s_nop 3
    s_cbranch_scc1 wl_57d
    s_sub_u32 s3, s3, 1
    s_cbranch_scc0 wl_57
wl_57d:
ep_56:
    ds_read_b128 v[32:35], v176 offset:49152
    ds_read_b64_tr_b16 v[112:113], v180 offset:16384
    ds_read_b64_tr_b16 v[114:115], v180 offset:16896
    v_mfma_f32_16x16x32_bf16 v[64:67], v[144:147], v[68:71], v[64:67]
    ds_read_b128 v[36:39], v177 offset:49152
    v_mfma_f32_32x32x16_bf16 v[16:31], v[148:151], v[84:87], v[16:31]
    s_waitcnt lgkmcnt(4)
    v_mov_b32 v6, 11
    ds_write_b32 v4, v6 offset:16
    ds_read_b64_tr_b16 v[116:117], v181 offset:16384
    ds_read_b64_tr_b16 v[118:119], v181 offset:16896
    v_mfma_f32_16x16x32_bf16 v[64:67], v[148:151], v[68:71], v[64:67]
    ds_read_b128 v[40:43], v178 offset:49152
    v_mfma_f32_32x32x16_bf16 v[16:31], v[152:155], v[88:91], v[16:31]
    ds_read_b64_tr_b16 v[120:121], v182 offset:16384
    ds_read_b64_tr_b16 v[122:123], v182 offset:16896
    ds_read_b128 v[44:47], v179 offset:49152
    v_mfma_f32_32x32x16_bf16 v[16:31], v[156:159], v[92:95], v[16:31]
    ds_read_b64_tr_b16 v[124:125], v183 offset:16384
    ds_read_b64_tr_b16 v[126:127], v183 offset:16896
    ds_read_b128 v[48:51], v176 offset:57344
    v_mfma_f32_32x32x16_bf16 v[16:31], v[160:163], v[96:99], v[16:31]
    ds_read_b64_tr_b16 v[128:129], v180 offset:24576
    ds_read_b64_tr_b16 v[130:131], v180 offset:25088
    ds_read_b128 v[52:55], v177 offset:57344
    v_mfma_f32_16x16x32_bf16 v[64:67], v[160:163], v[68:71], v[64:67]
    ds_read_b64_tr_b16 v[132:133], v181 offset:24576
    v_mfma_f32_32x32x16_bf16 v[16:31], v[164:167], v[100:103], v[16:31]
    ds_read_b64_tr_b16 v[134:135], v181 offset:25088
    ds_read_b128 v[56:59], v178 offset:57344
    ds_read_b64_tr_b16 v[136:137], v182 offset:24576
    v_mfma_f32_16x16x32_bf16 v[64:67], v[164:167], v[68:71], v[64:67]
    ds_read_b64_tr_b16 v[138:139], v182 offset:25088
    v_mfma_f32_32x32x16_bf16 v[16:31], v[168:171], v[104:107], v[16:31]
    ds_read_b128 v[60:63], v179 offset:57344
    ds_read_b64_tr_b16 v[140:141], v183 offset:24576
    ds_read_b64_tr_b16 v[142:143], v183 offset:25088
    v_mfma_f32_32x32x16_bf16 v[16:31], v[172:175], v[108:111], v[16:31]
    s_nop 1
    ds_write_b128 v189, v[64:67] offset:12288
mrg_55:
    v_mov_b32 v6, 12
    ds_write_b32 v4, v6 offset:16
    s_waitcnt lgkmcnt(8)
    v_mfma_f32_16x16x32_bf16 v[64:67], v[112:115], v[68:71], v[64:67]
    v_mfma_f32_16x16x32_bf16 v[64:67], v[116:119], v[68:71], v[64:67]
    v_mfma_f32_16x16x32_bf16 v[64:67], v[120:123], v[68:71], v[64:67]
    v_mfma_f32_16x16x32_bf16 v[64:67], v[124:127], v[68:71], v[64:67]
    v_mfma_f32_16x16x32_bf16 v[64:67], v[128:131], v[68:71], v[64:67]
    v_mfma_f32_16x16x32_bf16 v[64:67], v[132:135], v[68:71], v[64:67]
    s_waitcnt lgkmcnt(2)
    v_mfma_f32_16x16x32_bf16 v[64:67], v[136:139], v[68:71], v[64:67]
    v_mfma_f32_16x16x32_bf16 v[64:67], v[140:143], v[68:71], v[64:67]
    v_mfma_f32_32x32x16_bf16 v[16:31], v[112:115], v[32:35], v[16:31]
    s_mov_b32 s3, 0x10000
cq_58:
    ds_read_b128 v[76:79], v1 offset:16
    ds_read_b128 v[12:15], v5 offset:12288
    s_sub_u32 s3, s3, 1
    s_cbranch_scc1 cq_58d
    s_waitcnt lgkmcnt(0)
    v_min_u32 v76, v76, v77
    v_min3_u32 v76, v76, v78, v79
    s_nop 0
    v_readfirstlane_b32 s30, v76
    s_cmp_lt_u32 s30, 12
    s_cbranch_scc1 cq_58
cq_58d:
    v_mfma_f32_32x32x16_bf16 v[16:31], v[116:119], v[36:39], v[16:31]
    s_waitcnt lgkmcnt(0)
    v_add_f32 v12, v12, v64
    v_add_f32 v13, v13, v65
    v_add_f32 v14, v14, v66
    v_add_f32 v15, v15, v67
    ds_write_b128 v191, v[12:15]
    v_mfma_f32_32x32x16_bf16 v[16:31], v[120:123], v[40:43], v[16:31]
    ds_read_b128 v[80:83], v192 offset:0
    ds_read_b128 v[84:87], v192 offset:32
    ds_read_b128 v[88:91], v192 offset:64
    ds_read_b128 v[92:95], v192 offset:96
    s_lshl_b32 s36, s33, 12
    s_lshl_b32 s30, s32, 10
    s_add_u32 s36, s36, s30
    s_add_u32 s30, s36, 98304
    v_add_u32 v12, s30, v188
    v_mfma_f32_32x32x16_bf16 v[16:31], v[124:127], v[44:47], v[16:31]
    ds_write_b128 v12, v[240:243] offset:8192
    ds_write_b128 v12, v[244:247] offset:10240
    v_lshrrev_b32 v13, 5, v190
    v_and_b32 v13, 0x800, v13
    v_and_b32 v14, 0x1ff, v190
    s_add_u32 s30, s36, 114688
    v_add3_u32 v13, v13, v14, s30
    v_mfma_f32_32x32x16_bf16 v[16:31], v[128:131], v[48:51], v[16:31]
    ds_write_b128 v13, v[248:251]
    ds_write_b128 v13, v[252:255] offset:512
    v_mfma_f32_32x32x16_bf16 v[16:31], v[132:135], v[52:55], v[16:31]
    s_lshl_b32 s36, s28, 11
    s_add_u32 s30, s36, 98304
    v_add_u32 v13, s30, v188
    s_add_u32 s30, s36, 114688
    v_add_u32 v7, s30, v14
    v_mfma_f32_32x32x16_bf16 v[16:31], v[136:139], v[56:59], v[16:31]
    v_mfma_f32_32x32x16_bf16 v[16:31], v[140:143], v[60:63], v[16:31]
    s_mov_b64 exec, s[10:11]
    s_cmp_ge_u32 s27, 4
    s_cselect_b32 s30, s39, 0
    s_mov_b32 s31, s30
    v_mov_b64 v[176:177], s[30:31]
    v_mov_b64 v[178:179], s[30:31]
    v_mov_b64 v[180:181], s[30:31]
    v_mov_b64 v[182:183], s[30:31]
    v_mov_b64 v[184:185], s[30:31]
    v_mov_b64 v[186:187], s[30:31]
    v_mov_b64 v[188:189], s[30:31]
    v_mov_b64 v[190:191], s[30:31]
    s_cmp_ge_u32 s27, 3
    s_cselect_b32 s30, s39, 0
    s_mov_b32 s31, s30
    v_mov_b64 v[192:193], s[30:31]
    v_mov_b64 v[194:195], s[30:31]
    v_mov_b64 v[196:197], s[30:31]
    v_mov_b64 v[198:199], s[30:31]
    s_waitcnt lgkmcnt(0)
    s_cmp_ge_u32 s27, 0
    s_cselect_b32 s30, s39, 0
    s_mov_b32 s31, s30
    v_mov_b64 v[240:241], s[30:31]
    v_mov_b64 v[242:243], s[30:31]
    v_mov_b64 v[244:245], s[30:31]
    v_mov_b64 v[246:247], s[30:31]
    v_mov_b64 v[248:249], s[30:31]
    v_mov_b64 v[250:251], s[30:31]
    v_mov_b64 v[252:253], s[30:31]
    v_mov_b64 v[254:255], s[30:31]
    s_mov_b64 exec, -1
    v_pk_fma_f32 v[16:17], v[80:81], v[8:9], v[16:17]
    v_pk_fma_f32 v[18:19], v[82:83], v[8:9], v[18:19]
    v_pk_fma_f32 v[20:21], v[84:85], v[8:9], v[20:21]
    v_pk_fma_f32 v[22:23], v[86:87], v[8:9], v[22:23]
    v_pk_fma_f32 v[24:25], v[88:89], v[8:9], v[24:25]
    v_pk_fma_f32 v[26:27], v[90:91], v[8:9], v[26:27]
    v_pk_fma_f32 v[28:29], v[92:93], v[8:9], v[28:29]
    v_pk_fma_f32 v[30:31], v[94:95], v[8:9], v[30:31]
    v_pk_mul_f32 v[16:17], v[16:17], v[10:11]
    v_pk_mul_f32 v[18:19], v[18:19], v[10:11]
    v_pk_mul_f32 v[20:21], v[20:21], v[10:11]
    v_pk_mul_f32 v[22:23], v[22:23], v[10:11]
    v_pk_mul_f32 v[24:25], v[24:25], v[10:11]
    v_pk_mul_f32 v[26:27], v[26:27], v[10:11]
    v_pk_mul_f32 v[28:29], v[28:29], v[10:11]
    v_pk_mul_f32 v[30:31], v[30:31], v[10:11]
    v_cvt_pk_bf16_f32 v16, v16, v17
    v_cvt_pk_bf16_f32 v17, v18, v19
    v_cvt_pk_bf16_f32 v18, v20, v21
    v_cvt_pk_bf16_f32 v19, v22, v23
    v_cvt_pk_bf16_f32 v20, v24, v25
    v_cvt_pk_bf16_f32 v21, v26, v27
    v_cvt_pk_bf16_f32 v22, v28, v29
    v_cvt_pk_bf16_f32 v23, v30, v31
    ds_write_b128 v12, v[16:19]
    ds_write_b128 v12, v[20:23] offset:2048
    v_mov_b32 v6, 13
    ds_write_b32 v4, v6 offset:16
    v_lshlrev_b32 v168, 4, v0
    v_lshrrev_b32 v2, 5, v0
    v_lshlrev_b32 v2, 8, v2
    v_and_b32 v3, 15, v0
    v_lshl_add_u32 v2, v3, 4, v2
    v_add_u32 v169, 2097152, v2
    v_mov_b32 v3, 0xffff
    v_mov_b32 v5, 0xffff0000
    v_cndmask_b32_e64 v6, 0, v3, s[44:45]
    v_cndmask_b32_e64 v2, 0, v5, s[46:47]
    v_or_b32 v152, v6, v2
    v_cndmask_b32_e64 v6, 0, v3, s[48:49]
    v_cndmask_b32_e64 v2, 0, v5, s[50:51]
    v_or_b32 v153, v6, v2
    v_cndmask_b32_e64 v6, 0, v3, s[52:53]
    v_cndmask_b32_e64 v2, 0, v5, s[54:55]
    v_or_b32 v154, v6, v2
    v_cndmask_b32_e64 v6, 0, v3, s[56:57]
    v_cndmask_b32_e64 v2, 0, v5, s[58:59]
    v_or_b32 v155, v6, v2
    v_cndmask_b32_e64 v6, 0, v3, s[60:61]
    v_cndmask_b32_e64 v2, 0, v5, s[62:63]
    v_or_b32 v156, v6, v2
    v_cndmask_b32_e64 v6, 0, v3, s[64:65]
    v_cndmask_b32_e64 v2, 0, v5, s[66:67]
    v_or_b32 v157, v6, v2
    v_cndmask_b32_e64 v6, 0, v3, s[68:69]
    v_cndmask_b32_e64 v2, 0, v5, s[70:71]
    v_or_b32 v158, v6, v2
    v_cndmask_b32_e64 v6, 0, v3, s[72:73]
    v_cndmask_b32_e64 v2, 0, v5, s[74:75]
    v_or_b32 v159, v6, v2
    s_lshl_b32 s30, s26, 2
    s_add_u32 s30, s30, s28
    s_lshl_b32 s36, s30, 16
    s_lshl_b32 s38, s27, 11
    s_add_u32 s36, s36, s38
    s_sub_u32 s32, s36, 8192
    s_cmp_ge_u32 s27, 4
    s_cselect_b32 s32, s32, 2146435072
    s_sub_u32 s33, s36, 6144
    s_cmp_ge_u32 s27, 3
    s_cselect_b32 s33, s33, 2146435072
    s_sub_u32 s34, s36, 4096
    s_cmp_ge_u32 s27, 2
    s_cselect_b32 s34, s34, 2146435072
    s_sub_u32 s35, s36, 2048
    s_cmp_ge_u32 s27, 1
    s_cselect_b32 s35, s35, 2146435072
    v_lshlrev_b32 v170, 10, v0
    s_lshl_b32 s3, s26, 6
    s_lshl_b32 s38, s38, 2
    s_add_u32 s3, s3, s38
    s_add_u32 s3, s3, 7405568
    v_add_u32 v170, s3, v170
    s_lshl_b32 s37, s27, 16
    s_lshl_b32 s38, s30, 10
    s_add_u32 s37, s37, s38
    s_add_u32 s37, s37, 4194304
    s_add_u32 s38, s37, 32768
    v_xor_b32 v3, 4, v4
    s_mov_b32 s3, 0x10000
    s_nop 0
wl_59:
    ds_read_b32 v5, v3 offset:16
    s_waitcnt lgkmcnt(0)
    v_readfirstlane_b32 s30, v5
    s_cmp_ge_u32 s30, 13
    s_nop 3
    s_cbranch_scc1 wl_59d
    s_sub_u32 s3, s3, 1
    s_cbranch_scc0 wl_59
wl_59d:
    ds_read_b128 v[48:51], v13 offset:8192
    ds_read_b128 v[52:55], v13 offset:9216
    ds_read_b128 v[8:11], v13
    ds_read_b128 v[12:15], v13 offset:1024
    s_mov_b32 s10, 0x0000ffff
    s_mov_b32 s11, 0x0000ffff
    s_mov_b64 exec, s[10:11]
    ds_read_b128 v[240:243], v7 offset:0
    ds_read_b128 v[244:247], v7 offset:512
    ds_read_b128 v[248:251], v7 offset:1024
    ds_read_b128 v[252:255], v7 offset:1536
    s_mov_b64 exec, -1
    s_lshl_b32 s30, s28, 3
    v_add_u32 v3, s30, v1
    s_mov_b32 s3, 0x10000
    s_nop 0
kv_60:
    ds_read_b64 v[6:7], v3 offset:208
    s_waitcnt lgkmcnt(0)
    v_readfirstlane_b32 s30, v6
    s_cmp_lg_u32 s30, 0
    s_nop 3
    s_cbranch_scc1 kv_60d
    s_sub_u32 s3, s3, 1
    s_cbranch_scc0 kv_60
kv_60d:
    buffer_load_dwordx4 v[16:19], v168, s[40:43], s32 offen offset:0 sc1
    buffer_load_dwordx4 v[44:47], v168, s[40:43], s35 offen offset:1024 sc1
    buffer_load_dwordx4 v[40:43], v168, s[40:43], s35 offen offset:0 sc1
    s_mov_b64 exec, s[10:11]
    buffer_load_dwordx4 v[176:179], v169, s[40:43], s32 offen offset:0 sc1
    buffer_load_dwordx4 v[180:183], v169, s[40:43], s32 offen offset:512 sc1
    s_mov_b64 exec, -1
    buffer_load_dwordx4 v[36:39], v168, s[40:43], s34 offen offset:1024 sc1
    s_mov_b64 exec, s[10:11]
    buffer_load_dwordx4 v[232:235], v169, s[40:43], s35 offen offset:1024 sc1
    buffer_load_dwordx4 v[236:239], v169, s[40:43], s35 offen offset:1536 sc1
    s_mov_b64 exec, -1
    v_readfirstlane_b32 s36, v7
    v_mov_b32 v5, 0
    v_mov_b32 v6, 0
    s_mov_b32 s30, 0
    v_mfma_f32_32x32x16_bf16 v[104:119], v[48:51], v[12:15], 0
    v_mfma_f32_32x32x16_bf16 v[120:135], v[48:51], v[8:11], 0
    buffer_load_dwordx4 v[32:35], v168, s[40:43], s34 offen offset:0 sc1
    s_mov_b64 exec, s[10:11]
    buffer_load_dwordx4 v[224:227], v169, s[40:43], s35 offen offset:0 sc1
    buffer_load_dwordx4 v[228:231], v169, s[40:43], s35 offen offset:512 sc1
    s_mov_b64 exec, -1
    s_nop 5
    v_exp_f32 v104, v104
    v_exp_f32 v105, v105
    v_exp_f32 v106, v106
    v_exp_f32 v107, v107
    v_exp_f32 v108, v108
    v_exp_f32 v109, v109
    v_exp_f32 v110, v110
    v_exp_f32 v111, v111
    v_exp_f32 v112, v112
    v_exp_f32 v113, v113
    v_exp_f32 v114, v114
    v_exp_f32 v115, v115
    v_exp_f32 v116, v116
    v_exp_f32 v117, v117
    v_exp_f32 v118, v118
    v_exp_f32 v119, v119
    v_cvt_pk_bf16_f32 v104, v104, v105
    v_cvt_pk_bf16_f32 v105, v106, v107
    v_cvt_pk_bf16_f32 v106, v108, v109
    v_cvt_pk_bf16_f32 v107, v110, v111
    v_cvt_pk_bf16_f32 v108, v112, v113
    v_cvt_pk_bf16_f32 v109, v114, v115
    v_cvt_pk_bf16_f32 v110, v116, v117
    v_cvt_pk_bf16_f32 v111, v118, v119
    buffer_load_dwordx4 v[28:31], v168, s[40:43], s33 offen offset:1024 sc1
    s_mov_b64 exec, s[10:11]
    buffer_load_dwordx4 v[216:219], v169, s[40:43], s34 offen offset:1024 sc1
    buffer_load_dwordx4 v[220:223], v169, s[40:43], s34 offen offset:1536 sc1
    s_mov_b64 exec, -1
    s_waitcnt vmcnt(13)
    v_mfma_f32_32x32x16_bf16 v[136:151], v[16:19], v[8:11], 0
    s_waitcnt vmcnt(12)
    v_mfma_f32_32x32x16_bf16 v[56:71], v[44:47], v[8:11], 0
    v_add3_u32 v5, v5, v16, v17
    v_add3_u32 v5, v5, v18, v19
    v_add3_u32 v5, v5, v44, v45
    v_add3_u32 v5, v5, v46, v47
    v_mfma_f32_32x32x16_bf16 v[88:103], v[240:243], v[104:107], 0
    v_mfma_f32_32x32x16_bf16 v[88:103], v[244:247], v[108:111], v[88:103]
    s_nop 3
    v_cndmask_b32_e64 v120, v136, v120, s[44:45]
    v_cndmask_b32_e64 v121, v137, v121, s[46:47]
    v_cndmask_b32_e64 v122, v138, v122, s[48:49]
    v_cndmask_b32_e64 v123, v139, v123, s[50:51]
    v_cndmask_b32_e64 v124, v140, v124, s[52:53]
    v_cndmask_b32_e64 v125, v141, v125, s[54:55]
    v_cndmask_b32_e64 v126, v142, v126, s[56:57]
    v_cndmask_b32_e64 v127, v143, v127, s[58:59]
    v_cndmask_b32_e64 v128, v144, v128, s[60:61]
    v_cndmask_b32_e64 v129, v145, v129, s[62:63]
    v_cndmask_b32_e64 v130, v146, v130, s[64:65]
    v_cndmask_b32_e64 v131, v147, v131, s[66:67]
    v_cndmask_b32_e64 v132, v148, v132, s[68:69]
    v_cndmask_b32_e64 v133, v149, v133, s[70:71]
    v_cndmask_b32_e64 v134, v150, v134, s[72:73]
    v_cndmask_b32_e64 v135, v151, v135, s[74:75]
    v_exp_f32 v120, v120
    v_exp_f32 v121, v121
    v_exp_f32 v122, v122
    v_exp_f32 v123, v123
    v_exp_f32 v124, v124
    v_exp_f32 v125, v125
    v_exp_f32 v126, v126
    v_exp_f32 v127, v127
    s_waitcnt vmcnt(11)
    v_mfma_f32_32x32x16_bf16 v[136:151], v[40:43], v[8:11], 0
    v_add3_u32 v5, v5, v40, v41
    v_add3_u32 v5, v5, v42, v43
    buffer_load_dwordx4 v[24:27], v168, s[40:43], s33 offen offset:0 sc1
    v_exp_f32 v128, v128
    v_exp_f32 v129, v129
    v_exp_f32 v130, v130
    v_exp_f32 v131, v131
    v_exp_f32 v132, v132
    v_exp_f32 v133, v133
    v_exp_f32 v134, v134
    v_exp_f32 v135, v135
    v_cvt_pk_bf16_f32 v120, v120, v121
    v_cvt_pk_bf16_f32 v121, v122, v123
    v_cvt_pk_bf16_f32 v122, v124, v125
    v_cvt_pk_bf16_f32 v123, v126, v127
    v_cvt_pk_bf16_f32 v124, v128, v129
    v_cvt_pk_bf16_f32 v125, v130, v131
    v_cvt_pk_bf16_f32 v126, v132, v133
    v_cvt_pk_bf16_f32 v127, v134, v135
    v_and_b32 v128, v120, v152
    v_and_b32 v129, v121, v153
    v_and_b32 v130, v122, v154
    v_and_b32 v131, v123, v155
    v_and_b32 v132, v124, v156
    v_and_b32 v133, v125, v157
    v_and_b32 v134, v126, v158
    v_and_b32 v135, v127, v159
    v_xor_b32 v120, v120, v128
    v_xor_b32 v121, v121, v129
    v_xor_b32 v122, v122, v130
    v_xor_b32 v123, v123, v131
    v_xor_b32 v124, v124, v132
    v_xor_b32 v125, v125, v133
    v_xor_b32 v126, v126, v134
    v_xor_b32 v127, v127, v135
    v_exp_f32 v56, v56
    v_exp_f32 v57, v57
    v_mfma_f32_32x32x16_bf16 v[72:87], v[240:243], v[128:131], 0
    s_mov_b64 exec, s[10:11]
    buffer_load_dwordx4 v[208:211], v169, s[40:43], s34 offen offset:0 sc1
    buffer_load_dwordx4 v[212:215], v169, s[40:43], s34 offen offset:512 sc1
    s_mov_b64 exec, -1
    v_exp_f32 v58, v58
    v_exp_f32 v59, v59
    v_mfma_f32_32x32x16_bf16 v[72:87], v[244:247], v[132:135], v[72:87]
    buffer_load_dwordx4 v[20:23], v168, s[40:43], s32 offen offset:1024 sc1
    v_exp_f32 v60, v60
    v_exp_f32 v61, v61
    s_waitcnt vmcnt(13)
    v_mfma_f32_32x32x16_bf16 v[72:87], v[176:179], v[120:123], v[72:87]
    v_add3_u32 v6, v6, v176, v177
    v_add3_u32 v6, v6, v178, v179
    v_add3_u32 v6, v6, v180, v181
    v_add3_u32 v6, v6, v182, v183
    v_exp_f32 v62, v62
    v_exp_f32 v63, v63
    v_mfma_f32_32x32x16_bf16 v[72:87], v[180:183], v[124:127], v[72:87]
    v_exp_f32 v64, v64
    v_exp_f32 v65, v65
    s_waitcnt vmcnt(12)
    v_mfma_f32_32x32x16_bf16 v[104:119], v[36:39], v[8:11], 0
    v_add3_u32 v5, v5, v36, v37
    v_add3_u32 v5, v5, v38, v39
    v_exp_f32 v66, v66
    v_exp_f32 v67, v67
    v_exp_f32 v68, v68
    v_exp_f32 v69, v69
    v_exp_f32 v70, v70
    v_exp_f32 v71, v71
    v_cvt_pk_bf16_f32 v56, v56, v57
    v_cvt_pk_bf16_f32 v57, v58, v59
    v_cvt_pk_bf16_f32 v58, v60, v61
    v_cvt_pk_bf16_f32 v59, v62, v63
    v_cvt_pk_bf16_f32 v60, v64, v65
    v_cvt_pk_bf16_f32 v61, v66, v67
    v_cvt_pk_bf16_f32 v62, v68, v69
    v_cvt_pk_bf16_f32 v63, v70, v71
    v_exp_f32 v136, v136
    v_exp_f32 v137, v137
    v_exp_f32 v138, v138
    v_exp_f32 v139, v139
    s_waitcnt vmcnt(10)
    v_mfma_f32_32x32x16_bf16 v[72:87], v[232:235], v[56:59], v[72:87]
    v_add3_u32 v6, v6, v232, v233
    v_add3_u32 v6, v6, v234, v235
    v_add3_u32 v6, v6, v236, v237
    v_add3_u32 v6, v6, v238, v239
    s_mov_b64 exec, s[10:11]
    buffer_load_dwordx4 v[200:203], v169, s[40:43], s33 offen offset:1024 sc1
    buffer_load_dwordx4 v[204:207], v169, s[40:43], s33 offen offset:1536 sc1
    s_mov_b64 exec, -1
    v_exp_f32 v140, v140
    v_exp_f32 v141, v141
    v_exp_f32 v142, v142
    v_exp_f32 v143, v143
    v_mfma_f32_32x32x16_bf16 v[72:87], v[236:239], v[60:63], v[72:87]
    s_mov_b64 exec, s[10:11]
    buffer_load_dwordx4 v[192:195], v169, s[40:43], s33 offen offset:0 sc1
    buffer_load_dwordx4 v[196:199], v169, s[40:43], s33 offen offset:512 sc1
    s_mov_b64 exec, -1
    v_exp_f32 v144, v144
    v_exp_f32 v145, v145
    v_exp_f32 v146, v146
    v_exp_f32 v147, v147
    s_waitcnt vmcnt(13)
    v_mfma_f32_32x32x16_bf16 v[120:135], v[32:35], v[8:11], 0
    v_add3_u32 v5, v5, v32, v33
    v_add3_u32 v5, v5, v34, v35
    v_exp_f32 v148, v148
    v_exp_f32 v149, v149
    v_exp_f32 v150, v150
    v_exp_f32 v151, v151
    v_cvt_pk_bf16_f32 v136, v136, v137
    v_cvt_pk_bf16_f32 v137, v138, v139
    v_cvt_pk_bf16_f32 v138, v140, v141
    v_cvt_pk_bf16_f32 v139, v142, v143
    v_cvt_pk_bf16_f32 v140, v144, v145
    v_cvt_pk_bf16_f32 v141, v146, v147
    v_cvt_pk_bf16_f32 v142, v148, v149
    v_cvt_pk_bf16_f32 v143, v150, v151
    v_exp_f32 v104, v104
    v_exp_f32 v105, v105
    v_exp_f32 v106, v106
    v_exp_f32 v107, v107
    s_waitcnt vmcnt(11)
    v_mfma_f32_32x32x16_bf16 v[72:87], v[224:227], v[136:139], v[72:87]
    v_add3_u32 v6, v6, v224, v225
    v_add3_u32 v6, v6, v226, v227
    v_add3_u32 v6, v6, v228, v229
    v_add3_u32 v6, v6, v230, v231
    s_mov_b64 exec, s[10:11]
    buffer_load_dwordx4 v[184:187], v169, s[40:43], s32 offen offset:1024 sc1
    buffer_load_dwordx4 v[188:191], v169, s[40:43], s32 offen offset:1536 sc1
    s_mov_b64 exec, -1
    v_mov_b32 v2, 15
    ds_write_b32 v4, v2 offset:16
    v_exp_f32 v108, v108
    v_exp_f32 v109, v109
    v_exp_f32 v110, v110
    v_exp_f32 v111, v111
    v_mfma_f32_32x32x16_bf16 v[72:87], v[228:231], v[140:143], v[72:87]
    v_exp_f32 v112, v112
    v_exp_f32 v113, v113
    v_exp_f32 v114, v114
    v_exp_f32 v115, v115
    s_waitcnt vmcnt(12)
    v_mfma_f32_32x32x16_bf16 v[56:71], v[28:31], v[8:11], 0
    v_add3_u32 v5, v5, v28, v29
    v_add3_u32 v5, v5, v30, v31
    v_exp_f32 v116, v116
    v_exp_f32 v117, v117
    v_exp_f32 v118, v118
    v_exp_f32 v119, v119
    v_cvt_pk_bf16_f32 v104, v104, v105
    v_cvt_pk_bf16_f32 v105, v106, v107
    v_cvt_pk_bf16_f32 v106, v108, v109
    v_cvt_pk_bf16_f32 v107, v110, v111
    v_cvt_pk_bf16_f32 v108, v112, v113
    v_cvt_pk_bf16_f32 v109, v114, v115
    v_cvt_pk_bf16_f32 v110, v116, v117
    v_cvt_pk_bf16_f32 v111, v118, v119
    v_exp_f32 v120, v120
    v_exp_f32 v121, v121
    v_exp_f32 v122, v122
    v_exp_f32 v123, v123
    s_waitcnt vmcnt(10)
    v_mfma_f32_32x32x16_bf16 v[72:87], v[216:219], v[104:107], v[72:87]
    v_add3_u32 v6, v6, v216, v217
    v_add3_u32 v6, v6, v218, v219
    v_add3_u32 v6, v6, v220, v221
    v_add3_u32 v6, v6, v222, v223
    v_exp_f32 v124, v124
    v_exp_f32 v125, v125
    v_exp_f32 v126, v126
    v_exp_f32 v127, v127
    v_mfma_f32_32x32x16_bf16 v[72:87], v[220:223], v[108:111], v[72:87]
    v_exp_f32 v128, v128
    v_exp_f32 v129, v129
    v_exp_f32 v130, v130
    v_exp_f32 v131, v131
    s_waitcnt vmcnt(9)
    v_mfma_f32_32x32x16_bf16 v[136:151], v[24:27], v[8:11], 0
    v_add3_u32 v5, v5, v24, v25
    v_add3_u32 v5, v5, v26, v27
    v_exp_f32 v132, v132
    v_exp_f32 v133, v133
    v_exp_f32 v134, v134
    v_exp_f32 v135, v135
    v_cvt_pk_bf16_f32 v120, v120, v121
    v_cvt_pk_bf16_f32 v121, v122, v123
    v_cvt_pk_bf16_f32 v122, v124, v125
    v_cvt_pk_bf16_f32 v123, v126, v127
    v_cvt_pk_bf16_f32 v124, v128, v129
    v_cvt_pk_bf16_f32 v125, v130, v131
    v_cvt_pk_bf16_f32 v126, v132, v133
    v_cvt_pk_bf16_f32 v127, v134, v135
    v_exp_f32 v56, v56
    v_exp_f32 v57, v57
    v_exp_f32 v58, v58
    v_exp_f32 v59, v59
    s_waitcnt vmcnt(7)
    v_mfma_f32_32x32x16_bf16 v[72:87], v[208:211], v[120:123], v[72:87]
    v_add3_u32 v6, v6, v208, v209
    v_add3_u32 v6, v6, v210, v211
    v_add3_u32 v6, v6, v212, v213
    v_add3_u32 v6, v6, v214, v215
    v_exp_f32 v60, v60
    v_exp_f32 v61, v61
    v_exp_f32 v62, v62
    v_exp_f32 v63, v63
    v_mfma_f32_32x32x16_bf16 v[72:87], v[212:215], v[124:127], v[72:87]
    v_exp_f32 v64, v64
    v_exp_f32 v65, v65
    v_exp_f32 v66, v66
    v_exp_f32 v67, v67
    s_waitcnt vmcnt(6)
    v_mfma_f32_32x32x16_bf16 v[104:119], v[20:23], v[8:11], 0
    v_add3_u32 v5, v5, v20, v21
    v_add3_u32 v5, v5, v22, v23
    v_exp_f32 v68, v68
    v_exp_f32 v69, v69
    v_exp_f32 v70, v70
    v_exp_f32 v71, v71
    v_cvt_pk_bf16_f32 v56, v56, v57
    v_cvt_pk_bf16_f32 v57, v58, v59
    v_cvt_pk_bf16_f32 v58, v60, v61
    v_cvt_pk_bf16_f32 v59, v62, v63
    v_cvt_pk_bf16_f32 v60, v64, v65
    v_cvt_pk_bf16_f32 v61, v66, v67
    v_cvt_pk_bf16_f32 v62, v68, v69
    v_cvt_pk_bf16_f32 v63, v70, v71
    v_exp_f32 v136, v136
    v_exp_f32 v137, v137
    v_exp_f32 v138, v138
    s_waitcnt vmcnt(4)
    v_mfma_f32_32x32x16_bf16 v[72:87], v[200:203], v[56:59], v[72:87]
    v_add3_u32 v6, v6, v200, v201
    v_add3_u32 v6, v6, v202, v203
    v_add3_u32 v6, v6, v204, v205
    v_add3_u32 v6, v6, v206, v207
    v_exp_f32 v139, v139
    v_exp_f32 v140, v140
    v_exp_f32 v141, v141
    v_mfma_f32_32x32x16_bf16 v[72:87], v[204:207], v[60:63], v[72:87]
    v_exp_f32 v142, v142
    v_exp_f32 v143, v143
    v_exp_f32 v144, v144
    v_mfma_f32_32x32x16_bf16 v[120:135], v[52:55], v[12:15], 0
    v_exp_f32 v145, v145
    v_exp_f32 v146, v146
    v_exp_f32 v147, v147
    v_mfma_f32_32x32x16_bf16 v[56:71], v[20:23], v[12:15], 0
    v_exp_f32 v148, v148
    v_exp_f32 v149, v149
    v_exp_f32 v150, v150
    v_exp_f32 v151, v151
    v_cvt_pk_bf16_f32 v136, v136, v137
    v_cvt_pk_bf16_f32 v137, v138, v139
    v_cvt_pk_bf16_f32 v138, v140, v141
    v_cvt_pk_bf16_f32 v139, v142, v143
    v_cvt_pk_bf16_f32 v140, v144, v145
    v_cvt_pk_bf16_f32 v141, v146, v147
    v_cvt_pk_bf16_f32 v142, v148, v149
    v_cvt_pk_bf16_f32 v143, v150, v151
    v_exp_f32 v104, v104
    v_exp_f32 v105, v105
    v_exp_f32 v106, v106
    v_exp_f32 v107, v107
    s_waitcnt vmcnt(2)
    v_mfma_f32_32x32x16_bf16 v[72:87], v[192:195], v[136:139], v[72:87]
    v_add3_u32 v6, v6, v192, v193
    v_add3_u32 v6, v6, v194, v195
    v_add3_u32 v6, v6, v196, v197
    v_add3_u32 v6, v6, v198, v199
    v_exp_f32 v108, v108
    v_exp_f32 v109, v109
    v_exp_f32 v110, v110
    v_exp_f32 v111, v111
    v_mfma_f32_32x32x16_bf16 v[72:87], v[196:199], v[140:143], v[72:87]
    v_exp_f32 v112, v112
    v_exp_f32 v113, v113
    v_exp_f32 v114, v114
    v_exp_f32 v115, v115
    v_mfma_f32_32x32x16_bf16 v[136:151], v[44:47], v[12:15], 0
    v_exp_f32 v116, v116
    v_exp_f32 v117, v117
    v_exp_f32 v118, v118
    v_exp_f32 v119, v119
    v_cvt_pk_bf16_f32 v104, v104, v105
    v_cvt_pk_bf16_f32 v105, v106, v107
    v_cvt_pk_bf16_f32 v106, v108, v109
    v_cvt_pk_bf16_f32 v107, v110, v111
    v_cvt_pk_bf16_f32 v108, v112, v113
    v_cvt_pk_bf16_f32 v109, v114, v115
    v_cvt_pk_bf16_f32 v110, v116, v117
    v_cvt_pk_bf16_f32 v111, v118, v119
    v_cndmask_b32_e64 v120, v56, v120, s[44:45]
    v_cndmask_b32_e64 v121, v57, v121, s[46:47]
    v_cndmask_b32_e64 v122, v58, v122, s[48:49]
    v_cndmask_b32_e64 v123, v59, v123, s[50:51]
    v_cndmask_b32_e64 v124, v60, v124, s[52:53]
    v_cndmask_b32_e64 v125, v61, v125, s[54:55]
    v_cndmask_b32_e64 v126, v62, v126, s[56:57]
    v_cndmask_b32_e64 v127, v63, v127, s[58:59]
    v_cndmask_b32_e64 v128, v64, v128, s[60:61]
    v_cndmask_b32_e64 v129, v65, v129, s[62:63]
    v_cndmask_b32_e64 v130, v66, v130, s[64:65]
    v_cndmask_b32_e64 v131, v67, v131, s[66:67]
    v_cndmask_b32_e64 v132, v68, v132, s[68:69]
    v_cndmask_b32_e64 v133, v69, v133, s[70:71]
    v_cndmask_b32_e64 v134, v70, v134, s[72:73]
    v_cndmask_b32_e64 v135, v71, v135, s[74:75]
    v_exp_f32 v120, v120
    v_exp_f32 v121, v121
    v_exp_f32 v122, v122
    v_exp_f32 v123, v123
    s_waitcnt vmcnt(0)
    v_mfma_f32_32x32x16_bf16 v[72:87], v[184:187], v[104:107], v[72:87]
    v_add3_u32 v6, v6, v184, v185
    v_add3_u32 v6, v6, v186, v187
    v_add3_u32 v6, v6, v188, v189
    v_add3_u32 v6, v6, v190, v191
    v_exp_f32 v124, v124
    v_exp_f32 v125, v125
    v_exp_f32 v126, v126
    v_exp_f32 v127, v127
    v_mfma_f32_32x32x16_bf16 v[72:87], v[188:191], v[108:111], v[72:87]
    v_exp_f32 v128, v128
    v_exp_f32 v129, v129
    v_exp_f32 v130, v130
    v_exp_f32 v131, v131
    v_mfma_f32_32x32x16_bf16 v[56:71], v[40:43], v[12:15], 0
    v_exp_f32 v132, v132
    v_exp_f32 v133, v133
    v_exp_f32 v134, v134
    v_exp_f32 v135, v135
    v_cvt_pk_bf16_f32 v120, v120, v121
    v_cvt_pk_bf16_f32 v121, v122, v123
    v_cvt_pk_bf16_f32 v122, v124, v125
    v_cvt_pk_bf16_f32 v123, v126, v127
    v_cvt_pk_bf16_f32 v124, v128, v129
    v_cvt_pk_bf16_f32 v125, v130, v131
    v_cvt_pk_bf16_f32 v126, v132, v133
    v_cvt_pk_bf16_f32 v127, v134, v135
    v_and_b32 v128, v120, v152
    v_and_b32 v129, v121, v153
    v_and_b32 v130, v122, v154
    v_and_b32 v131, v123, v155
    v_and_b32 v132, v124, v156
    v_and_b32 v133, v125, v157
    v_and_b32 v134, v126, v158
    v_and_b32 v135, v127, v159
    v_xor_b32 v120, v120, v128
    v_xor_b32 v121, v121, v129
    v_xor_b32 v122, v122, v130
    v_xor_b32 v123, v123, v131
    v_xor_b32 v124, v124, v132
    v_xor_b32 v125, v125, v133
    v_xor_b32 v126, v126, v134
    v_xor_b32 v127, v127, v135
    v_exp_f32 v136, v136
    v_exp_f32 v137, v137
    v_mfma_f32_32x32x16_bf16 v[88:103], v[248:251], v[128:131], v[88:103]
    v_exp_f32 v138, v138
    v_exp_f32 v139, v139
    v_mfma_f32_32x32x16_bf16 v[88:103], v[252:255], v[132:135], v[88:103]
    v_exp_f32 v140, v140
    v_exp_f32 v141, v141
    v_mfma_f32_32x32x16_bf16 v[88:103], v[184:187], v[120:123], v[88:103]
    v_exp_f32 v142, v142
    v_exp_f32 v143, v143
    v_mfma_f32_32x32x16_bf16 v[88:103], v[188:191], v[124:127], v[88:103]
    v_exp_f32 v144, v144
    v_exp_f32 v145, v145
    v_mfma_f32_32x32x16_bf16 v[104:119], v[36:39], v[12:15], 0
    v_exp_f32 v146, v146
    v_exp_f32 v147, v147
    v_exp_f32 v148, v148
    v_exp_f32 v149, v149
    v_exp_f32 v150, v150
    v_exp_f32 v151, v151
    v_cvt_pk_bf16_f32 v136, v136, v137
    v_cvt_pk_bf16_f32 v137, v138, v139
    v_cvt_pk_bf16_f32 v138, v140, v141
    v_cvt_pk_bf16_f32 v139, v142, v143
    v_cvt_pk_bf16_f32 v140, v144, v145
    v_cvt_pk_bf16_f32 v141, v146, v147
    v_cvt_pk_bf16_f32 v142, v148, v149
    v_cvt_pk_bf16_f32 v143, v150, v151
    v_cndmask_b32_e64 v6, 0, v6, s[10:11]
    v_add_u32 v5, v5, v6
    v_mov_b32 v6, v5
    s_nop 1
    v_permlane32_swap_b32 v5, v6
    v_add_u32 v5, v5, v6
    v_mov_b32 v6, v5
    s_nop 1
    v_permlane16_swap_b32 v5, v6
    v_add_u32 v5, v5, v6
    s_nop 1
    v_add_u32_dpp v5, v5, v5 quad_perm:[1,0,3,2] row_mask:0xf bank_mask:0xf
    s_nop 1
    v_add_u32_dpp v5, v5, v5 quad_perm:[2,3,0,1] row_mask:0xf bank_mask:0xf
    s_nop 1
    v_add_u32_dpp v5, v5, v5 row_half_mirror row_mask:0xf bank_mask:0xf
    s_nop 1
    v_add_u32_dpp v5, v5, v5 row_mirror row_mask:0xf bank_mask:0xf
    s_nop 0
    v_readfirstlane_b32 s3, v5
    s_cmp_lg_u32 s3, s36
    s_nop 3
    s_cbranch_scc1 recurrent_scan__sliding_block__moe_arch_mod__prompt_kernel_kvbad
    v_mov_b32 v160, 0x2b800000
    v_mov_b32 v161, 0x53800000
    v_med3_f32 v160, v80, v160, v161
    v_cmp_neq_f32 vcc, v160, v80
    v_rcp_f32 v160, v80
    s_nop 3
    s_cbranch_vccnz f0_61
    v_mul_f32 v72, v72, v160
    v_mul_f32 v73, v73, v160
    v_mul_f32 v74, v74, v160
    v_mul_f32 v75, v75, v160
    v_mul_f32 v76, v76, v160
    v_mul_f32 v77, v77, v160
    v_mul_f32 v78, v78, v160
    v_mul_f32 v79, v79, v160
    v_cvt_pk_bf16_f32 v164, v72, v73
    v_cvt_pk_bf16_f32 v165, v74, v75
    v_cvt_pk_bf16_f32 v166, v76, v77
    v_cvt_pk_bf16_f32 v167, v78, v79
    buffer_store_dwordx4 v[164:167], v168, s[40:43], s37 offen sc1
    v_add3_u32 v163, v164, v165, v166
    v_add_u32 v163, v163, v167
    v_mov_b32 v162, v163
    s_nop 1
    v_permlane32_swap_b32 v163, v162
    v_add_u32 v163, v163, v162
    v_mov_b32 v162, v163
    s_nop 1
    v_permlane16_swap_b32 v163, v162
    v_add_u32 v163, v163, v162
    s_nop 1
    v_add_u32_dpp v163, v163, v163 quad_perm:[1,0,3,2] row_mask:0xf bank_mask:0xf
    s_nop 1
    v_add_u32_dpp v163, v163, v163 quad_perm:[2,3,0,1] row_mask:0xf bank_mask:0xf
    s_nop 1
    v_add_u32_dpp v163, v163, v163 row_half_mirror row_mask:0xf bank_mask:0xf
    s_nop 1
    v_add_u32_dpp v163, v163, v163 row_mirror row_mask:0xf bank_mask:0xf
    v_mov_b32 v162, 1
    s_mov_b64 exec, 1
    ds_add_rtn_u64 v[160:161], v1, v[162:163] offset:176
    s_mov_b64 exec, -1
    s_branch f0d_62
f0_61:
    s_mov_b32 s30, 1
f0d_62:
    v_exp_f32 v56, v56
    v_exp_f32 v57, v57
    v_exp_f32 v58, v58
    v_exp_f32 v59, v59
    v_mfma_f32_32x32x16_bf16 v[88:103], v[232:235], v[136:139], v[88:103]
    v_exp_f32 v60, v60
    v_exp_f32 v61, v61
    v_exp_f32 v62, v62
    v_exp_f32 v63, v63
    v_mfma_f32_32x32x16_bf16 v[88:103], v[236:239], v[140:143], v[88:103]
    v_exp_f32 v64, v64
    v_exp_f32 v65, v65
    v_exp_f32 v66, v66
    v_exp_f32 v67, v67
    v_mfma_f32_32x32x16_bf16 v[120:135], v[32:35], v[12:15], 0
    v_exp_f32 v68, v68
    v_exp_f32 v69, v69
    v_exp_f32 v70, v70
    v_exp_f32 v71, v71
    v_cvt_pk_bf16_f32 v56, v56, v57
    v_cvt_pk_bf16_f32 v57, v58, v59
    v_cvt_pk_bf16_f32 v58, v60, v61
    v_cvt_pk_bf16_f32 v59, v62, v63
    v_cvt_pk_bf16_f32 v60, v64, v65
    v_cvt_pk_bf16_f32 v61, v66, v67
    v_cvt_pk_bf16_f32 v62, v68, v69
    v_cvt_pk_bf16_f32 v63, v70, v71
    s_cmp_lg_u32 s30, 0
    s_nop 0
    s_cbranch_scc1 g1_63
    s_waitcnt lgkmcnt(0)
    v_readfirstlane_b32 s3, v160
    s_cmp_lg_u32 s3, 3
    s_nop 3
    s_cbranch_scc1 of_64
    v_readfirstlane_b32 s3, v161
    s_mov_b64 exec, 0xff
    s_nop 0
    v_add_u32 v162, s3, v163
    v_mov_b32 v163, s29
    buffer_store_dwordx2 v[162:163], v170, s[40:43], 0 offen offset:0 sc1
    s_mov_b64 exec, -1
of_64:
g1_63:
    v_exp_f32 v104, v104
    v_exp_f32 v105, v105
    v_exp_f32 v106, v106
    v_exp_f32 v107, v107
    v_mfma_f32_32x32x16_bf16 v[88:103], v[224:227], v[56:59], v[88:103]
    v_exp_f32 v108, v108
    v_exp_f32 v109, v109
    v_exp_f32 v110, v110
    v_exp_f32 v111, v111
    v_mfma_f32_32x32x16_bf16 v[88:103], v[228:231], v[60:63], v[88:103]
    v_exp_f32 v112, v112
    v_exp_f32 v113, v113
    v_exp_f32 v114, v114
    v_exp_f32 v115, v115
    v_mfma_f32_32x32x16_bf16 v[136:151], v[28:31], v[12:15], 0
    v_exp_f32 v116, v116
    v_exp_f32 v117, v117
    v_exp_f32 v118, v118
    v_exp_f32 v119, v119
    v_cvt_pk_bf16_f32 v104, v104, v105
    v_cvt_pk_bf16_f32 v105, v106, v107
    v_cvt_pk_bf16_f32 v106, v108, v109
    v_cvt_pk_bf16_f32 v107, v110, v111
    v_cvt_pk_bf16_f32 v108, v112, v113
    v_cvt_pk_bf16_f32 v109, v114, v115
    v_cvt_pk_bf16_f32 v110, v116, v117
    v_cvt_pk_bf16_f32 v111, v118, v119
    v_exp_f32 v120, v120
    v_exp_f32 v121, v121
    v_exp_f32 v122, v122
    v_exp_f32 v123, v123
    v_mfma_f32_32x32x16_bf16 v[88:103], v[216:219], v[104:107], v[88:103]
    v_exp_f32 v124, v124
    v_exp_f32 v125, v125
    v_exp_f32 v126, v126
    v_exp_f32 v127, v127
    v_mfma_f32_32x32x16_bf16 v[88:103], v[220:223], v[108:111], v[88:103]
    v_exp_f32 v128, v128
    v_exp_f32 v129, v129
    v_exp_f32 v130, v130
    v_exp_f32 v131, v131
    v_mfma_f32_32x32x16_bf16 v[56:71], v[24:27], v[12:15], 0
    v_exp_f32 v132, v132
    v_exp_f32 v133, v133
    v_exp_f32 v134, v134
    v_exp_f32 v135, v135
    v_cvt_pk_bf16_f32 v120, v120, v121
    v_cvt_pk_bf16_f32 v121, v122, v123
    v_cvt_pk_bf16_f32 v122, v124, v125
    v_cvt_pk_bf16_f32 v123, v126, v127
    v_cvt_pk_bf16_f32 v124, v128, v129
    v_cvt_pk_bf16_f32 v125, v130, v131
    v_cvt_pk_bf16_f32 v126, v132, v133
    v_cvt_pk_bf16_f32 v127, v134, v135
    v_exp_f32 v136, v136
    v_exp_f32 v137, v137
    v_exp_f32 v138, v138
    v_exp_f32 v139, v139
    v_exp_f32 v140, v140
    v_mfma_f32_32x32x16_bf16 v[88:103], v[208:211], v[120:123], v[88:103]
    v_exp_f32 v141, v141
    v_exp_f32 v142, v142
    v_exp_f32 v143, v143
    v_exp_f32 v144, v144
    v_exp_f32 v145, v145
    v_mfma_f32_32x32x16_bf16 v[88:103], v[212:215], v[124:127], v[88:103]
    v_exp_f32 v146, v146
    v_exp_f32 v147, v147
    v_exp_f32 v148, v148
    v_exp_f32 v149, v149
    v_exp_f32 v150, v150
    v_exp_f32 v151, v151
    v_cvt_pk_bf16_f32 v136, v136, v137
    v_cvt_pk_bf16_f32 v137, v138, v139
    v_cvt_pk_bf16_f32 v138, v140, v141
    v_cvt_pk_bf16_f32 v139, v142, v143
    v_cvt_pk_bf16_f32 v140, v144, v145
    v_cvt_pk_bf16_f32 v141, v146, v147
    v_cvt_pk_bf16_f32 v142, v148, v149
    v_cvt_pk_bf16_f32 v143, v150, v151
    v_exp_f32 v56, v56
    v_exp_f32 v57, v57
    v_exp_f32 v58, v58
    v_exp_f32 v59, v59
    v_exp_f32 v60, v60
    v_mfma_f32_32x32x16_bf16 v[88:103], v[200:203], v[136:139], v[88:103]
    v_exp_f32 v61, v61
    v_exp_f32 v62, v62
    v_exp_f32 v63, v63
    v_exp_f32 v64, v64
    v_exp_f32 v65, v65
    v_mfma_f32_32x32x16_bf16 v[88:103], v[204:207], v[140:143], v[88:103]
    v_exp_f32 v66, v66
    v_exp_f32 v67, v67
    v_exp_f32 v68, v68
    v_exp_f32 v69, v69
    v_exp_f32 v70, v70
    v_exp_f32 v71, v71
    v_cvt_pk_bf16_f32 v56, v56, v57
    v_cvt_pk_bf16_f32 v57, v58, v59
    v_cvt_pk_bf16_f32 v58, v60, v61
    v_cvt_pk_bf16_f32 v59, v62, v63
    v_cvt_pk_bf16_f32 v60, v64, v65
    v_cvt_pk_bf16_f32 v61, v66, v67
    v_cvt_pk_bf16_f32 v62, v68, v69
    v_cvt_pk_bf16_f32 v63, v70, v71
    v_mfma_f32_32x32x16_bf16 v[88:103], v[192:195], v[56:59], v[88:103]
    s_nop 0
    v_mfma_f32_32x32x16_bf16 v[88:103], v[196:199], v[60:63], v[88:103]
    s_cmp_lg_u32 s30, 0
    s_nop 7
    s_nop 2
    s_cbranch_scc1 recurrent_scan__sliding_block__moe_arch_mod__prompt_kernel_max0
    v_mov_b32 v160, 0x2b800000
    v_mov_b32 v161, 0x53800000
    v_med3_f32 v160, v96, v160, v161
    v_cmp_neq_f32 vcc, v160, v96
    v_rcp_f32 v160, v96
    s_nop 3
    s_cbranch_vccnz recurrent_scan__sliding_block__moe_arch_mod__prompt_kernel_max1
    v_mul_f32 v88, v88, v160
    v_mul_f32 v89, v89, v160
    v_mul_f32 v90, v90, v160
    v_mul_f32 v91, v91, v160
    v_mul_f32 v92, v92, v160
    v_mul_f32 v93, v93, v160
    v_mul_f32 v94, v94, v160
    v_mul_f32 v95, v95, v160
    v_cvt_pk_bf16_f32 v164, v88, v89
    v_cvt_pk_bf16_f32 v165, v90, v91
    v_cvt_pk_bf16_f32 v166, v92, v93
    v_cvt_pk_bf16_f32 v167, v94, v95
    buffer_store_dwordx4 v[164:167], v168, s[40:43], s38 offen sc1
    s_nop 1
recurrent_scan__sliding_block__moe_arch_mod__prompt_kernel_attn_done:
    v_add3_u32 v163, v164, v165, v166
    v_add_u32 v163, v163, v167
    v_mov_b32 v162, v163
    s_nop 1
    v_permlane32_swap_b32 v163, v162
    v_add_u32 v163, v163, v162
    v_mov_b32 v162, v163
    s_nop 1
    v_permlane16_swap_b32 v163, v162
    v_add_u32 v163, v163, v162
    s_nop 1
    v_add_u32_dpp v163, v163, v163 quad_perm:[1,0,3,2] row_mask:0xf bank_mask:0xf
    s_nop 1
    v_add_u32_dpp v163, v163, v163 quad_perm:[2,3,0,1] row_mask:0xf bank_mask:0xf
    s_nop 1
    v_add_u32_dpp v163, v163, v163 row_half_mirror row_mask:0xf bank_mask:0xf
    s_nop 1
    v_add_u32_dpp v163, v163, v163 row_mirror row_mask:0xf bank_mask:0xf
    v_mov_b32 v162, 1
    s_mov_b64 exec, 1
    ds_add_rtn_u64 v[160:161], v1, v[162:163] offset:184
    s_mov_b64 exec, -1
    s_waitcnt lgkmcnt(0)
    v_readfirstlane_b32 s3, v160
    s_cmp_lg_u32 s3, 3
    s_nop 3
    s_cbranch_scc1 of_65
    v_readfirstlane_b32 s3, v161
    s_mov_b64 exec, 0xff
    s_nop 0
    v_add_u32 v162, s3, v163
    v_mov_b32 v163, s29
    buffer_store_dwordx2 v[162:163], v170, s[40:43], 0 offen offset:512 sc1
    s_mov_b64 exec, -1
of_65:
    s_mov_b32 s32, 1
    s_mov_b32 s33, s28
recurrent_scan__sliding_block__moe_arch_mod__prompt_kernel_op:
    s_mov_b32 s48, s20
    s_mov_b32 s49, s21
    s_mov_b32 s50, 0x200000
    s_mov_b32 s51, 0x00020000
    s_mov_b32 s3, 0x10000
wl_66:
    ds_read_b32 v12, v1 offset:112
    s_waitcnt lgkmcnt(0)
    v_readfirstlane_b32 s52, v12
    s_cmp_ge_u32 s52, 1
    s_nop 3
    s_cbranch_scc1 wl_66d
    s_sleep 1
    s_sub_u32 s3, s3, 1
    s_cbranch_scc0 wl_66
wl_66d:
    s_cmp_lg_u32 s32, 0
    s_cbranch_scc1 pr_67
    s_setprio 0
    s_cmp_eq_u32 s52, 1
    s_cbranch_scc1 pr_67
    s_setprio 0
pr_67:
    s_mov_b32 s3, 0x10000
wl_68:
    ds_read_b32 v12, v1 offset:164
    s_waitcnt lgkmcnt(0)
    v_readfirstlane_b32 s30, v12
    s_cmp_ge_u32 s30, 1
    s_nop 3
    s_cbranch_scc1 wl_68d
    s_sleep 2
    s_sub_u32 s3, s3, 1
    s_cbranch_scc0 wl_68
wl_68d:
    v_lshlrev_b32 v2, 4, v0
    v_and_b32 v4, 31, v0
    s_lshl_b32 s35, s32, 5
    v_add_u32 v3, s35, v4
    v_lshrrev_b32 v5, 5, v0
    v_lshl_add_u32 v5, v5, 2, s33
    v_bfe_u32 v6, v0, 1, 3
    v_xor_b32 v5, v5, v6
    v_lshlrev_b32 v5, 4, v5
    v_lshl_add_u32 v5, v3, 7, v5
    v_add_u32 v5, 122880, v5
    ds_read_b128 v[172:175], v5
    s_lshl_b32 s34, s27, 6
    v_add_u32 v4, s34, v3
    v_lshl_add_u32 v3, v3, 2, v1
    ds_read_b32 v9, v3 offset:512
    ds_read_b32 v8, v3 offset:768
    v_lshrrev_b32 v5, 5, v0
    v_lshlrev_b32 v6, 6, v5
    v_lshl_add_u32 v6, v4, 10, v6
    s_lshl_b32 s34, s26, 7
    s_lshl_b32 s35, s33, 4
    s_add_u32 s34, s34, s35
    v_add_u32 v6, s34, v6
    v_bfe_u32 v10, v0, 2, 2
    v_lshl_add_u32 v11, v5, 2, v10
    v_lshlrev_b32 v11, 7, v11
    v_and_b32 v12, 1, v0
    v_lshl_add_u32 v11, v12, 6, v11
    v_lshrrev_b32 v10, 1, v10
    v_lshl_add_u32 v11, v10, 5, v11
    v_bfe_u32 v12, v0, 4, 1
    v_lshl_add_u32 v11, v12, 4, v11
    v_bfe_u32 v12, v0, 1, 1
    v_lshl_add_u32 v11, v12, 3, v11
    v_xor_b32 v11, s35, v11
    s_lshl_b32 s34, s33, 14
    v_add_u32 v10, s34, v11
    v_xor_b32 v11, 32, v10
    s_lshl_b32 s34, s33, 2
    v_add_u32 v7, s34, v1
    s_waitcnt lgkmcnt(0)
    v_lshlrev_b32 v112, 16, v172
    v_and_b32 v113, 0xffff0000, v172
    v_add_f32 v96, v112, v8
    v_add_f32 v97, v113, v8
    v_cvt_pk_bf16_f32 v104, v96, v97
    v_lshlrev_b32 v96, 16, v104
    v_and_b32 v97, 0xffff0000, v104
    v_mul_f32 v96, v96, v9
    v_mul_f32 v97, v97, v9
    v_cvt_pk_bf16_f32 v104, v96, v97
    v_lshlrev_b32 v128, 16, v104
    v_and_b32 v129, 0xffff0000, v104
    v_lshlrev_b32 v114, 16, v173
    v_and_b32 v115, 0xffff0000, v173
    v_add_f32 v98, v114, v8
    v_add_f32 v99, v115, v8
    v_cvt_pk_bf16_f32 v105, v98, v99
    v_lshlrev_b32 v98, 16, v105
    v_and_b32 v99, 0xffff0000, v105
    v_mul_f32 v98, v98, v9
    v_mul_f32 v99, v99, v9
    v_cvt_pk_bf16_f32 v105, v98, v99
    v_lshlrev_b32 v130, 16, v105
    v_and_b32 v131, 0xffff0000, v105
    v_lshlrev_b32 v116, 16, v174
    v_and_b32 v117, 0xffff0000, v174
    v_add_f32 v100, v116, v8
    v_add_f32 v101, v117, v8
    v_cvt_pk_bf16_f32 v106, v100, v101
    v_lshlrev_b32 v100, 16, v106
    v_and_b32 v101, 0xffff0000, v106
    v_mul_f32 v100, v100, v9
    v_mul_f32 v101, v101, v9
    v_cvt_pk_bf16_f32 v106, v100, v101
    v_lshlrev_b32 v132, 16, v106
    v_and_b32 v133, 0xffff0000, v106
    v_lshlrev_b32 v118, 16, v175
    v_and_b32 v119, 0xffff0000, v175
    v_add_f32 v102, v118, v8
    v_add_f32 v103, v119, v8
    v_cvt_pk_bf16_f32 v107, v102, v103
    v_lshlrev_b32 v102, 16, v107
    v_and_b32 v103, 0xffff0000, v107
    v_mul_f32 v102, v102, v9
    v_mul_f32 v103, v103, v9
    v_cvt_pk_bf16_f32 v107, v102, v103
    v_lshlrev_b32 v134, 16, v107
    v_and_b32 v135, 0xffff0000, v107
    v_mul_f32 v96, 0xbfb8aa3b, v128
    v_mul_f32 v97, 0xbfb8aa3b, v129
    v_mul_f32 v98, 0xbfb8aa3b, v130
    v_mul_f32 v99, 0xbfb8aa3b, v131
    v_mul_f32 v100, 0xbfb8aa3b, v132
    v_mul_f32 v101, 0xbfb8aa3b, v133
    v_mul_f32 v102, 0xbfb8aa3b, v134
    v_mul_f32 v103, 0xbfb8aa3b, v135
    v_exp_f32 v96, v96
    v_exp_f32 v97, v97
    v_exp_f32 v98, v98
    v_exp_f32 v99, v99
    v_exp_f32 v100, v100
    v_exp_f32 v101, v101
    v_exp_f32 v102, v102
    v_exp_f32 v103, v103
    v_add_f32 v96, 1.0, v96
    v_add_f32 v97, 1.0, v97
    v_add_f32 v98, 1.0, v98
    v_add_f32 v99, 1.0, v99
    v_add_f32 v100, 1.0, v100
    v_add_f32 v101, 1.0, v101
    v_add_f32 v102, 1.0, v102
    v_add_f32 v103, 1.0, v103
    v_rcp_f32 v96, v96
    v_rcp_f32 v97, v97
    v_rcp_f32 v98, v98
    v_rcp_f32 v99, v99
    v_rcp_f32 v100, v100
    v_rcp_f32 v101, v101
    v_rcp_f32 v102, v102
    v_rcp_f32 v103, v103
    v_mul_f32 v80, v128, v96
    v_mul_f32 v81, v129, v97
    v_mul_f32 v82, v130, v98
    v_mul_f32 v83, v131, v99
    v_mul_f32 v84, v132, v100
    v_mul_f32 v85, v133, v101
    v_mul_f32 v86, v134, v102
    v_mul_f32 v87, v135, v103
    s_lshl_b32 s34, s27, 3
    s_add_u32 s34, s34, s26
    s_lshl_b32 s34, s34, 10
    s_lshl_b32 s35, s32, 9
    s_add_u32 s34, s34, s35
    s_lshl_b32 s35, s33, 7
    s_add_u32 s34, s34, s35
    s_add_u32 s34, s34, 7405568
    s_lshl_b32 s35, s27, 16
    s_lshl_b32 s36, s32, 15
    s_add_u32 s35, s35, s36
    s_lshl_b32 s36, s33, 13
    s_add_u32 s35, s35, s36
    s_add_u32 s35, s35, 4194304
    s_add_u32 s36, s35, 4096
    s_mul_i32 s37, s32, 65536
    s_add_u32 s37, s37, 65536
    s_xor_b32 s38, s33, 0
    s_mul_i32 s38, s38, 6144
    s_add_u32 s38, s38, s37
    v_add_u32 v120, s38, v2
    s_xor_b32 s38, s33, 1
    s_mul_i32 s38, s38, 6144
    s_add_u32 s38, s38, s37
    v_add_u32 v121, s38, v2
    s_xor_b32 s38, s33, 2
    s_mul_i32 s38, s38, 6144
    s_add_u32 s38, s38, s37
    v_add_u32 v122, s38, v2
    s_xor_b32 s38, s33, 3
    s_mul_i32 s38, s38, 6144
    s_add_u32 s38, s38, s37
    v_add_u32 v123, s38, v2
    s_lshr_b32 s72, s52, 1
    s_nop 0
    s_cbranch_scc0 hm_69
    v_and_b32 v152, 7, v0
    v_lshl_add_u32 v152, v152, 2, v1
    ds_read_b32 v152, v152 offset:320
    s_waitcnt lgkmcnt(0)
    v_bfe_u32 v160, v152, 5, 1
    v_cmp_eq_u32 vcc, s32, v160
    s_and_b32 s72, s72, vcc_lo
    s_nop 3
hm_69:
    v_lshlrev_b32 v126, 6, v0
    v_mov_b32 v125, 0
    v_mov_b32 v127, 0
    s_mov_b32 s61, 0
    s_cmp_eq_u32 s32, 0
    s_cbranch_scc1 recurrent_scan__sliding_block__moe_arch_mod__prompt_kernel_wod
recurrent_scan__sliding_block__moe_arch_mod__prompt_kernel_wow:
    s_mov_b32 s3, 0x10000
wl_70:
    ds_read_b32 v12, v7 offset:48
    s_waitcnt lgkmcnt(0)
    v_readfirstlane_b32 s30, v12
    s_cmp_ge_u32 s30, 1
    s_nop 3
    s_cbranch_scc1 wl_70d
    s_sleep 1
    s_sub_u32 s3, s3, 1
    s_cbranch_scc0 wl_70
wl_70d:
    s_cmp_eq_u32 s61, 0
    s_cbranch_scc1 p3_71
    s_setprio 2
p3_71:
    ds_read_b64_tr_b16 v[176:177], v10 offset:0
    ds_read_b64_tr_b16 v[178:179], v10 offset:1024
    ds_read_b64_tr_b16 v[180:181], v11 offset:0
    ds_read_b64_tr_b16 v[182:183], v11 offset:1024
    ds_read_b64_tr_b16 v[184:185], v10 offset:2048
    ds_read_b64_tr_b16 v[186:187], v10 offset:3072
    ds_read_b64_tr_b16 v[188:189], v11 offset:2048
    ds_read_b64_tr_b16 v[190:191], v11 offset:3072
    s_waitcnt lgkmcnt(4)
    ds_read_b64_tr_b16 v[192:193], v10 offset:4096
    ds_read_b64_tr_b16 v[194:195], v10 offset:5120
    ds_read_b64_tr_b16 v[196:197], v11 offset:4096
    ds_read_b64_tr_b16 v[198:199], v11 offset:5120
    ds_read_b64_tr_b16 v[200:201], v10 offset:6144
    ds_read_b64_tr_b16 v[202:203], v10 offset:7168
    ds_read_b64_tr_b16 v[204:205], v11 offset:6144
    ds_read_b64_tr_b16 v[206:207], v11 offset:7168
    s_waitcnt lgkmcnt(4)
    ds_read_b64_tr_b16 v[208:209], v10 offset:8192
    ds_read_b64_tr_b16 v[210:211], v10 offset:9216
    ds_read_b64_tr_b16 v[212:213], v11 offset:8192
    ds_read_b64_tr_b16 v[214:215], v11 offset:9216
    ds_read_b64_tr_b16 v[216:217], v10 offset:10240
    ds_read_b64_tr_b16 v[218:219], v10 offset:11264
    ds_read_b64_tr_b16 v[220:221], v11 offset:10240
    ds_read_b64_tr_b16 v[222:223], v11 offset:11264
    s_waitcnt lgkmcnt(4)
    ds_read_b64_tr_b16 v[224:225], v10 offset:12288
    ds_read_b64_tr_b16 v[226:227], v10 offset:13312
    ds_read_b64_tr_b16 v[228:229], v11 offset:12288
    ds_read_b64_tr_b16 v[230:231], v11 offset:13312
    ds_read_b64_tr_b16 v[232:233], v10 offset:14336
    ds_read_b64_tr_b16 v[234:235], v10 offset:15360
    ds_read_b64_tr_b16 v[236:237], v11 offset:14336
    ds_read_b64_tr_b16 v[238:239], v11 offset:15360
    s_waitcnt lgkmcnt(4)
    s_mov_b32 s53, 0
    s_lshl_b32 s38, s32, 4
    v_add_u32 v14, s38, v1
    v_add_u32 v15, s38, v7
    s_cmp_lg_u32 s32, 0
    s_nop 0
    s_cbranch_scc1 oa_72
    s_cmp_lg_u32 s61, 0
    s_cbranch_scc1 recurrent_scan__sliding_block__moe_arch_mod__prompt_kernel_yearly
recurrent_scan__sliding_block__moe_arch_mod__prompt_kernel_yeret:
    s_mov_b32 s3, 0x10000
wl_73:
    ds_read_b32 v13, v1 offset:176
    s_waitcnt lgkmcnt(0)
    v_readfirstlane_b32 s30, v13
    s_cmp_ge_u32 s30, 4
    s_nop 3
    s_cbranch_scc1 wl_73d
    s_sleep 2
    s_sub_u32 s3, s3, 1
    s_cbranch_scc0 wl_73
wl_73d:
    s_sleep 4
oa_72:
    s_mov_b64 exec, 3
    s_mov_b32 s3, 0x8000
op_74:
    buffer_load_dwordx2 v[124:125], v126, s[40:43], s34 offen sc1
    s_waitcnt vmcnt(0)
    v_cmp_eq_u32 vcc, s29, v125
    s_bcnt1_i32_b32 s30, vcc_lo
    s_cmp_ge_u32 s30, 2
    s_nop 2
    s_cbranch_scc1 recurrent_scan__sliding_block__moe_arch_mod__prompt_kernel_opd
    s_sleep 2
    s_sub_u32 s3, s3, 1
    s_cbranch_scc0 op_74
recurrent_scan__sliding_block__moe_arch_mod__prompt_kernel_opd:
    s_mov_b64 exec, -1
    s_mov_b32 s67, 0x400
recurrent_scan__sliding_block__moe_arch_mod__prompt_kernel_ord:
    buffer_load_dwordx4 v[16:19], v2, s[40:43], s35 offen offset:0 sc1
    buffer_load_dwordx4 v[20:23], v2, s[40:43], s35 offen offset:1024 sc1
    buffer_load_dwordx4 v[24:27], v2, s[40:43], s35 offen offset:2048 sc1
    buffer_load_dwordx4 v[28:31], v2, s[40:43], s35 offen offset:3072 sc1
    buffer_load_dwordx4 v[32:35], v2, s[40:43], s36 offen offset:0 sc1
    buffer_load_dwordx4 v[36:39], v2, s[40:43], s36 offen offset:1024 sc1
    buffer_load_dwordx4 v[40:43], v2, s[40:43], s36 offen offset:2048 sc1
    buffer_load_dwordx4 v[44:47], v2, s[40:43], s36 offen offset:3072 sc1
    s_cmp_lg_u32 s72, 0
    s_cbranch_scc1 recurrent_scan__sliding_block__moe_arch_mod__prompt_kernel_ychk
recurrent_scan__sliding_block__moe_arch_mod__prompt_kernel_hret:
    v_readlane_b32 s30, v124, 0
    v_readlane_b32 s31, v124, 1
    v_mov_b32 v13, 0
    s_add_u32 s31, s31, s30
    s_waitcnt lgkmcnt(0)
    s_waitcnt vmcnt(7)
    v_mfma_f32_32x32x16_bf16 v[48:63], v[176:179], v[16:19], 0
    v_add3_u32 v13, v13, v16, v17
    v_mfma_f32_32x32x16_bf16 v[64:79], v[180:183], v[16:19], 0
    v_add3_u32 v13, v13, v18, v19
    s_waitcnt vmcnt(6)
    v_mfma_f32_32x32x16_bf16 v[48:63], v[184:187], v[20:23], v[48:63]
    v_add3_u32 v13, v13, v20, v21
    v_mfma_f32_32x32x16_bf16 v[64:79], v[188:191], v[20:23], v[64:79]
    v_add3_u32 v13, v13, v22, v23
    s_waitcnt vmcnt(5)
    v_mfma_f32_32x32x16_bf16 v[48:63], v[192:195], v[24:27], v[48:63]
    v_add3_u32 v13, v13, v24, v25
    v_mfma_f32_32x32x16_bf16 v[64:79], v[196:199], v[24:27], v[64:79]
    v_add3_u32 v13, v13, v26, v27
    s_waitcnt vmcnt(4)
    v_mfma_f32_32x32x16_bf16 v[48:63], v[200:203], v[28:31], v[48:63]
    v_add3_u32 v13, v13, v28, v29
    v_mfma_f32_32x32x16_bf16 v[64:79], v[204:207], v[28:31], v[64:79]
    v_add3_u32 v13, v13, v30, v31
    s_waitcnt vmcnt(3)
    v_mfma_f32_32x32x16_bf16 v[48:63], v[208:211], v[32:35], v[48:63]
    v_add3_u32 v13, v13, v32, v33
    v_mfma_f32_32x32x16_bf16 v[64:79], v[212:215], v[32:35], v[64:79]
    v_add3_u32 v13, v13, v34, v35
    s_waitcnt vmcnt(2)
    v_mfma_f32_32x32x16_bf16 v[48:63], v[216:219], v[36:39], v[48:63]
    v_add3_u32 v13, v13, v36, v37
    v_mfma_f32_32x32x16_bf16 v[64:79], v[220:223], v[36:39], v[64:79]
    v_add3_u32 v13, v13, v38, v39
    s_waitcnt vmcnt(1)
    v_mfma_f32_32x32x16_bf16 v[48:63], v[224:227], v[40:43], v[48:63]
    v_add3_u32 v13, v13, v40, v41
    v_mfma_f32_32x32x16_bf16 v[64:79], v[228:231], v[40:43], v[64:79]
    v_add3_u32 v13, v13, v42, v43
    s_waitcnt vmcnt(0)
    v_mfma_f32_32x32x16_bf16 v[48:63], v[232:235], v[44:47], v[48:63]
    v_add3_u32 v13, v13, v44, v45
    v_mfma_f32_32x32x16_bf16 v[64:79], v[236:239], v[44:47], v[64:79]
    v_add3_u32 v13, v13, v46, v47
    v_mov_b32 v12, v13
    s_nop 1
    v_permlane32_swap_b32 v13, v12
    v_add_u32 v13, v13, v12
    v_mov_b32 v12, v13
    s_nop 1
    v_permlane16_swap_b32 v13, v12
    v_add_u32 v13, v13, v12
    s_nop 1
    v_add_u32_dpp v13, v13, v13 quad_perm:[1,0,3,2] row_mask:0xf bank_mask:0xf
    s_nop 1
    v_add_u32_dpp v13, v13, v13 quad_perm:[2,3,0,1] row_mask:0xf bank_mask:0xf
    s_nop 1
    v_add_u32_dpp v13, v13, v13 row_half_mirror row_mask:0xf bank_mask:0xf
    s_nop 1
    v_add_u32_dpp v13, v13, v13 row_mirror row_mask:0xf bank_mask:0xf
    s_nop 0
    v_readfirstlane_b32 s30, v13
    s_cmp_lg_u32 s30, s31
    s_nop 3
    s_cbranch_scc1 recurrent_scan__sliding_block__moe_arch_mod__prompt_kernel_obad
recurrent_scan__sliding_block__moe_arch_mod__prompt_kernel_ook:
    ds_write_b128 v121, v[56:59] offset:0
    ds_write_b128 v121, v[60:63] offset:1024
    ds_write_b128 v122, v[64:67] offset:2048
    ds_write_b128 v122, v[68:71] offset:3072
    ds_write_b128 v123, v[72:75] offset:4096
    ds_write_b128 v123, v[76:79] offset:5120
    v_mov_b32 v13, 1
    ds_write_b32 v15, v13 offset:80
    s_mov_b32 s62, 1
    s_mov_b32 s59, 0
    s_cmp_lg_u32 s61, 0
    s_cbranch_scc1 recurrent_scan__sliding_block__moe_arch_mod__prompt_kernel_ysum
recurrent_scan__sliding_block__moe_arch_mod__prompt_kernel_yret:
    s_mov_b32 s53, 1
    s_cmp_lg_u32 s72, 0
    s_cbranch_scc1 recurrent_scan__sliding_block__moe_arch_mod__prompt_kernel_hasy
recurrent_scan__sliding_block__moe_arch_mod__prompt_kernel_fin:
    s_mov_b32 s3, 0x10000
wl_75:
    ds_read_b128 v[96:99], v14 offset:80
    s_waitcnt lgkmcnt(0)
    v_min_u32 v96, v96, v97
    v_min3_u32 v96, v96, v98, v99
    s_nop 0
    v_readfirstlane_b32 s30, v96
    s_cmp_ge_u32 s30, 1
    s_nop 3
    s_cbranch_scc1 wl_75d
    s_sub_u32 s3, s3, 1
    s_cbranch_scc0 wl_75
wl_75d:
    ds_read_b128 v[56:59], v120 offset:0
    ds_read_b128 v[60:63], v120 offset:1024
    ds_read_b128 v[64:67], v120 offset:2048
    ds_read_b128 v[68:71], v120 offset:3072
    ds_read_b128 v[72:75], v120 offset:4096
    ds_read_b128 v[76:79], v120 offset:5120
    s_waitcnt lgkmcnt(4)
    v_add_f32 v48, v48, v56
    v_add_f32 v49, v49, v57
    v_add_f32 v50, v50, v58
    v_add_f32 v51, v51, v59
    v_add_f32 v52, v52, v60
    v_add_f32 v53, v53, v61
    v_add_f32 v54, v54, v62
    v_add_f32 v55, v55, v63
    s_waitcnt lgkmcnt(2)
    v_add_f32 v48, v48, v64
    v_add_f32 v49, v49, v65
    v_add_f32 v50, v50, v66
    v_add_f32 v51, v51, v67
    v_add_f32 v52, v52, v68
    v_add_f32 v53, v53, v69
    v_add_f32 v54, v54, v70
    v_add_f32 v55, v55, v71
    s_waitcnt lgkmcnt(0)
    v_add_f32 v48, v48, v72
    v_add_f32 v49, v49, v73
    v_add_f32 v50, v50, v74
    v_add_f32 v51, v51, v75
    v_add_f32 v52, v52, v76
    v_add_f32 v53, v53, v77
    v_add_f32 v54, v54, v78
    v_add_f32 v55, v55, v79
    v_fmac_f32 v112, v48, v80
    v_fmac_f32 v113, v49, v81
    v_fmac_f32 v114, v50, v82
    v_fmac_f32 v115, v51, v83
    v_fmac_f32 v116, v52, v84
    v_fmac_f32 v117, v53, v85
    v_fmac_f32 v118, v54, v86
    v_fmac_f32 v119, v55, v87
    v_cvt_pk_bf16_f32 v48, v112, v113
    v_cvt_pk_bf16_f32 v49, v114, v115
    v_cvt_pk_bf16_f32 v50, v116, v117
    v_cvt_pk_bf16_f32 v51, v118, v119
    buffer_store_dwordx4 v[48:51], v6, s[48:51], 0 offen
    s_nop 1
recurrent_scan__sliding_block__moe_arch_mod__prompt_kernel_end:
    s_endpgm
recurrent_scan__sliding_block__moe_arch_mod__prompt_kernel_obad:
    s_sleep 1
    s_sub_u32 s67, s67, 1
    s_cbranch_scc0 recurrent_scan__sliding_block__moe_arch_mod__prompt_kernel_ord
    s_branch recurrent_scan__sliding_block__moe_arch_mod__prompt_kernel_ook
recurrent_scan__sliding_block__moe_arch_mod__prompt_kernel_wod:
    s_lshr_b32 s61, s52, 1
    s_mov_b32 s68, s52
    s_mov_b32 s62, 0
    s_ff1_i32_b32 s38, s61
    s_and_b32 s38, s38, 7
    s_lshl_b32 s38, s38, 11
    s_lshl_b32 s39, s26, 8
    s_add_u32 s38, s38, s39
    s_add_u32 s38, s38, 6291704
    v_and_b32 v12, 3, v0
    v_bfe_u32 v13, v0, 2, 2
    v_lshl_add_u32 v12, v13, 4, v12
    s_lshl_b32 s39, s33, 2
    v_add_u32 v12, s39, v12
    v_min_u32 v13, 55, v12
    v_lshlrev_b32 v13, 14, v13
    v_add_u32 v13, s38, v13
    v_add_u32 v12, s34, v126
    v_cmp_gt_u32 vcc, 2, v0
    s_nop 1
    v_cndmask_b32 v127, v13, v12, vcc
    s_mov_b32 s58, 0
    s_cmp_ge_u32 s33, 2
    s_cbranch_scc1 recurrent_scan__sliding_block__moe_arch_mod__prompt_kernel_wow
    s_lshl_b32 s38, s33, 14
    v_add_u32 v136, s38, v2
    v_mov_b32 v137, 1
    s_mov_b32 s56, s8
    s_mov_b32 s57, s9
    s_mov_b32 s58, 0x80000
    s_mov_b32 s59, 0x00020000
    s_lshl_b32 s55, s33, 14
    s_mov_b32 s3, 0x10000
wl_76:
    ds_read_b128 v[12:15], v1 offset:16
    s_waitcnt lgkmcnt(0)
    v_min_u32 v12, v12, v13
    v_min3_u32 v12, v12, v14, v15
    s_nop 0
    v_readfirstlane_b32 s30, v12
    s_cmp_ge_u32 s30, 15
    s_nop 3
    s_cbranch_scc1 wl_76d
    s_sleep 2
    s_sub_u32 s3, s3, 1
    s_cbranch_scc0 wl_76
wl_76d:
    s_mov_b32 s38, 0
    s_add_u32 m0, s55, 0
    s_nop 0
    buffer_load_dwordx4 v138, s[56:59], s38 offen lds
    s_mov_b32 s38, 8192
    s_add_u32 m0, s55, 1024
    s_nop 0
    buffer_load_dwordx4 v138, s[56:59], s38 offen lds
    s_mov_b32 s38, 16384
    s_add_u32 m0, s55, 2048
    s_nop 0
    buffer_load_dwordx4 v138, s[56:59], s38 offen lds
    s_mov_b32 s38, 24576
    s_add_u32 m0, s55, 3072
    s_nop 0
    buffer_load_dwordx4 v138, s[56:59], s38 offen lds
    s_mov_b32 s38, 32768
    s_add_u32 m0, s55, 4096
    s_nop 0
    buffer_load_dwordx4 v138, s[56:59], s38 offen lds
    s_mov_b32 s38, 40960
    s_add_u32 m0, s55, 5120
    s_nop 0
    buffer_load_dwordx4 v138, s[56:59], s38 offen lds
    s_mov_b32 s38, 49152
    s_add_u32 m0, s55, 6144
    s_nop 0
    buffer_load_dwordx4 v138, s[56:59], s38 offen lds
    s_mov_b32 s38, 57344
    s_add_u32 m0, s55, 7168
    s_nop 0
    buffer_load_dwordx4 v138, s[56:59], s38 offen lds
    s_mov_b32 s38, 65536
    s_add_u32 m0, s55, 8192
    s_nop 0
    buffer_load_dwordx4 v138, s[56:59], s38 offen lds
    s_mov_b32 s38, 73728
    s_add_u32 m0, s55, 9216
    s_nop 0
    buffer_load_dwordx4 v138, s[56:59], s38 offen lds
    s_mov_b32 s38, 81920
    s_add_u32 m0, s55, 10240
    s_nop 0
    buffer_load_dwordx4 v138, s[56:59], s38 offen lds
    s_mov_b32 s38, 90112
    s_add_u32 m0, s55, 11264
    s_nop 0
    buffer_load_dwordx4 v138, s[56:59], s38 offen lds
    s_mov_b32 s38, 98304
    s_add_u32 m0, s55, 12288
    s_nop 0
    buffer_load_dwordx4 v138, s[56:59], s38 offen lds
    s_mov_b32 s38, 106496
    s_add_u32 m0, s55, 13312
    s_nop 0
    buffer_load_dwordx4 v138, s[56:59], s38 offen lds
    s_mov_b32 s38, 114688
    s_add_u32 m0, s55, 14336
    s_nop 0
    buffer_load_dwordx4 v138, s[56:59], s38 offen lds
    s_mov_b32 s38, 122880
    s_add_u32 m0, s55, 15360
    s_nop 0
    buffer_load_dwordx4 v138, s[56:59], s38 offen lds
    s_mov_b32 s38, 262144
    s_add_u32 m0, s55, 32768
    s_nop 0
    buffer_load_dwordx4 v138, s[56:59], s38 offen lds
    s_mov_b32 s38, 270336
    s_add_u32 m0, s55, 33792
    s_nop 0
    buffer_load_dwordx4 v138, s[56:59], s38 offen lds
    s_mov_b32 s38, 278528
    s_add_u32 m0, s55, 34816
    s_nop 0
    buffer_load_dwordx4 v138, s[56:59], s38 offen lds
    s_mov_b32 s38, 286720
    s_add_u32 m0, s55, 35840
    s_nop 0
    buffer_load_dwordx4 v138, s[56:59], s38 offen lds
    s_mov_b32 s38, 294912
    s_add_u32 m0, s55, 36864
    s_nop 0
    buffer_load_dwordx4 v138, s[56:59], s38 offen lds
    s_mov_b32 s38, 303104
    s_add_u32 m0, s55, 37888
    s_nop 0
    buffer_load_dwordx4 v138, s[56:59], s38 offen lds
    s_mov_b32 s38, 311296
    s_add_u32 m0, s55, 38912
    s_nop 0
    buffer_load_dwordx4 v138, s[56:59], s38 offen lds
    s_mov_b32 s38, 319488
    s_add_u32 m0, s55, 39936
    s_nop 0
    buffer_load_dwordx4 v138, s[56:59], s38 offen lds
    s_mov_b32 s38, 327680
    s_add_u32 m0, s55, 40960
    s_nop 0
    buffer_load_dwordx4 v138, s[56:59], s38 offen lds
    s_mov_b32 s38, 335872
    s_add_u32 m0, s55, 41984
    s_nop 0
    buffer_load_dwordx4 v138, s[56:59], s38 offen lds
    s_mov_b32 s38, 344064
    s_add_u32 m0, s55, 43008
    s_nop 0
    buffer_load_dwordx4 v138, s[56:59], s38 offen lds
    s_mov_b32 s38, 352256
    s_add_u32 m0, s55, 44032
    s_nop 0
    buffer_load_dwordx4 v138, s[56:59], s38 offen lds
    s_mov_b32 s38, 360448
    s_add_u32 m0, s55, 45056
    s_nop 0
    buffer_load_dwordx4 v138, s[56:59], s38 offen lds
    s_mov_b32 s38, 368640
    s_add_u32 m0, s55, 46080
    s_nop 0
    buffer_load_dwordx4 v138, s[56:59], s38 offen lds
    s_mov_b32 s38, 376832
    s_add_u32 m0, s55, 47104
    s_nop 0
    buffer_load_dwordx4 v138, s[56:59], s38 offen lds
    s_mov_b32 s38, 385024
    s_add_u32 m0, s55, 48128
    s_nop 0
    buffer_load_dwordx4 v138, s[56:59], s38 offen lds
    s_mov_b32 s58, 0
    s_waitcnt vmcnt(16)
    ds_write_b32 v7, v137 offset:48
    s_waitcnt vmcnt(0)
    ds_write_b32 v7, v137 offset:56
    s_branch recurrent_scan__sliding_block__moe_arch_mod__prompt_kernel_wow
recurrent_scan__sliding_block__moe_arch_mod__prompt_kernel_ychk:
    ds_read_b128 v[160:163], v1 offset:64
    s_waitcnt lgkmcnt(0)
    v_min_u32 v160, v160, v161
    v_min3_u32 v160, v160, v162, v163
    s_nop 0
    v_readfirstlane_b32 s30, v160
    s_cmp_eq_u32 s30, 0
    s_nop 3
    s_cbranch_scc1 recurrent_scan__sliding_block__moe_arch_mod__prompt_kernel_hret
    s_branch recurrent_scan__sliding_block__moe_arch_mod__prompt_kernel_hgo
recurrent_scan__sliding_block__moe_arch_mod__prompt_kernel_hasy:
    s_mov_b32 s3, 0x10000
wl_77:
    ds_read_b128 v[160:163], v1 offset:64
    s_waitcnt lgkmcnt(0)
    v_min_u32 v160, v160, v161
    v_min3_u32 v160, v160, v162, v163
    s_nop 0
    v_readfirstlane_b32 s30, v160
    s_cmp_ge_u32 s30, 1
    s_nop 3
    s_cbranch_scc1 wl_77d
    s_sub_u32 s3, s3, 1
    s_cbranch_scc0 wl_77
wl_77d:
recurrent_scan__sliding_block__moe_arch_mod__prompt_kernel_hgo:
    v_lshlrev_b32 v164, 7, v5
    s_lshl_b32 s38, s33, 5
    s_add_u32 s38, s38, 90112
    v_add_u32 v164, s38, v164
    s_nop 1
recurrent_scan__sliding_block__moe_arch_mod__prompt_kernel_hj:
    s_ff1_i32_b32 s38, s72
    s_bitset0_b32 s72, s38
    v_readlane_b32 s69, v152, s38
    s_lshl_b32 s38, s38, 8
    v_add_u32 v160, s38, v164
    ds_read_b128 v[104:107], v160 offset:0
    ds_read_b128 v[108:111], v160 offset:16
    ds_read_b128 v[96:99], v160 offset:2048
    ds_read_b128 v[100:103], v160 offset:2064
    ds_read_b128 v[136:139], v160 offset:4096
    ds_read_b128 v[140:143], v160 offset:4112
    ds_read_b128 v[144:147], v160 offset:6144
    ds_read_b128 v[148:151], v160 offset:6160
    s_and_b32 s69, s69, 2047
    v_cmp_eq_u32 vcc, s69, v4
    s_waitcnt lgkmcnt(4)
    v_add_f32 v104, v104, v96
    v_add_f32 v105, v105, v97
    v_add_f32 v106, v106, v98
    v_add_f32 v107, v107, v99
    v_add_f32 v108, v108, v100
    v_add_f32 v109, v109, v101
    v_add_f32 v110, v110, v102
    v_add_f32 v111, v111, v103
    s_waitcnt lgkmcnt(0)
    v_add_f32 v136, v136, v144
    v_add_f32 v137, v137, v145
    v_add_f32 v138, v138, v146
    v_add_f32 v139, v139, v147
    v_add_f32 v140, v140, v148
    v_add_f32 v141, v141, v149
    v_add_f32 v142, v142, v150
    v_add_f32 v143, v143, v151
    v_add_f32 v104, v104, v136
    v_add_f32 v105, v105, v137
    v_add_f32 v106, v106, v138
    v_add_f32 v107, v107, v139
    v_add_f32 v108, v108, v140
    v_add_f32 v109, v109, v141
    v_add_f32 v110, v110, v142
    v_add_f32 v111, v111, v143
    v_add_f32 v104, v104, v128
    v_add_f32 v105, v105, v129
    v_add_f32 v106, v106, v130
    v_add_f32 v107, v107, v131
    v_add_f32 v108, v108, v132
    v_add_f32 v109, v109, v133
    v_add_f32 v110, v110, v134
    v_add_f32 v111, v111, v135
    v_cndmask_b32 v128, v128, v104, vcc
    v_cndmask_b32 v129, v129, v105, vcc
    v_cndmask_b32 v130, v130, v106, vcc
    v_cndmask_b32 v131, v131, v107, vcc
    v_cndmask_b32 v132, v132, v108, vcc
    v_cndmask_b32 v133, v133, v109, vcc
    v_cndmask_b32 v134, v134, v110, vcc
    v_cndmask_b32 v135, v135, v111, vcc
    s_cmp_lg_u32 s72, 0
    s_nop 0
    s_cbranch_scc1 recurrent_scan__sliding_block__moe_arch_mod__prompt_kernel_hj
    v_mul_f32 v96, 0xbfb8aa3b, v128
    v_mul_f32 v97, 0xbfb8aa3b, v129
    v_mul_f32 v98, 0xbfb8aa3b, v130
    v_mul_f32 v99, 0xbfb8aa3b, v131
    v_mul_f32 v100, 0xbfb8aa3b, v132
    v_mul_f32 v101, 0xbfb8aa3b, v133
    v_mul_f32 v102, 0xbfb8aa3b, v134
    v_mul_f32 v103, 0xbfb8aa3b, v135
    v_exp_f32 v96, v96
    v_exp_f32 v97, v97
    v_exp_f32 v98, v98
    v_exp_f32 v99, v99
    v_exp_f32 v100, v100
    v_exp_f32 v101, v101
    v_exp_f32 v102, v102
    v_exp_f32 v103, v103
    v_add_f32 v96, 1.0, v96
    v_add_f32 v97, 1.0, v97
    v_add_f32 v98, 1.0, v98
    v_add_f32 v99, 1.0, v99
    v_add_f32 v100, 1.0, v100
    v_add_f32 v101, 1.0, v101
    v_add_f32 v102, 1.0, v102
    v_add_f32 v103, 1.0, v103
    v_rcp_f32 v96, v96
    v_rcp_f32 v97, v97
    v_rcp_f32 v98, v98
    v_rcp_f32 v99, v99
    v_rcp_f32 v100, v100
    v_rcp_f32 v101, v101
    v_rcp_f32 v102, v102
    v_rcp_f32 v103, v103
    v_mul_f32 v80, v128, v96
    v_mul_f32 v81, v129, v97
    v_mul_f32 v82, v130, v98
    v_mul_f32 v83, v131, v99
    v_mul_f32 v84, v132, v100
    v_mul_f32 v85, v133, v101
    v_mul_f32 v86, v134, v102
    v_mul_f32 v87, v135, v103
    s_cmp_eq_u32 s53, 0
    s_nop 0
    s_cbranch_scc1 recurrent_scan__sliding_block__moe_arch_mod__prompt_kernel_hret
    s_branch recurrent_scan__sliding_block__moe_arch_mod__prompt_kernel_fin
recurrent_scan__sliding_block__moe_arch_mod__prompt_kernel_ypre:
    s_cmp_eq_u32 s61, 0
    s_cbranch_scc1 recurrent_scan__sliding_block__moe_arch_mod__prompt_kernel_wow
    s_mov_b32 s62, 2
recurrent_scan__sliding_block__moe_arch_mod__prompt_kernel_yearly:
    s_mov_b32 s3, 0x10000
wl_78:
    ds_read_b128 v[136:139], v1 offset:16
    s_waitcnt lgkmcnt(0)
    v_min_u32 v136, v136, v137
    v_min3_u32 v136, v136, v138, v139
    s_nop 0
    v_readfirstlane_b32 s30, v136
    s_cmp_ge_u32 s30, 15
    s_nop 3
    s_cbranch_scc1 wl_78d
    s_sleep 2
    s_sub_u32 s3, s3, 1
    s_cbranch_scc0 wl_78
wl_78d:
    s_mov_b32 s3, 0x8000
    s_mov_b64 exec, 0xffff0003
    s_mov_b32 s59, 16
    s_branch recurrent_scan__sliding_block__moe_arch_mod__prompt_kernel_ysum
recurrent_scan__sliding_block__moe_arch_mod__prompt_kernel_yp:
    s_waitcnt vmcnt(0)
    v_cmp_ne_u32 vcc, s29, v125
    s_lshr_b32 s38, vcc_lo, 16
    s_bcnt1_i32_b32 s38, s38
    s_cmp_le_u32 s38, s59
    s_nop 1
    s_cbranch_scc1 recurrent_scan__sliding_block__moe_arch_mod__prompt_kernel_ysum
    s_and_b32 s38, vcc_lo, 3
    s_cbranch_scc0 recurrent_scan__sliding_block__moe_arch_mod__prompt_kernel_yesc
    s_sleep 2
    buffer_load_dwordx2 v[124:125], v127, s[40:43], 0 offen sc1
    s_sub_u32 s3, s3, 1
    s_cbranch_scc0 recurrent_scan__sliding_block__moe_arch_mod__prompt_kernel_yp
recurrent_scan__sliding_block__moe_arch_mod__prompt_kernel_yesc:
    s_cmp_eq_u32 s62, 2
    s_cbranch_scc0 recurrent_scan__sliding_block__moe_arch_mod__prompt_kernel_opd
    s_mov_b32 s62, 0
    s_mov_b64 exec, -1
    s_branch recurrent_scan__sliding_block__moe_arch_mod__prompt_kernel_wow
recurrent_scan__sliding_block__moe_arch_mod__prompt_kernel_yback:
    s_mov_b32 s59, 0
    s_bitset1_b32 s61, s70
    s_bitset1_b32 s61, s71
    s_and_b32 s61, s61, 0xff
    s_mov_b32 s3, 0x8000
    s_mov_b64 exec, 0xffff0003
    buffer_load_dwordx2 v[124:125], v127, s[40:43], 0 offen sc1
    s_branch recurrent_scan__sliding_block__moe_arch_mod__prompt_kernel_yp
recurrent_scan__sliding_block__moe_arch_mod__prompt_kernel_ysum:
    s_mov_b64 exec, -1
    v_lshrrev_b32 v16, 4, v0
    v_lshlrev_b32 v16, 14, v16
    v_and_b32 v17, 15, v0
    v_lshl_add_u32 v16, v17, 4, v16
    s_lshl_b32 s63, s26, 8
    s_lshl_b32 s39, s33, 16
    s_add_u32 s63, s63, s39
    s_add_u32 s63, s63, 6291456
    v_add_u32 v16, s63, v16
    s_cmp_lt_u32 s33, 2
    s_cselect_b32 s63, 786432, 0
    s_cselect_b32 s39, -1, 0
    s_mov_b32 s54, 0x00003f80
    s_mov_b32 s55, 0x3f800000
    s_and_b32 s56, s54, s39
    s_and_b32 s57, s55, s39
recurrent_scan__sliding_block__moe_arch_mod__prompt_kernel_yt:
    s_ff1_i32_b32 s70, s61
    s_bitset0_b32 s61, s70
    s_ff1_i32_b32 s71, s61
    s_bitset0_b32 s61, s71
    s_mov_b32 s3, 0x2000
recurrent_scan__sliding_block__moe_arch_mod__prompt_kernel_yr:
    s_lshl_b32 s65, s70, 11
    s_add_u32 s38, s65, s63
    buffer_load_dwordx4 v[148:151], v16, s[40:43], s38 offen sc1
    buffer_load_dwordx4 v[136:139], v16, s[40:43], s65 offen sc1
    s_add_u32 s65, s65, 262144
    buffer_load_dwordx4 v[140:143], v16, s[40:43], s65 offen sc1
    s_add_u32 s65, s65, 262144
    buffer_load_dwordx4 v[144:147], v16, s[40:43], s65 offen sc1
    s_cmp_lt_i32 s71, 0
    s_cbranch_scc1 recurrent_scan__sliding_block__moe_arch_mod__prompt_kernel_y1
    s_lshl_b32 s65, s71, 11
    s_add_u32 s38, s65, s63
    buffer_load_dwordx4 v[252:255], v16, s[40:43], s38 offen sc1
    buffer_load_dwordx4 v[240:243], v16, s[40:43], s65 offen sc1
    s_add_u32 s65, s65, 262144
    buffer_load_dwordx4 v[244:247], v16, s[40:43], s65 offen sc1
    s_add_u32 s65, s65, 262144
    buffer_load_dwordx4 v[248:251], v16, s[40:43], s65 offen sc1
recurrent_scan__sliding_block__moe_arch_mod__prompt_kernel_y1:
    s_mov_b64 exec, 3
    buffer_load_dwordx2 v[124:125], v127, s[40:43], 0 offen sc1
    s_mov_b64 exec, -1
    v_bfe_u32 v17, v0, 1, 1
    v_lshlrev_b32 v17, 7, v17
    v_bfe_u32 v22, v0, 2, 2
    v_lshl_add_u32 v17, v22, 3, v17
    v_and_b32 v22, 1, v0
    v_lshl_add_u32 v17, v22, 2, v17
    s_lshl_b32 s38, s33, 11
    s_add_u32 s38, s38, 90112
    v_add_u32 v17, s38, v17
    s_waitcnt vmcnt(1)
    v_readlane_b32 s64, v152, s70
    s_lshl_b32 s38, s70, 8
    v_add_u32 v18, s38, v17
    v_min3_u32 v20, s29, v149, v151
    v_max3_u32 v21, s29, v149, v151
    s_and_b32 s64, s64, 0xffff0000
    v_dot2_f32_bf16 v24, v148, s56, 0
    v_dot2_f32_bf16 v25, v148, s57, 0
    v_dot2_f32_bf16 v26, v150, s56, 0
    v_dot2_f32_bf16 v27, v150, s57, 0
    v_min3_u32 v20, v20, v137, v139
    v_max3_u32 v21, v21, v137, v139
    v_dot2_f32_bf16 v24, v136, s54, v24
    v_dot2_f32_bf16 v25, v136, s55, v25
    v_dot2_f32_bf16 v26, v138, s54, v26
    v_dot2_f32_bf16 v27, v138, s55, v27
    v_min3_u32 v20, v20, v141, v143
    v_max3_u32 v21, v21, v141, v143
    v_dot2_f32_bf16 v24, v140, s54, v24
    v_dot2_f32_bf16 v25, v140, s55, v25
    v_dot2_f32_bf16 v26, v142, s54, v26
    v_dot2_f32_bf16 v27, v142, s55, v27
    v_min3_u32 v20, v20, v145, v147
    v_max3_u32 v21, v21, v145, v147
    v_dot2_f32_bf16 v24, v144, s54, v24
    v_dot2_f32_bf16 v25, v144, s55, v25
    v_dot2_f32_bf16 v26, v146, s54, v26
    v_dot2_f32_bf16 v27, v146, s55, v27
    v_cmp_ne_u32 vcc, v20, v21
    s_nop 4
    s_cbranch_vccz recurrent_scan__sliding_block__moe_arch_mod__prompt_kernel_yg0
    s_cmp_lg_u32 s59, 0
    s_cbranch_scc1 recurrent_scan__sliding_block__moe_arch_mod__prompt_kernel_yback
    s_sub_u32 s3, s3, 1
    s_cbranch_scc0 recurrent_scan__sliding_block__moe_arch_mod__prompt_kernel_yr
recurrent_scan__sliding_block__moe_arch_mod__prompt_kernel_yg0:
    v_mov_b32 v28, v24
    v_mov_b32 v29, v25
    v_mov_b32 v30, v26
    v_mov_b32 v31, v27
    v_permlane16_swap_b32 v24, v28
    v_permlane16_swap_b32 v25, v29
    v_permlane16_swap_b32 v26, v30
    v_permlane16_swap_b32 v27, v31
    v_add_f32 v24, v24, v28
    v_add_f32 v25, v25, v29
    v_add_f32 v26, v26, v30
    v_add_f32 v27, v27, v31
    v_mov_b32 v28, v24
    v_mov_b32 v29, v25
    v_mov_b32 v30, v26
    v_mov_b32 v31, v27
    v_permlane32_swap_b32 v24, v28
    v_permlane32_swap_b32 v25, v29
    v_permlane32_swap_b32 v26, v30
    v_permlane32_swap_b32 v27, v31
    v_add_f32 v24, v24, v28
    v_add_f32 v25, v25, v29
    v_add_f32 v26, v26, v30
    v_add_f32 v27, v27, v31
    v_mul_f32 v24, s64, v24
    v_mul_f32 v25, s64, v25
    v_mul_f32 v26, s64, v26
    v_mul_f32 v27, s64, v27
    ds_write_b32 v18, v24 offset:0
    ds_write_b32 v18, v25 offset:32
    ds_write_b32 v18, v26 offset:64
    ds_write_b32 v18, v27 offset:96
    s_cmp_lt_i32 s71, 0
    s_cbranch_scc1 recurrent_scan__sliding_block__moe_arch_mod__prompt_kernel_ydone
    v_readlane_b32 s64, v152, s71
    s_lshl_b32 s38, s71, 8
    v_add_u32 v18, s38, v17
    v_min3_u32 v20, s29, v253, v255
    v_max3_u32 v21, s29, v253, v255
    s_and_b32 s64, s64, 0xffff0000
    v_dot2_f32_bf16 v24, v252, s56, 0
    v_dot2_f32_bf16 v25, v252, s57, 0
    v_dot2_f32_bf16 v26, v254, s56, 0
    v_dot2_f32_bf16 v27, v254, s57, 0
    v_min3_u32 v20, v20, v241, v243
    v_max3_u32 v21, v21, v241, v243
    v_dot2_f32_bf16 v24, v240, s54, v24
    v_dot2_f32_bf16 v25, v240, s55, v25
    v_dot2_f32_bf16 v26, v242, s54, v26
    v_dot2_f32_bf16 v27, v242, s55, v27
    v_min3_u32 v20, v20, v245, v247
    v_max3_u32 v21, v21, v245, v247
    v_dot2_f32_bf16 v24, v244, s54, v24
    v_dot2_f32_bf16 v25, v244, s55, v25
    v_dot2_f32_bf16 v26, v246, s54, v26
    v_dot2_f32_bf16 v27, v246, s55, v27
    v_min3_u32 v20, v20, v249, v251
    v_max3_u32 v21, v21, v249, v251
    v_dot2_f32_bf16 v24, v248, s54, v24
    v_dot2_f32_bf16 v25, v248, s55, v25
    v_dot2_f32_bf16 v26, v250, s54, v26
    v_dot2_f32_bf16 v27, v250, s55, v27
    v_cmp_ne_u32 vcc, v20, v21
    s_nop 4
    s_cbranch_vccz recurrent_scan__sliding_block__moe_arch_mod__prompt_kernel_yg1
    s_cmp_lg_u32 s59, 0
    s_cbranch_scc1 recurrent_scan__sliding_block__moe_arch_mod__prompt_kernel_yback
    s_sub_u32 s3, s3, 1
    s_cbranch_scc0 recurrent_scan__sliding_block__moe_arch_mod__prompt_kernel_yr
recurrent_scan__sliding_block__moe_arch_mod__prompt_kernel_yg1:
    v_mov_b32 v28, v24
    v_mov_b32 v29, v25
    v_mov_b32 v30, v26
    v_mov_b32 v31, v27
    v_permlane16_swap_b32 v24, v28
    v_permlane16_swap_b32 v25, v29
    v_permlane16_swap_b32 v26, v30
    v_permlane16_swap_b32 v27, v31
    v_add_f32 v24, v24, v28
    v_add_f32 v25, v25, v29
    v_add_f32 v26, v26, v30
    v_add_f32 v27, v27, v31
    v_mov_b32 v28, v24
    v_mov_b32 v29, v25
    v_mov_b32 v30, v26
    v_mov_b32 v31, v27
    v_permlane32_swap_b32 v24, v28
    v_permlane32_swap_b32 v25, v29
    v_permlane32_swap_b32 v26, v30
    v_permlane32_swap_b32 v27, v31
    v_add_f32 v24, v24, v28
    v_add_f32 v25, v25, v29
    v_add_f32 v26, v26, v30
    v_add_f32 v27, v27, v31
    v_mul_f32 v24, s64, v24
    v_mul_f32 v25, s64, v25
    v_mul_f32 v26, s64, v26
    v_mul_f32 v27, s64, v27
    ds_write_b32 v18, v24 offset:0
    ds_write_b32 v18, v25 offset:32
    ds_write_b32 v18, v26 offset:64
    ds_write_b32 v18, v27 offset:96
    s_cmp_lg_u32 s61, 0
    s_cbranch_scc1 recurrent_scan__sliding_block__moe_arch_mod__prompt_kernel_yt
recurrent_scan__sliding_block__moe_arch_mod__prompt_kernel_ydone:
    s_setprio 0
    v_mov_b32 v22, s68
    ds_write_b32 v7, v22 offset:64
    s_waitcnt vmcnt(0)
    s_cmp_eq_u32 s62, 1
    s_cbranch_scc1 recurrent_scan__sliding_block__moe_arch_mod__prompt_kernel_yret
    s_cmp_eq_u32 s62, 2
    s_cbranch_scc1 recurrent_scan__sliding_block__moe_arch_mod__prompt_kernel_yesc
    v_cmp_ne_u32 vcc, s29, v125
    s_and_b32 s38, vcc_lo, 3
    s_nop 3
    s_cbranch_scc0 recurrent_scan__sliding_block__moe_arch_mod__prompt_kernel_opd
    s_branch recurrent_scan__sliding_block__moe_arch_mod__prompt_kernel_yeret
slw_31:
    s_nop 7
    s_nop 3
    s_waitcnt lgkmcnt(0)
    v_mfma_f32_32x32x16_bf16 v[32:47], v[112:115], v[80:83], 0
    v_mfma_f32_16x16x32_bf16 v[64:67], v[112:115], v[68:71], 0
    v_mfma_f32_32x32x16_bf16 v[48:63], v[80:83], v[116:119], 0
    v_mov_b32 v6, 1
    ds_write_b32 v4, v6 offset:16
    v_mfma_f32_16x16x32_bf16 v[64:67], v[116:119], v[72:75], v[64:67]
    v_mfma_f32_32x32x16_bf16 v[32:47], v[120:123], v[84:87], v[32:47]
    v_mfma_f32_16x16x32_bf16 v[64:67], v[120:123], v[68:71], v[64:67]
    v_mfma_f32_32x32x16_bf16 v[48:63], v[84:87], v[124:127], v[48:63]
    v_mfma_f32_16x16x32_bf16 v[64:67], v[124:127], v[72:75], v[64:67]
    v_mfma_f32_32x32x16_bf16 v[32:47], v[128:131], v[88:91], v[32:47]
    v_mfma_f32_32x32x16_bf16 v[48:63], v[88:91], v[132:135], v[48:63]
    v_mfma_f32_32x32x16_bf16 v[32:47], v[136:139], v[92:95], v[32:47]
    v_mfma_f32_32x32x16_bf16 v[48:63], v[92:95], v[140:143], v[48:63]
    s_mov_b32 s3, 0x10000
    s_nop 7
    s_nop 2
wl_79:
    ds_read_b64 v[2:3], v1 offset:0
    s_waitcnt lgkmcnt(0)
    v_min_u32 v2, v2, v3
    s_nop 0
    v_readfirstlane_b32 s30, v2
    s_cmp_ge_u32 s30, 2
    s_nop 3
    s_cbranch_scc1 wl_79d
    s_sub_u32 s3, s3, 1
    s_cbranch_scc0 wl_79
wl_79d:
    ds_read_b128 v[96:99], v176 offset:8192
    ds_read_b64_tr_b16 v[144:145], v180 offset:16384
    ds_read_b64_tr_b16 v[146:147], v180 offset:16896
    ds_read_b64_tr_b16 v[148:149], v180 offset:17408
    ds_read_b64_tr_b16 v[150:151], v180 offset:17920
    ds_read_b128 v[100:103], v177 offset:8192
    ds_read_b64_tr_b16 v[152:153], v181 offset:16384
    ds_read_b64_tr_b16 v[154:155], v181 offset:16896
    ds_read_b64_tr_b16 v[156:157], v181 offset:17408
    ds_read_b64_tr_b16 v[158:159], v181 offset:17920
    ds_read_b128 v[104:107], v178 offset:8192
    ds_read_b64_tr_b16 v[160:161], v182 offset:16384
    ds_read_b64_tr_b16 v[162:163], v182 offset:16896
    ds_read_b64_tr_b16 v[164:165], v182 offset:17408
    ds_read_b64_tr_b16 v[166:167], v182 offset:17920
    ds_read_b64 v[2:3], v1 offset:0
    ds_read_b128 v[108:111], v179 offset:8192
    ds_read_b64_tr_b16 v[168:169], v183 offset:16384
    ds_read_b64_tr_b16 v[170:171], v183 offset:16896
    ds_read_b64_tr_b16 v[172:173], v183 offset:17408
    ds_read_b64_tr_b16 v[174:175], v183 offset:17920
    s_waitcnt lgkmcnt(0)
    s_branch mrg_32
slw_33:
    s_nop 7
    s_nop 3
    s_waitcnt lgkmcnt(0)
    v_mfma_f32_32x32x16_bf16 v[32:47], v[144:147], v[96:99], v[32:47]
    v_mfma_f32_16x16x32_bf16 v[64:67], v[144:147], v[68:71], v[64:67]
    v_mfma_f32_32x32x16_bf16 v[48:63], v[96:99], v[148:151], v[48:63]
    v_mov_b32 v6, 2
    ds_write_b32 v4, v6 offset:16
    v_mfma_f32_16x16x32_bf16 v[64:67], v[148:151], v[72:75], v[64:67]
    v_mfma_f32_32x32x16_bf16 v[32:47], v[152:155], v[100:103], v[32:47]
    v_mfma_f32_16x16x32_bf16 v[64:67], v[152:155], v[68:71], v[64:67]
    v_mfma_f32_32x32x16_bf16 v[48:63], v[100:103], v[156:159], v[48:63]
    v_mfma_f32_16x16x32_bf16 v[64:67], v[156:159], v[72:75], v[64:67]
    v_mfma_f32_32x32x16_bf16 v[32:47], v[160:163], v[104:107], v[32:47]
    v_mfma_f32_32x32x16_bf16 v[48:63], v[104:107], v[164:167], v[48:63]
    v_mfma_f32_32x32x16_bf16 v[32:47], v[168:171], v[108:111], v[32:47]
    v_mfma_f32_32x32x16_bf16 v[48:63], v[108:111], v[172:175], v[48:63]
    s_mov_b32 s3, 0x10000
    s_nop 7
    s_nop 2
wl_80:
    ds_read_b64 v[2:3], v1 offset:0
    s_waitcnt lgkmcnt(0)
    v_min_u32 v2, v2, v3
    s_nop 0
    v_readfirstlane_b32 s30, v2
    s_cmp_ge_u32 s30, 3
    s_nop 3
    s_cbranch_scc1 wl_80d
    s_sub_u32 s3, s3, 1
    s_cbranch_scc0 wl_80
wl_80d:
    ds_read_b128 v[80:83], v176 offset:16384
    ds_read_b64_tr_b16 v[112:113], v180 offset:32768
    ds_read_b64_tr_b16 v[114:115], v180 offset:33280
    ds_read_b64_tr_b16 v[116:117], v180 offset:33792
    ds_read_b64_tr_b16 v[118:119], v180 offset:34304
    ds_read_b128 v[84:87], v177 offset:16384
    ds_read_b64_tr_b16 v[120:121], v181 offset:32768
    ds_read_b64_tr_b16 v[122:123], v181 offset:33280
    ds_read_b64_tr_b16 v[124:125], v181 offset:33792
    ds_read_b64_tr_b16 v[126:127], v181 offset:34304
    ds_read_b128 v[88:91], v178 offset:16384
    ds_read_b64_tr_b16 v[128:129], v182 offset:32768
    ds_read_b64_tr_b16 v[130:131], v182 offset:33280
    ds_read_b64_tr_b16 v[132:133], v182 offset:33792
    ds_read_b64_tr_b16 v[134:135], v182 offset:34304
    ds_read_b64 v[2:3], v1 offset:0
    ds_read_b128 v[92:95], v179 offset:16384
    ds_read_b64_tr_b16 v[136:137], v183 offset:32768
    ds_read_b64_tr_b16 v[138:139], v183 offset:33280
    ds_read_b64_tr_b16 v[140:141], v183 offset:33792
    ds_read_b64_tr_b16 v[142:143], v183 offset:34304
    s_waitcnt lgkmcnt(0)
    s_branch mrg_34
slw_35:
    s_nop 7
    s_nop 3
    s_waitcnt lgkmcnt(0)
    v_mfma_f32_32x32x16_bf16 v[32:47], v[112:115], v[80:83], v[32:47]
    v_mfma_f32_16x16x32_bf16 v[64:67], v[112:115], v[68:71], v[64:67]
    v_mfma_f32_32x32x16_bf16 v[48:63], v[80:83], v[116:119], v[48:63]
    v_mov_b32 v6, 3
    ds_write_b32 v4, v6 offset:16
    v_mfma_f32_16x16x32_bf16 v[64:67], v[116:119], v[72:75], v[64:67]
    v_mfma_f32_32x32x16_bf16 v[32:47], v[120:123], v[84:87], v[32:47]
    v_mfma_f32_16x16x32_bf16 v[64:67], v[120:123], v[68:71], v[64:67]
    v_mfma_f32_32x32x16_bf16 v[48:63], v[84:87], v[124:127], v[48:63]
    v_mfma_f32_16x16x32_bf16 v[64:67], v[124:127], v[72:75], v[64:67]
    v_mfma_f32_32x32x16_bf16 v[32:47], v[128:131], v[88:91], v[32:47]
    v_mfma_f32_32x32x16_bf16 v[48:63], v[88:91], v[132:135], v[48:63]
    v_mfma_f32_32x32x16_bf16 v[32:47], v[136:139], v[92:95], v[32:47]
    v_mfma_f32_32x32x16_bf16 v[48:63], v[92:95], v[140:143], v[48:63]
    s_mov_b32 s3, 0x10000
    s_nop 7
    s_nop 2
wl_81:
    ds_read_b64 v[2:3], v1 offset:0
    s_waitcnt lgkmcnt(0)
    v_min_u32 v2, v2, v3
    s_nop 0
    v_readfirstlane_b32 s30, v2
    s_cmp_ge_u32 s30, 4
    s_nop 3
    s_cbranch_scc1 wl_81d
    s_sub_u32 s3, s3, 1
    s_cbranch_scc0 wl_81
wl_81d:
    ds_read_b128 v[96:99], v176 offset:24576
    ds_read_b64_tr_b16 v[144:145], v180 offset:49152
    ds_read_b64_tr_b16 v[146:147], v180 offset:49664
    ds_read_b64_tr_b16 v[148:149], v180 offset:50176
    ds_read_b64_tr_b16 v[150:151], v180 offset:50688
    ds_read_b128 v[100:103], v177 offset:24576
    ds_read_b64_tr_b16 v[152:153], v181 offset:49152
    ds_read_b64_tr_b16 v[154:155], v181 offset:49664
    ds_read_b64_tr_b16 v[156:157], v181 offset:50176
    ds_read_b64_tr_b16 v[158:159], v181 offset:50688
    ds_read_b128 v[104:107], v178 offset:24576
    ds_read_b64_tr_b16 v[160:161], v182 offset:49152
    ds_read_b64_tr_b16 v[162:163], v182 offset:49664
    ds_read_b64_tr_b16 v[164:165], v182 offset:50176
    ds_read_b64_tr_b16 v[166:167], v182 offset:50688
    ds_read_b64 v[2:3], v1 offset:0
    ds_read_b128 v[108:111], v179 offset:24576
    ds_read_b64_tr_b16 v[168:169], v183 offset:49152
    ds_read_b64_tr_b16 v[170:171], v183 offset:49664
    ds_read_b64_tr_b16 v[172:173], v183 offset:50176
    ds_read_b64_tr_b16 v[174:175], v183 offset:50688
    v_add_u32 v180, 65536, v180
    v_add_u32 v181, 65536, v181
    v_add_u32 v182, 65536, v182
    v_add_u32 v183, 65536, v183
    s_waitcnt lgkmcnt(0)
    s_nop 0
    s_branch mrg_36
slw_37:
    s_nop 7
    s_nop 3
    s_waitcnt lgkmcnt(0)
    v_mfma_f32_32x32x16_bf16 v[32:47], v[144:147], v[96:99], v[32:47]
    v_mfma_f32_16x16x32_bf16 v[64:67], v[144:147], v[68:71], v[64:67]
    v_mfma_f32_32x32x16_bf16 v[48:63], v[96:99], v[148:151], v[48:63]
    v_mov_b32 v6, 4
    ds_write_b32 v4, v6 offset:16
    v_mfma_f32_16x16x32_bf16 v[64:67], v[148:151], v[72:75], v[64:67]
    v_mfma_f32_32x32x16_bf16 v[32:47], v[152:155], v[100:103], v[32:47]
    v_mfma_f32_16x16x32_bf16 v[64:67], v[152:155], v[68:71], v[64:67]
    v_mfma_f32_32x32x16_bf16 v[48:63], v[100:103], v[156:159], v[48:63]
    v_mfma_f32_16x16x32_bf16 v[64:67], v[156:159], v[72:75], v[64:67]
    v_mfma_f32_32x32x16_bf16 v[32:47], v[160:163], v[104:107], v[32:47]
    v_mfma_f32_32x32x16_bf16 v[48:63], v[104:107], v[164:167], v[48:63]
    v_mfma_f32_32x32x16_bf16 v[32:47], v[168:171], v[108:111], v[32:47]
    v_mfma_f32_32x32x16_bf16 v[48:63], v[108:111], v[172:175], v[48:63]
    s_mov_b32 s3, 0x10000
    s_nop 7
    s_nop 2
wl_82:
    ds_read_b64 v[2:3], v1 offset:0
    s_waitcnt lgkmcnt(0)
    v_min_u32 v2, v2, v3
    s_nop 0
    v_readfirstlane_b32 s30, v2
    s_cmp_ge_u32 s30, 5
    s_nop 3
    s_cbranch_scc1 wl_82d
    s_sub_u32 s3, s3, 1
    s_cbranch_scc0 wl_82
wl_82d:
    ds_read_b128 v[80:83], v176 offset:32768
    ds_read_b64_tr_b16 v[112:113], v180 offset:0
    ds_read_b64_tr_b16 v[114:115], v180 offset:512
    ds_read_b64_tr_b16 v[116:117], v180 offset:1024
    ds_read_b64_tr_b16 v[118:119], v180 offset:1536
    ds_read_b128 v[84:87], v177 offset:32768
    ds_read_b64_tr_b16 v[120:121], v181 offset:0
    ds_read_b64_tr_b16 v[122:123], v181 offset:512
    ds_read_b64_tr_b16 v[124:125], v181 offset:1024
    ds_read_b64_tr_b16 v[126:127], v181 offset:1536
    ds_read_b128 v[88:91], v178 offset:32768
    ds_read_b64_tr_b16 v[128:129], v182 offset:0
    ds_read_b64_tr_b16 v[130:131], v182 offset:512
    ds_read_b64_tr_b16 v[132:133], v182 offset:1024
    ds_read_b64_tr_b16 v[134:135], v182 offset:1536
    ds_read_b64 v[2:3], v1 offset:0
    ds_read_b128 v[92:95], v179 offset:32768
    ds_read_b64_tr_b16 v[136:137], v183 offset:0
    ds_read_b64_tr_b16 v[138:139], v183 offset:512
    ds_read_b64_tr_b16 v[140:141], v183 offset:1024
    ds_read_b64_tr_b16 v[142:143], v183 offset:1536
    v_add_u32 v180, -65536, v180
    v_add_u32 v181, -65536, v181
    v_add_u32 v182, -65536, v182
    v_add_u32 v183, -65536, v183
    s_waitcnt lgkmcnt(0)
    s_nop 0
    s_branch mrg_38
slw_39:
    s_nop 7
    s_nop 3
    s_waitcnt lgkmcnt(0)
    v_mfma_f32_32x32x16_bf16 v[32:47], v[112:115], v[80:83], v[32:47]
    v_mfma_f32_16x16x32_bf16 v[64:67], v[112:115], v[68:71], v[64:67]
    v_mfma_f32_32x32x16_bf16 v[48:63], v[80:83], v[116:119], v[48:63]
    v_mov_b32 v6, 5
    ds_write_b32 v4, v6 offset:16
    v_mfma_f32_16x16x32_bf16 v[64:67], v[116:119], v[72:75], v[64:67]
    v_mfma_f32_32x32x16_bf16 v[32:47], v[120:123], v[84:87], v[32:47]
    v_mfma_f32_16x16x32_bf16 v[64:67], v[120:123], v[68:71], v[64:67]
    v_mfma_f32_32x32x16_bf16 v[48:63], v[84:87], v[124:127], v[48:63]
    v_mfma_f32_16x16x32_bf16 v[64:67], v[124:127], v[72:75], v[64:67]
    v_mfma_f32_32x32x16_bf16 v[32:47], v[128:131], v[88:91], v[32:47]
    v_mfma_f32_32x32x16_bf16 v[48:63], v[88:91], v[132:135], v[48:63]
    v_mfma_f32_32x32x16_bf16 v[32:47], v[136:139], v[92:95], v[32:47]
    v_mfma_f32_32x32x16_bf16 v[48:63], v[92:95], v[140:143], v[48:63]
    s_mov_b32 s3, 0x10000
    s_nop 7
    s_nop 2
wl_83:
    ds_read_b64 v[2:3], v1 offset:0
    s_waitcnt lgkmcnt(0)
    v_min_u32 v2, v2, v3
    s_nop 0
    v_readfirstlane_b32 s30, v2
    s_cmp_ge_u32 s30, 6
    s_nop 3
    s_cbranch_scc1 wl_83d
    s_sub_u32 s3, s3, 1
    s_cbranch_scc0 wl_83
wl_83d:
    ds_read_b128 v[96:99], v176 offset:40960
    ds_read_b64_tr_b16 v[144:145], v180 offset:0
    ds_read_b64_tr_b16 v[146:147], v180 offset:512
    ds_read_b64_tr_b16 v[148:149], v180 offset:1024
    ds_read_b64_tr_b16 v[150:151], v180 offset:1536
    ds_read_b128 v[100:103], v177 offset:40960
    ds_read_b64_tr_b16 v[152:153], v181 offset:0
    ds_read_b64_tr_b16 v[154:155], v181 offset:512
    ds_read_b64_tr_b16 v[156:157], v181 offset:1024
    ds_read_b64_tr_b16 v[158:159], v181 offset:1536
    ds_read_b128 v[104:107], v178 offset:40960
    ds_read_b64_tr_b16 v[160:161], v182 offset:0
    ds_read_b64_tr_b16 v[162:163], v182 offset:512
    ds_read_b64_tr_b16 v[164:165], v182 offset:1024
    ds_read_b64_tr_b16 v[166:167], v182 offset:1536
    ds_read_b64 v[2:3], v1 offset:0
    ds_read_b128 v[108:111], v179 offset:40960
    ds_read_b64_tr_b16 v[168:169], v183 offset:0
    ds_read_b64_tr_b16 v[170:171], v183 offset:512
    ds_read_b64_tr_b16 v[172:173], v183 offset:1024
    ds_read_b64_tr_b16 v[174:175], v183 offset:1536
    s_waitcnt lgkmcnt(0)
    s_branch mrg_40
slw_41:
    s_nop 7
    s_nop 3
    s_waitcnt lgkmcnt(0)
    v_mfma_f32_32x32x16_bf16 v[32:47], v[144:147], v[96:99], v[32:47]
    v_mfma_f32_16x16x32_bf16 v[64:67], v[144:147], v[68:71], v[64:67]
    v_mfma_f32_32x32x16_bf16 v[48:63], v[96:99], v[148:151], v[48:63]
    v_mov_b32 v6, 6
    ds_write_b32 v4, v6 offset:16
    v_mfma_f32_16x16x32_bf16 v[64:67], v[148:151], v[72:75], v[64:67]
    v_mfma_f32_32x32x16_bf16 v[32:47], v[152:155], v[100:103], v[32:47]
    v_mfma_f32_16x16x32_bf16 v[64:67], v[152:155], v[68:71], v[64:67]
    v_mfma_f32_32x32x16_bf16 v[48:63], v[100:103], v[156:159], v[48:63]
    v_mfma_f32_16x16x32_bf16 v[64:67], v[156:159], v[72:75], v[64:67]
    v_mfma_f32_32x32x16_bf16 v[32:47], v[160:163], v[104:107], v[32:47]
    v_mfma_f32_32x32x16_bf16 v[48:63], v[104:107], v[164:167], v[48:63]
    v_mfma_f32_32x32x16_bf16 v[32:47], v[168:171], v[108:111], v[32:47]
    v_mfma_f32_32x32x16_bf16 v[48:63], v[108:111], v[172:175], v[48:63]
    s_mov_b32 s3, 0x10000
    s_nop 7
    s_nop 2
wl_84:
    ds_read_b64 v[2:3], v1 offset:0
    s_waitcnt lgkmcnt(0)
    v_min_u32 v2, v2, v3
    s_nop 0
    v_readfirstlane_b32 s30, v2
    s_cmp_ge_u32 s30, 7
    s_nop 3
    s_cbranch_scc1 wl_84d
    s_sub_u32 s3, s3, 1
    s_cbranch_scc0 wl_84
wl_84d:
    ds_read_b128 v[80:83], v176 offset:49152
    ds_read_b64_tr_b16 v[112:113], v180 offset:16384
    ds_read_b64_tr_b16 v[114:115], v180 offset:16896
    ds_read_b64_tr_b16 v[116:117], v180 offset:17408
    ds_read_b64_tr_b16 v[118:119], v180 offset:17920
    ds_read_b128 v[84:87], v177 offset:49152
    ds_read_b64_tr_b16 v[120:121], v181 offset:16384
    ds_read_b64_tr_b16 v[122:123], v181 offset:16896
    ds_read_b64_tr_b16 v[124:125], v181 offset:17408
    ds_read_b64_tr_b16 v[126:127], v181 offset:17920
    ds_read_b128 v[88:91], v178 offset:49152
    ds_read_b64_tr_b16 v[128:129], v182 offset:16384
    ds_read_b64_tr_b16 v[130:131], v182 offset:16896
    ds_read_b64_tr_b16 v[132:133], v182 offset:17408
    ds_read_b64_tr_b16 v[134:135], v182 offset:17920
    ds_read_b64 v[2:3], v1 offset:0
    ds_read_b128 v[92:95], v179 offset:49152
    ds_read_b64_tr_b16 v[136:137], v183 offset:16384
    ds_read_b64_tr_b16 v[138:139], v183 offset:16896
    ds_read_b64_tr_b16 v[140:141], v183 offset:17408
    ds_read_b64_tr_b16 v[142:143], v183 offset:17920
    s_waitcnt lgkmcnt(0)
    s_branch mrg_42
slw_43:
    s_nop 7
    s_nop 3
    s_waitcnt lgkmcnt(0)
    v_mfma_f32_32x32x16_bf16 v[32:47], v[112:115], v[80:83], v[32:47]
    v_mfma_f32_16x16x32_bf16 v[64:67], v[112:115], v[68:71], v[64:67]
    v_mfma_f32_32x32x16_bf16 v[48:63], v[80:83], v[116:119], v[48:63]
    v_mov_b32 v6, 7
    ds_write_b32 v4, v6 offset:16
    v_mfma_f32_16x16x32_bf16 v[64:67], v[116:119], v[72:75], v[64:67]
    v_mfma_f32_32x32x16_bf16 v[32:47], v[120:123], v[84:87], v[32:47]
    v_mfma_f32_16x16x32_bf16 v[64:67], v[120:123], v[68:71], v[64:67]
    v_mfma_f32_32x32x16_bf16 v[48:63], v[84:87], v[124:127], v[48:63]
    v_mfma_f32_16x16x32_bf16 v[64:67], v[124:127], v[72:75], v[64:67]
    v_mfma_f32_32x32x16_bf16 v[32:47], v[128:131], v[88:91], v[32:47]
    v_mfma_f32_32x32x16_bf16 v[48:63], v[88:91], v[132:135], v[48:63]
    s_nop 5
    ds_write_b128 v189, v[64:67]
    v_xor_b32 v78, 4, v4
    v_xor_b32 v5, 1024, v189
    v_mfma_f32_32x32x16_bf16 v[32:47], v[136:139], v[92:95], v[32:47]
    v_mfma_f32_32x32x16_bf16 v[48:63], v[92:95], v[140:143], v[48:63]
    s_mov_b32 s3, 0x10000
    s_nop 7
    s_nop 2
wl_85:
    ds_read_b64 v[2:3], v1 offset:0
    s_waitcnt lgkmcnt(0)
    v_min_u32 v2, v2, v3
    s_nop 0
    v_readfirstlane_b32 s30, v2
    s_cmp_ge_u32 s30, 8
    s_nop 3
    s_cbranch_scc1 wl_85d
    s_sub_u32 s3, s3, 1
    s_cbranch_scc0 wl_85
wl_85d:
    ds_read_b128 v[96:99], v176 offset:57344
    ds_read_b64_tr_b16 v[144:145], v180 offset:32768
    ds_read_b64_tr_b16 v[146:147], v180 offset:33280
    ds_read_b64_tr_b16 v[148:149], v180 offset:33792
    ds_read_b64_tr_b16 v[150:151], v180 offset:34304
    ds_read_b128 v[100:103], v177 offset:57344
    ds_read_b64_tr_b16 v[152:153], v181 offset:32768
    ds_read_b64_tr_b16 v[154:155], v181 offset:33280
    ds_read_b64_tr_b16 v[156:157], v181 offset:33792
    ds_read_b64_tr_b16 v[158:159], v181 offset:34304
    ds_read_b128 v[104:107], v178 offset:57344
    ds_read_b64_tr_b16 v[160:161], v182 offset:32768
    ds_read_b64_tr_b16 v[162:163], v182 offset:33280
    ds_read_b64_tr_b16 v[164:165], v182 offset:33792
    ds_read_b64_tr_b16 v[166:167], v182 offset:34304
    ds_read_b32 v2, v1 offset:172
    ds_read_b128 v[108:111], v179 offset:57344
    ds_read_b64_tr_b16 v[168:169], v183 offset:32768
    ds_read_b64_tr_b16 v[170:171], v183 offset:33280
    ds_read_b64_tr_b16 v[172:173], v183 offset:33792
    ds_read_b64_tr_b16 v[174:175], v183 offset:34304
    s_waitcnt lgkmcnt(0)
    s_branch mrg_44
slw_50:
    s_nop 7
    s_nop 3
    s_waitcnt lgkmcnt(0)
    v_mfma_f32_32x32x16_bf16 v[16:31], v[144:147], v[80:83], 0
    v_add3_u32 v72, v248, v249, v250
    v_add3_u32 v73, v251, v252, v253
    v_add3_u32 v72, v72, v254, v255
    v_add_u32 v72, v72, v73
    v_lshrrev_b32 v12, 5, v0
    v_mfma_f32_16x16x32_bf16 v[64:67], v[144:147], v[68:71], 0
    v_cndmask_b32_e64 v73, v72, 0, s[10:11]
    v_cndmask_b32_e64 v72, 0, v72, s[10:11]
    v_mfma_f32_32x32x16_bf16 v[16:31], v[148:151], v[84:87], v[16:31]
    v_mov_b32 v6, 9
    ds_write_b32 v4, v6 offset:16
    v_mfma_f32_16x16x32_bf16 v[64:67], v[148:151], v[68:71], v[64:67]
    v_add3_u32 v73, v73, v240, v241
    v_add3_u32 v72, v72, v244, v245
    v_mfma_f32_32x32x16_bf16 v[16:31], v[152:155], v[88:91], v[16:31]
    v_add3_u32 v73, v73, v242, v243
    v_add3_u32 v72, v72, v246, v247
    v_lshl_add_u32 v12, v12, 2, s38
    v_mov_b32 v14, 1
    v_mfma_f32_32x32x16_bf16 v[16:31], v[156:159], v[92:95], v[16:31]
    v_permlane32_swap_b32 v73, v72
    v_mul_f32 v10, 0x3eb8aa3b, v10
    v_add_u32 v73, v73, v72
    v_mul_f32 v11, 0x3eb8aa3b, v11
    v_mfma_f32_32x32x16_bf16 v[16:31], v[160:163], v[96:99], v[16:31]
    v_add_u32_dpp v73, v73, v73 quad_perm:[1,0,3,2] row_mask:0xf bank_mask:0xf
    v_mfma_f32_16x16x32_bf16 v[64:67], v[160:163], v[68:71], v[64:67]
    s_nop 0
    v_add_u32_dpp v73, v73, v73 quad_perm:[2,3,0,1] row_mask:0xf bank_mask:0xf
    v_mfma_f32_32x32x16_bf16 v[16:31], v[164:167], v[100:103], v[16:31]
    s_nop 0
    v_add_u32_dpp v73, v73, v73 row_half_mirror row_mask:0xf bank_mask:0xf
    v_mfma_f32_16x16x32_bf16 v[64:67], v[164:167], v[68:71], v[64:67]
    s_nop 0
    v_add_u32_dpp v73, v73, v73 row_mirror row_mask:0xf bank_mask:0xf
    v_mfma_f32_32x32x16_bf16 v[16:31], v[168:171], v[104:107], v[16:31]
    s_mov_b64 exec, s[36:37]
    ds_add_u32 v12, v73
    s_mov_b64 exec, 1
    ds_add_u32 v1, v14 offset:160
    s_mov_b64 exec, -1
    v_mfma_f32_32x32x16_bf16 v[16:31], v[172:175], v[108:111], v[16:31]
    s_mov_b32 s3, 0x10000
    s_nop 7
    s_nop 2
wl_86:
    ds_read_b64 v[2:3], v1 offset:0
    s_waitcnt lgkmcnt(0)
    v_min_u32 v2, v2, v3
    s_nop 0
    v_readfirstlane_b32 s30, v2
    s_cmp_ge_u32 s30, 10
    s_nop 3
    s_cbranch_scc1 wl_86d
    s_sub_u32 s3, s3, 1
    s_cbranch_scc0 wl_86
wl_86d:
    ds_read_b128 v[32:35], v176 offset:16384
    ds_read_b64_tr_b16 v[112:113], v180 offset:0
    ds_read_b64_tr_b16 v[114:115], v180 offset:512
    ds_read_b128 v[36:39], v177 offset:16384
    ds_read_b64_tr_b16 v[116:117], v181 offset:0
    ds_read_b64_tr_b16 v[118:119], v181 offset:512
    ds_read_b128 v[40:43], v178 offset:16384
    ds_read_b64_tr_b16 v[120:121], v182 offset:0
    ds_read_b64_tr_b16 v[122:123], v182 offset:512
    ds_read_b128 v[44:47], v179 offset:16384
    ds_read_b64_tr_b16 v[124:125], v183 offset:0
    ds_read_b64_tr_b16 v[126:127], v183 offset:512
    ds_read_b128 v[48:51], v176 offset:24576
    ds_read_b64_tr_b16 v[128:129], v180 offset:8192
    ds_read_b64_tr_b16 v[130:131], v180 offset:8704
    ds_read_b128 v[52:55], v177 offset:24576
    ds_read_b64_tr_b16 v[132:133], v181 offset:8192
    ds_read_b64_tr_b16 v[134:135], v181 offset:8704
    ds_read_b64 v[2:3], v1 offset:0
    ds_read_b128 v[56:59], v178 offset:24576
    ds_read_b64_tr_b16 v[136:137], v182 offset:8192
    ds_read_b64_tr_b16 v[138:139], v182 offset:8704
    ds_read_b128 v[60:63], v179 offset:24576
    ds_read_b64_tr_b16 v[140:141], v183 offset:8192
    ds_read_b64_tr_b16 v[142:143], v183 offset:8704
    v_add_u32 v180, -65536, v180
    v_add_u32 v181, -65536, v181
    v_add_u32 v182, -65536, v182
    v_add_u32 v183, -65536, v183
    s_waitcnt lgkmcnt(0)
    s_nop 0
    s_branch mrg_51
slw_52:
    s_nop 7
    s_nop 3
    s_waitcnt lgkmcnt(0)
    v_mfma_f32_32x32x16_bf16 v[16:31], v[112:115], v[32:35], v[16:31]
    ds_read_b32 v13, v1 offset:32
    v_mfma_f32_16x16x32_bf16 v[64:67], v[112:115], v[68:71], v[64:67]
    v_mfma_f32_32x32x16_bf16 v[16:31], v[116:119], v[36:39], v[16:31]
    v_mov_b32 v6, 10
    ds_write_b32 v4, v6 offset:16
    v_mfma_f32_16x16x32_bf16 v[64:67], v[116:119], v[68:71], v[64:67]
    v_mfma_f32_32x32x16_bf16 v[16:31], v[120:123], v[40:43], v[16:31]
    v_mfma_f32_32x32x16_bf16 v[16:31], v[124:127], v[44:47], v[16:31]
    v_mfma_f32_32x32x16_bf16 v[16:31], v[128:131], v[48:51], v[16:31]
    v_mfma_f32_16x16x32_bf16 v[64:67], v[128:131], v[68:71], v[64:67]
    v_mfma_f32_32x32x16_bf16 v[16:31], v[132:135], v[52:55], v[16:31]
    v_mfma_f32_16x16x32_bf16 v[64:67], v[132:135], v[68:71], v[64:67]
    v_mfma_f32_32x32x16_bf16 v[16:31], v[136:139], v[56:59], v[16:31]
    v_mfma_f32_32x32x16_bf16 v[16:31], v[140:143], v[60:63], v[16:31]
    s_mov_b32 s3, 0x10000
    s_nop 7
    s_nop 2
wl_87:
    ds_read_b64 v[2:3], v1 offset:0
    s_waitcnt lgkmcnt(0)
    v_min_u32 v2, v2, v3
    s_nop 0
    v_readfirstlane_b32 s30, v2
    s_cmp_ge_u32 s30, 11
    s_nop 3
    s_cbranch_scc1 wl_87d
    s_sub_u32 s3, s3, 1
    s_cbranch_scc0 wl_87
wl_87d:
    ds_read_b128 v[80:83], v176 offset:32768
    ds_read_b64_tr_b16 v[144:145], v180 offset:0
    ds_read_b64_tr_b16 v[146:147], v180 offset:512
    ds_read_b128 v[84:87], v177 offset:32768
    ds_read_b64_tr_b16 v[148:149], v181 offset:0
    ds_read_b64_tr_b16 v[150:151], v181 offset:512
    ds_read_b128 v[88:91], v178 offset:32768
    ds_read_b64_tr_b16 v[152:153], v182 offset:0
    ds_read_b64_tr_b16 v[154:155], v182 offset:512
    ds_read_b128 v[92:95], v179 offset:32768
    ds_read_b64_tr_b16 v[156:157], v183 offset:0
    ds_read_b64_tr_b16 v[158:159], v183 offset:512
    ds_read_b128 v[96:99], v176 offset:40960
    ds_read_b64_tr_b16 v[160:161], v180 offset:8192
    ds_read_b64_tr_b16 v[162:163], v180 offset:8704
    ds_read_b128 v[100:103], v177 offset:40960
    ds_read_b64_tr_b16 v[164:165], v181 offset:8192
    ds_read_b64_tr_b16 v[166:167], v181 offset:8704
    ds_read_b64 v[2:3], v1 offset:0
    ds_read_b128 v[104:107], v178 offset:40960
    ds_read_b64_tr_b16 v[168:169], v182 offset:8192
    ds_read_b64_tr_b16 v[170:171], v182 offset:8704
    ds_read_b128 v[108:111], v179 offset:40960
    ds_read_b64_tr_b16 v[172:173], v183 offset:8192
    ds_read_b64_tr_b16 v[174:175], v183 offset:8704
    s_waitcnt lgkmcnt(0)
    s_branch mrg_53
slw_54:
    s_nop 7
    s_nop 3
    s_waitcnt lgkmcnt(0)
    v_mfma_f32_32x32x16_bf16 v[16:31], v[144:147], v[80:83], v[16:31]
    v_readfirstlane_b32 s29, v13
    s_cmp_lg_u32 s29, 0
    s_cbranch_scc1 ep_88
    s_mov_b32 s3, 0x10000
    s_nop 7
wl_89:
    ds_read_b32 v13, v1 offset:32
    s_waitcnt lgkmcnt(0)
    v_readfirstlane_b32 s29, v13
    s_cmp_ge_u32 s29, 1
    s_nop 3
    s_cbranch_scc1 wl_89d
    s_sub_u32 s3, s3, 1
    s_cbranch_scc0 wl_89
wl_89d:
ep_88:
    v_mfma_f32_16x16x32_bf16 v[64:67], v[144:147], v[68:71], v[64:67]
    v_mfma_f32_32x32x16_bf16 v[16:31], v[148:151], v[84:87], v[16:31]
    v_mov_b32 v6, 11
    ds_write_b32 v4, v6 offset:16
    v_mfma_f32_16x16x32_bf16 v[64:67], v[148:151], v[68:71], v[64:67]
    v_mfma_f32_32x32x16_bf16 v[16:31], v[152:155], v[88:91], v[16:31]
    v_mfma_f32_32x32x16_bf16 v[16:31], v[156:159], v[92:95], v[16:31]
    v_mfma_f32_32x32x16_bf16 v[16:31], v[160:163], v[96:99], v[16:31]
    v_mfma_f32_16x16x32_bf16 v[64:67], v[160:163], v[68:71], v[64:67]
    v_mfma_f32_32x32x16_bf16 v[16:31], v[164:167], v[100:103], v[16:31]
    v_mfma_f32_16x16x32_bf16 v[64:67], v[164:167], v[68:71], v[64:67]
    v_mfma_f32_32x32x16_bf16 v[16:31], v[168:171], v[104:107], v[16:31]
    v_mfma_f32_32x32x16_bf16 v[16:31], v[172:175], v[108:111], v[16:31]
    s_nop 5
    ds_write_b128 v189, v[64:67] offset:12288
    s_mov_b32 s3, 0x10000
    s_nop 3
wl_90:
    ds_read_b64 v[2:3], v1 offset:0
    s_waitcnt lgkmcnt(0)
    v_min_u32 v2, v2, v3
    s_nop 0
    v_readfirstlane_b32 s30, v2
    s_cmp_ge_u32 s30, 12
    s_nop 3
    s_cbranch_scc1 wl_90d
    s_sub_u32 s3, s3, 1
    s_cbranch_scc0 wl_90
wl_90d:
    ds_read_b128 v[32:35], v176 offset:49152
    ds_read_b64_tr_b16 v[112:113], v180 offset:16384
    ds_read_b64_tr_b16 v[114:115], v180 offset:16896
    ds_read_b128 v[36:39], v177 offset:49152
    ds_read_b64_tr_b16 v[116:117], v181 offset:16384
    ds_read_b64_tr_b16 v[118:119], v181 offset:16896
    ds_read_b128 v[40:43], v178 offset:49152
    ds_read_b64_tr_b16 v[120:121], v182 offset:16384
    ds_read_b64_tr_b16 v[122:123], v182 offset:16896
    ds_read_b128 v[44:47], v179 offset:49152
    ds_read_b64_tr_b16 v[124:125], v183 offset:16384
    ds_read_b64_tr_b16 v[126:127], v183 offset:16896
    ds_read_b128 v[48:51], v176 offset:57344
    ds_read_b64_tr_b16 v[128:129], v180 offset:24576
    ds_read_b64_tr_b16 v[130:131], v180 offset:25088
    ds_read_b128 v[52:55], v177 offset:57344
    ds_read_b64_tr_b16 v[132:133], v181 offset:24576
    ds_read_b64_tr_b16 v[134:135], v181 offset:25088
    ds_read_b128 v[56:59], v178 offset:57344
    ds_read_b64_tr_b16 v[136:137], v182 offset:24576
    ds_read_b64_tr_b16 v[138:139], v182 offset:25088
    ds_read_b128 v[60:63], v179 offset:57344
    ds_read_b64_tr_b16 v[140:141], v183 offset:24576
    ds_read_b64_tr_b16 v[142:143], v183 offset:25088
    s_waitcnt lgkmcnt(0)
    s_branch mrg_55
recurrent_scan__sliding_block__moe_arch_mod__prompt_kernel_kvbad:
    s_mov_b32 s30, 0x400
recurrent_scan__sliding_block__moe_arch_mod__prompt_kernel_kvb1:
    s_sleep 4
    v_mov_b32 v5, 0
    v_mov_b32 v6, 0
    buffer_load_dwordx4 v[16:19], v168, s[40:43], s32 offen offset:0 sc1
    s_mov_b64 exec, s[10:11]
    buffer_load_dwordx4 v[176:179], v169, s[40:43], s32 offen offset:0 sc1
    buffer_load_dwordx4 v[180:183], v169, s[40:43], s32 offen offset:512 sc1
    s_mov_b64 exec, -1
    buffer_load_dwordx4 v[20:23], v168, s[40:43], s32 offen offset:1024 sc1
    s_mov_b64 exec, s[10:11]
    buffer_load_dwordx4 v[184:187], v169, s[40:43], s32 offen offset:1024 sc1
    buffer_load_dwordx4 v[188:191], v169, s[40:43], s32 offen offset:1536 sc1
    s_mov_b64 exec, -1
    buffer_load_dwordx4 v[24:27], v168, s[40:43], s33 offen offset:0 sc1
    s_mov_b64 exec, s[10:11]
    buffer_load_dwordx4 v[192:195], v169, s[40:43], s33 offen offset:0 sc1
    buffer_load_dwordx4 v[196:199], v169, s[40:43], s33 offen offset:512 sc1
    s_mov_b64 exec, -1
    buffer_load_dwordx4 v[28:31], v168, s[40:43], s33 offen offset:1024 sc1
    s_mov_b64 exec, s[10:11]
    buffer_load_dwordx4 v[200:203], v169, s[40:43], s33 offen offset:1024 sc1
    buffer_load_dwordx4 v[204:207], v169, s[40:43], s33 offen offset:1536 sc1
    s_mov_b64 exec, -1
    buffer_load_dwordx4 v[32:35], v168, s[40:43], s34 offen offset:0 sc1
    s_mov_b64 exec, s[10:11]
    buffer_load_dwordx4 v[208:211], v169, s[40:43], s34 offen offset:0 sc1
    buffer_load_dwordx4 v[212:215], v169, s[40:43], s34 offen offset:512 sc1
    s_mov_b64 exec, -1
    buffer_load_dwordx4 v[36:39], v168, s[40:43], s34 offen offset:1024 sc1
    s_mov_b64 exec, s[10:11]
    buffer_load_dwordx4 v[216:219], v169, s[40:43], s34 offen offset:1024 sc1
    buffer_load_dwordx4 v[220:223], v169, s[40:43], s34 offen offset:1536 sc1
    s_mov_b64 exec, -1
    buffer_load_dwordx4 v[40:43], v168, s[40:43], s35 offen offset:0 sc1
    s_mov_b64 exec, s[10:11]
    buffer_load_dwordx4 v[224:227], v169, s[40:43], s35 offen offset:0 sc1
    buffer_load_dwordx4 v[228:231], v169, s[40:43], s35 offen offset:512 sc1
    s_mov_b64 exec, -1
    buffer_load_dwordx4 v[44:47], v168, s[40:43], s35 offen offset:1024 sc1
    s_mov_b64 exec, s[10:11]
    buffer_load_dwordx4 v[232:235], v169, s[40:43], s35 offen offset:1024 sc1
    buffer_load_dwordx4 v[236:239], v169, s[40:43], s35 offen offset:1536 sc1
    s_mov_b64 exec, -1
    s_waitcnt vmcnt(0)
    v_add3_u32 v5, v5, v16, v17
    v_add3_u32 v5, v5, v18, v19
    v_add3_u32 v6, v6, v176, v177
    v_add3_u32 v6, v6, v178, v179
    v_add3_u32 v6, v6, v180, v181
    v_add3_u32 v6, v6, v182, v183
    v_add3_u32 v5, v5, v20, v21
    v_add3_u32 v5, v5, v22, v23
    v_add3_u32 v6, v6, v184, v185
    v_add3_u32 v6, v6, v186, v187
    v_add3_u32 v6, v6, v188, v189
    v_add3_u32 v6, v6, v190, v191
    v_add3_u32 v5, v5, v24, v25
    v_add3_u32 v5, v5, v26, v27
    v_add3_u32 v6, v6, v192, v193
    v_add3_u32 v6, v6, v194, v195
    v_add3_u32 v6, v6, v196, v197
    v_add3_u32 v6, v6, v198, v199
    v_add3_u32 v5, v5, v28, v29
    v_add3_u32 v5, v5, v30, v31
    v_add3_u32 v6, v6, v200, v201
    v_add3_u32 v6, v6, v202, v203
    v_add3_u32 v6, v6, v204, v205
    v_add3_u32 v6, v6, v206, v207
    v_add3_u32 v5, v5, v32, v33
    v_add3_u32 v5, v5, v34, v35
    v_add3_u32 v6, v6, v208, v209
    v_add3_u32 v6, v6, v210, v211
    v_add3_u32 v6, v6, v212, v213
    v_add3_u32 v6, v6, v214, v215
    v_add3_u32 v5, v5, v36, v37
    v_add3_u32 v5, v5, v38, v39
    v_add3_u32 v6, v6, v216, v217
    v_add3_u32 v6, v6, v218, v219
    v_add3_u32 v6, v6, v220, v221
    v_add3_u32 v6, v6, v222, v223
    v_add3_u32 v5, v5, v40, v41
    v_add3_u32 v5, v5, v42, v43
    v_add3_u32 v6, v6, v224, v225
    v_add3_u32 v6, v6, v226, v227
    v_add3_u32 v6, v6, v228, v229
    v_add3_u32 v6, v6, v230, v231
    v_add3_u32 v5, v5, v44, v45
    v_add3_u32 v5, v5, v46, v47
    v_add3_u32 v6, v6, v232, v233
    v_add3_u32 v6, v6, v234, v235
    v_add3_u32 v6, v6, v236, v237
    v_add3_u32 v6, v6, v238, v239
    v_cndmask_b32_e64 v6, 0, v6, s[10:11]
    v_add_u32 v5, v5, v6
    v_mov_b32 v6, v5
    s_nop 1
    v_permlane32_swap_b32 v5, v6
    v_add_u32 v5, v5, v6
    v_mov_b32 v6, v5
    s_nop 1
    v_permlane16_swap_b32 v5, v6
    v_add_u32 v5, v5, v6
    s_nop 1
    v_add_u32_dpp v5, v5, v5 quad_perm:[1,0,3,2] row_mask:0xf bank_mask:0xf
    s_nop 1
    v_add_u32_dpp v5, v5, v5 quad_perm:[2,3,0,1] row_mask:0xf bank_mask:0xf
    s_nop 1
    v_add_u32_dpp v5, v5, v5 row_half_mirror row_mask:0xf bank_mask:0xf
    s_nop 1
    v_add_u32_dpp v5, v5, v5 row_mirror row_mask:0xf bank_mask:0xf
    s_nop 0
    v_readfirstlane_b32 s3, v5
    s_cmp_lg_u32 s3, s36
    s_nop 3
    s_cbranch_scc0 recurrent_scan__sliding_block__moe_arch_mod__prompt_kernel_slow0_c0
    s_sub_u32 s30, s30, 1
    s_cbranch_scc0 recurrent_scan__sliding_block__moe_arch_mod__prompt_kernel_kvb1
recurrent_scan__sliding_block__moe_arch_mod__prompt_kernel_slow0_c0:
    v_mov_b32 v171, 0
    s_mov_b32 s31, 0
    s_nop 0
recurrent_scan__sliding_block__moe_arch_mod__prompt_kernel_slow0:
    v_mov_b32 v56, v171
    v_mov_b32 v57, v171
    v_mov_b32 v58, v171
    v_mov_b32 v59, v171
    v_mov_b32 v60, v171
    v_mov_b32 v61, v171
    v_mov_b32 v62, v171
    v_mov_b32 v63, v171
    v_mov_b32 v64, v171
    v_mov_b32 v65, v171
    v_mov_b32 v66, v171
    v_mov_b32 v67, v171
    v_mov_b32 v68, v171
    v_mov_b32 v69, v171
    v_mov_b32 v70, v171
    v_mov_b32 v71, v171
    s_nop 1
    v_mfma_f32_32x32x16_bf16 v[104:119], v[48:51], v[8:11], v[56:71]
    s_cmp_lt_u32 s27, 4
    s_nop 7
    s_nop 2
    s_cbranch_scc1 fi_91
    v_mfma_f32_32x32x16_bf16 v[120:135], v[16:19], v[8:11], v[56:71]
    s_nop 7
    s_nop 3
    s_branch fd_92
fi_91:
    v_mov_b32 v120, 0xf149f2ca
    v_mov_b32 v121, 0xf149f2ca
    v_mov_b32 v122, 0xf149f2ca
    v_mov_b32 v123, 0xf149f2ca
    v_mov_b32 v124, 0xf149f2ca
    v_mov_b32 v125, 0xf149f2ca
    v_mov_b32 v126, 0xf149f2ca
    v_mov_b32 v127, 0xf149f2ca
    v_mov_b32 v128, 0xf149f2ca
    v_mov_b32 v129, 0xf149f2ca
    v_mov_b32 v130, 0xf149f2ca
    v_mov_b32 v131, 0xf149f2ca
    v_mov_b32 v132, 0xf149f2ca
    v_mov_b32 v133, 0xf149f2ca
    v_mov_b32 v134, 0xf149f2ca
    v_mov_b32 v135, 0xf149f2ca
    s_nop 1
fd_92:
    s_cmp_lg_u32 s27, 0
    s_cbranch_scc1 sw_93
    v_mov_b32 v56, 0xf149f2ca
    v_mov_b32 v57, 0xf149f2ca
    v_mov_b32 v58, 0xf149f2ca
    v_mov_b32 v59, 0xf149f2ca
    v_mov_b32 v60, 0xf149f2ca
    v_mov_b32 v61, 0xf149f2ca
    v_mov_b32 v62, 0xf149f2ca
    v_mov_b32 v63, 0xf149f2ca
    v_mov_b32 v64, 0xf149f2ca
    v_mov_b32 v65, 0xf149f2ca
    v_mov_b32 v66, 0xf149f2ca
    v_mov_b32 v67, 0xf149f2ca
    v_mov_b32 v68, 0xf149f2ca
    v_mov_b32 v69, 0xf149f2ca
    v_mov_b32 v70, 0xf149f2ca
    v_mov_b32 v71, 0xf149f2ca
    s_nop 1
sw_93:
    v_mfma_f32_32x32x16_bf16 v[136:151], v[44:47], v[8:11], v[56:71]
    v_cndmask_b32_e64 v104, v120, v104, s[44:45]
    v_cndmask_b32_e64 v105, v121, v105, s[46:47]
    v_cndmask_b32_e64 v106, v122, v106, s[48:49]
    v_cndmask_b32_e64 v107, v123, v107, s[50:51]
    v_cndmask_b32_e64 v108, v124, v108, s[52:53]
    v_cndmask_b32_e64 v109, v125, v109, s[54:55]
    v_cndmask_b32_e64 v110, v126, v110, s[56:57]
    v_cndmask_b32_e64 v111, v127, v111, s[58:59]
    v_cndmask_b32_e64 v112, v128, v112, s[60:61]
    v_cndmask_b32_e64 v113, v129, v113, s[62:63]
    v_cndmask_b32_e64 v114, v130, v114, s[64:65]
    v_cndmask_b32_e64 v115, v131, v115, s[66:67]
    v_cndmask_b32_e64 v116, v132, v116, s[68:69]
    v_cndmask_b32_e64 v117, v133, v117, s[70:71]
    v_cndmask_b32_e64 v118, v134, v118, s[72:73]
    v_cndmask_b32_e64 v119, v135, v119, s[74:75]
    v_exp_f32 v104, v104
    v_exp_f32 v105, v105
    v_exp_f32 v106, v106
    v_exp_f32 v107, v107
    v_exp_f32 v108, v108
    v_exp_f32 v109, v109
    v_exp_f32 v110, v110
    v_exp_f32 v111, v111
    v_mfma_f32_32x32x16_bf16 v[120:135], v[40:43], v[8:11], v[56:71]
    v_exp_f32 v112, v112
    v_exp_f32 v113, v113
    v_exp_f32 v114, v114
    v_exp_f32 v115, v115
    v_exp_f32 v116, v116
    v_exp_f32 v117, v117
    v_exp_f32 v118, v118
    v_exp_f32 v119, v119
    v_cvt_pk_bf16_f32 v104, v104, v105
    v_cvt_pk_bf16_f32 v105, v106, v107
    v_cvt_pk_bf16_f32 v106, v108, v109
    v_cvt_pk_bf16_f32 v107, v110, v111
    v_cvt_pk_bf16_f32 v108, v112, v113
    v_cvt_pk_bf16_f32 v109, v114, v115
    v_cvt_pk_bf16_f32 v110, v116, v117
    v_cvt_pk_bf16_f32 v111, v118, v119
    v_and_b32 v112, v104, v152
    v_and_b32 v113, v105, v153
    v_and_b32 v114, v106, v154
    v_and_b32 v115, v107, v155
    v_and_b32 v116, v108, v156
    v_and_b32 v117, v109, v157
    v_and_b32 v118, v110, v158
    v_and_b32 v119, v111, v159
    v_xor_b32 v104, v104, v112
    v_xor_b32 v105, v105, v113
    v_xor_b32 v106, v106, v114
    v_xor_b32 v107, v107, v115
    v_xor_b32 v108, v108, v116
    v_xor_b32 v109, v109, v117
    v_xor_b32 v110, v110, v118
    v_xor_b32 v111, v111, v119
    v_exp_f32 v136, v136
    v_exp_f32 v137, v137
    v_mfma_f32_32x32x16_bf16 v[72:87], v[240:243], v[112:115], 0
    v_exp_f32 v138, v138
    v_exp_f32 v139, v139
    v_mfma_f32_32x32x16_bf16 v[72:87], v[244:247], v[116:119], v[72:87]
    v_exp_f32 v140, v140
    v_exp_f32 v141, v141
    v_mfma_f32_32x32x16_bf16 v[72:87], v[176:179], v[104:107], v[72:87]
    v_exp_f32 v142, v142
    v_exp_f32 v143, v143
    v_mfma_f32_32x32x16_bf16 v[72:87], v[180:183], v[108:111], v[72:87]
    v_exp_f32 v144, v144
    v_exp_f32 v145, v145
    s_cmp_lg_u32 s27, 1
    s_nop 7
    s_nop 0
    s_cbranch_scc1 sw_94
    v_mov_b32 v56, 0xf149f2ca
    v_mov_b32 v57, 0xf149f2ca
    v_mov_b32 v58, 0xf149f2ca
    v_mov_b32 v59, 0xf149f2ca
    v_mov_b32 v60, 0xf149f2ca
    v_mov_b32 v61, 0xf149f2ca
    v_mov_b32 v62, 0xf149f2ca
    v_mov_b32 v63, 0xf149f2ca
    v_mov_b32 v64, 0xf149f2ca
    v_mov_b32 v65, 0xf149f2ca
    v_mov_b32 v66, 0xf149f2ca
    v_mov_b32 v67, 0xf149f2ca
    v_mov_b32 v68, 0xf149f2ca
    v_mov_b32 v69, 0xf149f2ca
    v_mov_b32 v70, 0xf149f2ca
    v_mov_b32 v71, 0xf149f2ca
    s_nop 1
sw_94:
    v_mfma_f32_32x32x16_bf16 v[104:119], v[36:39], v[8:11], v[56:71]
    v_exp_f32 v146, v146
    v_exp_f32 v147, v147
    v_exp_f32 v148, v148
    v_exp_f32 v149, v149
    v_exp_f32 v150, v150
    v_exp_f32 v151, v151
    v_cvt_pk_bf16_f32 v136, v136, v137
    v_cvt_pk_bf16_f32 v137, v138, v139
    v_cvt_pk_bf16_f32 v138, v140, v141
    v_cvt_pk_bf16_f32 v139, v142, v143
    v_cvt_pk_bf16_f32 v140, v144, v145
    v_cvt_pk_bf16_f32 v141, v146, v147
    v_cvt_pk_bf16_f32 v142, v148, v149
    v_cvt_pk_bf16_f32 v143, v150, v151
    v_exp_f32 v120, v120
    v_exp_f32 v121, v121
    v_exp_f32 v122, v122
    v_exp_f32 v123, v123
    v_mfma_f32_32x32x16_bf16 v[72:87], v[232:235], v[136:139], v[72:87]
    v_exp_f32 v124, v124
    v_exp_f32 v125, v125
    v_exp_f32 v126, v126
    v_exp_f32 v127, v127
    v_mfma_f32_32x32x16_bf16 v[72:87], v[236:239], v[140:143], v[72:87]
    v_exp_f32 v128, v128
    v_exp_f32 v129, v129
    v_exp_f32 v130, v130
    v_exp_f32 v131, v131
    v_mfma_f32_32x32x16_bf16 v[136:151], v[32:35], v[8:11], v[56:71]
    v_exp_f32 v132, v132
    v_exp_f32 v133, v133
    v_exp_f32 v134, v134
    v_exp_f32 v135, v135
    v_cvt_pk_bf16_f32 v120, v120, v121
    v_cvt_pk_bf16_f32 v121, v122, v123
    v_cvt_pk_bf16_f32 v122, v124, v125
    v_cvt_pk_bf16_f32 v123, v126, v127
    v_cvt_pk_bf16_f32 v124, v128, v129
    v_cvt_pk_bf16_f32 v125, v130, v131
    v_cvt_pk_bf16_f32 v126, v132, v133
    v_cvt_pk_bf16_f32 v127, v134, v135
    v_exp_f32 v104, v104
    v_exp_f32 v105, v105
    v_exp_f32 v106, v106
    v_exp_f32 v107, v107
    v_mfma_f32_32x32x16_bf16 v[72:87], v[224:227], v[120:123], v[72:87]
    v_exp_f32 v108, v108
    v_exp_f32 v109, v109
    v_exp_f32 v110, v110
    v_exp_f32 v111, v111
    v_mfma_f32_32x32x16_bf16 v[72:87], v[228:231], v[124:127], v[72:87]
    v_exp_f32 v112, v112
    v_exp_f32 v113, v113
    v_exp_f32 v114, v114
    v_exp_f32 v115, v115
    s_cmp_lg_u32 s27, 2
    s_nop 6
    s_cbranch_scc1 sw_95
    v_mov_b32 v56, 0xf149f2ca
    v_mov_b32 v57, 0xf149f2ca
    v_mov_b32 v58, 0xf149f2ca
    v_mov_b32 v59, 0xf149f2ca
    v_mov_b32 v60, 0xf149f2ca
    v_mov_b32 v61, 0xf149f2ca
    v_mov_b32 v62, 0xf149f2ca
    v_mov_b32 v63, 0xf149f2ca
    v_mov_b32 v64, 0xf149f2ca
    v_mov_b32 v65, 0xf149f2ca
    v_mov_b32 v66, 0xf149f2ca
    v_mov_b32 v67, 0xf149f2ca
    v_mov_b32 v68, 0xf149f2ca
    v_mov_b32 v69, 0xf149f2ca
    v_mov_b32 v70, 0xf149f2ca
    v_mov_b32 v71, 0xf149f2ca
    s_nop 1
sw_95:
    v_mfma_f32_32x32x16_bf16 v[120:135], v[28:31], v[8:11], v[56:71]
    v_exp_f32 v116, v116
    v_exp_f32 v117, v117
    v_exp_f32 v118, v118
    v_exp_f32 v119, v119
    v_cvt_pk_bf16_f32 v104, v104, v105
    v_cvt_pk_bf16_f32 v105, v106, v107
    v_cvt_pk_bf16_f32 v106, v108, v109
    v_cvt_pk_bf16_f32 v107, v110, v111
    v_cvt_pk_bf16_f32 v108, v112, v113
    v_cvt_pk_bf16_f32 v109, v114, v115
    v_cvt_pk_bf16_f32 v110, v116, v117
    v_cvt_pk_bf16_f32 v111, v118, v119
    v_exp_f32 v136, v136
    v_exp_f32 v137, v137
    v_exp_f32 v138, v138
    v_exp_f32 v139, v139
    v_mfma_f32_32x32x16_bf16 v[72:87], v[216:219], v[104:107], v[72:87]
    v_exp_f32 v140, v140
    v_exp_f32 v141, v141
    v_exp_f32 v142, v142
    v_exp_f32 v143, v143
    v_mfma_f32_32x32x16_bf16 v[72:87], v[220:223], v[108:111], v[72:87]
    v_exp_f32 v144, v144
    v_exp_f32 v145, v145
    v_exp_f32 v146, v146
    v_exp_f32 v147, v147
    v_mfma_f32_32x32x16_bf16 v[104:119], v[24:27], v[8:11], v[56:71]
    v_exp_f32 v148, v148
    v_exp_f32 v149, v149
    v_exp_f32 v150, v150
    v_exp_f32 v151, v151
    v_cvt_pk_bf16_f32 v136, v136, v137
    v_cvt_pk_bf16_f32 v137, v138, v139
    v_cvt_pk_bf16_f32 v138, v140, v141
    v_cvt_pk_bf16_f32 v139, v142, v143
    v_cvt_pk_bf16_f32 v140, v144, v145
    v_cvt_pk_bf16_f32 v141, v146, v147
    v_cvt_pk_bf16_f32 v142, v148, v149
    v_cvt_pk_bf16_f32 v143, v150, v151
    v_exp_f32 v120, v120
    v_exp_f32 v121, v121
    v_exp_f32 v122, v122
    v_exp_f32 v123, v123
    v_mfma_f32_32x32x16_bf16 v[72:87], v[208:211], v[136:139], v[72:87]
    v_exp_f32 v124, v124
    v_exp_f32 v125, v125
    v_exp_f32 v126, v126
    v_exp_f32 v127, v127
    v_mfma_f32_32x32x16_bf16 v[72:87], v[212:215], v[140:143], v[72:87]
    v_exp_f32 v128, v128
    v_exp_f32 v129, v129
    v_exp_f32 v130, v130
    v_exp_f32 v131, v131
    s_cmp_lg_u32 s27, 3
    s_nop 6
    s_cbranch_scc1 sw_96
    v_mov_b32 v56, 0xf149f2ca
    v_mov_b32 v57, 0xf149f2ca
    v_mov_b32 v58, 0xf149f2ca
    v_mov_b32 v59, 0xf149f2ca
    v_mov_b32 v60, 0xf149f2ca
    v_mov_b32 v61, 0xf149f2ca
    v_mov_b32 v62, 0xf149f2ca
    v_mov_b32 v63, 0xf149f2ca
    v_mov_b32 v64, 0xf149f2ca
    v_mov_b32 v65, 0xf149f2ca
    v_mov_b32 v66, 0xf149f2ca
    v_mov_b32 v67, 0xf149f2ca
    v_mov_b32 v68, 0xf149f2ca
    v_mov_b32 v69, 0xf149f2ca
    v_mov_b32 v70, 0xf149f2ca
    v_mov_b32 v71, 0xf149f2ca
    s_nop 1
sw_96:
    v_mfma_f32_32x32x16_bf16 v[136:151], v[20:23], v[8:11], v[56:71]
    v_exp_f32 v132, v132
    v_exp_f32 v133, v133
    v_exp_f32 v134, v134
    v_exp_f32 v135, v135
    v_cvt_pk_bf16_f32 v120, v120, v121
    v_cvt_pk_bf16_f32 v121, v122, v123
    v_cvt_pk_bf16_f32 v122, v124, v125
    v_cvt_pk_bf16_f32 v123, v126, v127
    v_cvt_pk_bf16_f32 v124, v128, v129
    v_cvt_pk_bf16_f32 v125, v130, v131
    v_cvt_pk_bf16_f32 v126, v132, v133
    v_cvt_pk_bf16_f32 v127, v134, v135
    v_exp_f32 v104, v104
    v_exp_f32 v105, v105
    v_exp_f32 v106, v106
    v_exp_f32 v107, v107
    v_exp_f32 v108, v108
    v_mfma_f32_32x32x16_bf16 v[72:87], v[200:203], v[120:123], v[72:87]
    v_exp_f32 v109, v109
    v_exp_f32 v110, v110
    v_exp_f32 v111, v111
    v_exp_f32 v112, v112
    v_exp_f32 v113, v113
    v_mfma_f32_32x32x16_bf16 v[72:87], v[204:207], v[124:127], v[72:87]
    v_exp_f32 v114, v114
    v_exp_f32 v115, v115
    v_exp_f32 v116, v116
    v_exp_f32 v117, v117
    v_exp_f32 v118, v118
    v_exp_f32 v119, v119
    v_cvt_pk_bf16_f32 v104, v104, v105
    v_cvt_pk_bf16_f32 v105, v106, v107
    v_cvt_pk_bf16_f32 v106, v108, v109
    v_cvt_pk_bf16_f32 v107, v110, v111
    v_cvt_pk_bf16_f32 v108, v112, v113
    v_cvt_pk_bf16_f32 v109, v114, v115
    v_cvt_pk_bf16_f32 v110, v116, v117
    v_cvt_pk_bf16_f32 v111, v118, v119
    v_exp_f32 v136, v136
    v_exp_f32 v137, v137
    v_exp_f32 v138, v138
    v_exp_f32 v139, v139
    v_exp_f32 v140, v140
    v_mfma_f32_32x32x16_bf16 v[72:87], v[192:195], v[104:107], v[72:87]
    v_exp_f32 v141, v141
    v_exp_f32 v142, v142
    v_exp_f32 v143, v143
    v_exp_f32 v144, v144
    v_exp_f32 v145, v145
    v_mfma_f32_32x32x16_bf16 v[72:87], v[196:199], v[108:111], v[72:87]
    v_exp_f32 v146, v146
    v_exp_f32 v147, v147
    v_exp_f32 v148, v148
    v_exp_f32 v149, v149
    v_exp_f32 v150, v150
    v_exp_f32 v151, v151
    v_cvt_pk_bf16_f32 v136, v136, v137
    v_cvt_pk_bf16_f32 v137, v138, v139
    v_cvt_pk_bf16_f32 v138, v140, v141
    v_cvt_pk_bf16_f32 v139, v142, v143
    v_cvt_pk_bf16_f32 v140, v144, v145
    v_cvt_pk_bf16_f32 v141, v146, v147
    v_cvt_pk_bf16_f32 v142, v148, v149
    v_cvt_pk_bf16_f32 v143, v150, v151
    v_mfma_f32_32x32x16_bf16 v[72:87], v[184:187], v[136:139], v[72:87]
    s_nop 0
    v_mfma_f32_32x32x16_bf16 v[72:87], v[188:191], v[140:143], v[72:87]
    s_cmp_lg_u32 s31, 0
    s_nop 7
    s_nop 2
    s_cbranch_scc1 sf_97
    v_mov_b32 v160, 0x2b800000
    v_mov_b32 v161, 0x53800000
    v_med3_f32 v160, v80, v160, v161
    v_cmp_neq_f32 vcc, v160, v80
    s_nop 4
    s_cbranch_vccnz recurrent_scan__sliding_block__moe_arch_mod__prompt_kernel_max0
sf_97:
    v_mov_b32 v160, 0x2b800000
    v_mov_b32 v161, 0x53800000
    v_med3_f32 v160, v80, v160, v161
    v_cmp_neq_f32 vcc, v160, v80
    v_rcp_f32 v160, v80
    s_nop 0
    v_mul_f32 v72, v72, v160
    v_mul_f32 v73, v73, v160
    v_mul_f32 v74, v74, v160
    v_mul_f32 v75, v75, v160
    v_mul_f32 v76, v76, v160
    v_mul_f32 v77, v77, v160
    v_mul_f32 v78, v78, v160
    v_mul_f32 v79, v79, v160
    v_cvt_pk_bf16_f32 v164, v72, v73
    v_cvt_pk_bf16_f32 v165, v74, v75
    v_cvt_pk_bf16_f32 v166, v76, v77
    v_cvt_pk_bf16_f32 v167, v78, v79
    buffer_store_dwordx4 v[164:167], v168, s[40:43], s37 offen sc1
    v_add3_u32 v163, v164, v165, v166
    v_add_u32 v163, v163, v167
    v_mov_b32 v162, v163
    s_nop 1
    v_permlane32_swap_b32 v163, v162
    v_add_u32 v163, v163, v162
    v_mov_b32 v162, v163
    s_nop 1
    v_permlane16_swap_b32 v163, v162
    v_add_u32 v163, v163, v162
    s_nop 1
    v_add_u32_dpp v163, v163, v163 quad_perm:[1,0,3,2] row_mask:0xf bank_mask:0xf
    s_nop 1
    v_add_u32_dpp v163, v163, v163 quad_perm:[2,3,0,1] row_mask:0xf bank_mask:0xf
    s_nop 1
    v_add_u32_dpp v163, v163, v163 row_half_mirror row_mask:0xf bank_mask:0xf
    s_nop 1
    v_add_u32_dpp v163, v163, v163 row_mirror row_mask:0xf bank_mask:0xf
    v_mov_b32 v162, 1
    s_mov_b64 exec, 1
    ds_add_rtn_u64 v[160:161], v1, v[162:163] offset:176
    s_mov_b64 exec, -1
    s_waitcnt lgkmcnt(0)
    v_readfirstlane_b32 s3, v160
    s_cmp_lg_u32 s3, 3
    s_nop 3
    s_cbranch_scc1 of_99
    v_readfirstlane_b32 s3, v161
    s_mov_b64 exec, 0xff
    s_nop 0
    v_add_u32 v162, s3, v163
    v_mov_b32 v163, s29
    buffer_store_dwordx2 v[162:163], v170, s[40:43], 0 offen offset:0 sc1
    s_mov_b64 exec, -1
of_99:
recurrent_scan__sliding_block__moe_arch_mod__prompt_kernel_slow1_c0:
    v_mov_b32 v171, 0
    s_mov_b32 s31, 0
    s_nop 0
recurrent_scan__sliding_block__moe_arch_mod__prompt_kernel_slow1:
    v_mov_b32 v56, v171
    v_mov_b32 v57, v171
    v_mov_b32 v58, v171
    v_mov_b32 v59, v171
    v_mov_b32 v60, v171
    v_mov_b32 v61, v171
    v_mov_b32 v62, v171
    v_mov_b32 v63, v171
    v_mov_b32 v64, v171
    v_mov_b32 v65, v171
    v_mov_b32 v66, v171
    v_mov_b32 v67, v171
    v_mov_b32 v68, v171
    v_mov_b32 v69, v171
    v_mov_b32 v70, v171
    v_mov_b32 v71, v171
    s_nop 1
    v_mfma_f32_32x32x16_bf16 v[104:119], v[52:55], v[12:15], v[56:71]
    s_cmp_lt_u32 s27, 4
    s_nop 7
    s_nop 2
    s_cbranch_scc1 fi_100
    v_mfma_f32_32x32x16_bf16 v[120:135], v[20:23], v[12:15], v[56:71]
    s_nop 7
    s_nop 3
    s_branch fd_101
fi_100:
    v_mov_b32 v120, 0xf149f2ca
    v_mov_b32 v121, 0xf149f2ca
    v_mov_b32 v122, 0xf149f2ca
    v_mov_b32 v123, 0xf149f2ca
    v_mov_b32 v124, 0xf149f2ca
    v_mov_b32 v125, 0xf149f2ca
    v_mov_b32 v126, 0xf149f2ca
    v_mov_b32 v127, 0xf149f2ca
    v_mov_b32 v128, 0xf149f2ca
    v_mov_b32 v129, 0xf149f2ca
    v_mov_b32 v130, 0xf149f2ca
    v_mov_b32 v131, 0xf149f2ca
    v_mov_b32 v132, 0xf149f2ca
    v_mov_b32 v133, 0xf149f2ca
    v_mov_b32 v134, 0xf149f2ca
    v_mov_b32 v135, 0xf149f2ca
    s_nop 1
fd_101:
    v_mfma_f32_32x32x16_bf16 v[136:151], v[48:51], v[12:15], v[56:71]
    v_cndmask_b32_e64 v104, v120, v104, s[44:45]
    v_cndmask_b32_e64 v105, v121, v105, s[46:47]
    v_cndmask_b32_e64 v106, v122, v106, s[48:49]
    v_cndmask_b32_e64 v107, v123, v107, s[50:51]
    v_cndmask_b32_e64 v108, v124, v108, s[52:53]
    v_cndmask_b32_e64 v109, v125, v109, s[54:55]
    v_cndmask_b32_e64 v110, v126, v110, s[56:57]
    v_cndmask_b32_e64 v111, v127, v111, s[58:59]
    v_cndmask_b32_e64 v112, v128, v112, s[60:61]
    v_cndmask_b32_e64 v113, v129, v113, s[62:63]
    v_cndmask_b32_e64 v114, v130, v114, s[64:65]
    v_cndmask_b32_e64 v115, v131, v115, s[66:67]
    v_cndmask_b32_e64 v116, v132, v116, s[68:69]
    v_cndmask_b32_e64 v117, v133, v117, s[70:71]
    v_cndmask_b32_e64 v118, v134, v118, s[72:73]
    v_cndmask_b32_e64 v119, v135, v119, s[74:75]
    v_exp_f32 v104, v104
    v_exp_f32 v105, v105
    v_exp_f32 v106, v106
    v_exp_f32 v107, v107
    v_exp_f32 v108, v108
    v_exp_f32 v109, v109
    v_exp_f32 v110, v110
    v_exp_f32 v111, v111
    s_cmp_lg_u32 s27, 0
    s_nop 0
    s_cbranch_scc1 sw_102
    v_mov_b32 v56, 0xf149f2ca
    v_mov_b32 v57, 0xf149f2ca
    v_mov_b32 v58, 0xf149f2ca
    v_mov_b32 v59, 0xf149f2ca
    v_mov_b32 v60, 0xf149f2ca
    v_mov_b32 v61, 0xf149f2ca
    v_mov_b32 v62, 0xf149f2ca
    v_mov_b32 v63, 0xf149f2ca
    v_mov_b32 v64, 0xf149f2ca
    v_mov_b32 v65, 0xf149f2ca
    v_mov_b32 v66, 0xf149f2ca
    v_mov_b32 v67, 0xf149f2ca
    v_mov_b32 v68, 0xf149f2ca
    v_mov_b32 v69, 0xf149f2ca
    v_mov_b32 v70, 0xf149f2ca
    v_mov_b32 v71, 0xf149f2ca
    s_nop 1
sw_102:
    v_mfma_f32_32x32x16_bf16 v[120:135], v[44:47], v[12:15], v[56:71]
    v_exp_f32 v112, v112
    v_exp_f32 v113, v113
    v_exp_f32 v114, v114
    v_exp_f32 v115, v115
    v_exp_f32 v116, v116
    v_exp_f32 v117, v117
    v_exp_f32 v118, v118
    v_exp_f32 v119, v119
    v_cvt_pk_bf16_f32 v104, v104, v105
    v_cvt_pk_bf16_f32 v105, v106, v107
    v_cvt_pk_bf16_f32 v106, v108, v109
    v_cvt_pk_bf16_f32 v107, v110, v111
    v_cvt_pk_bf16_f32 v108, v112, v113
    v_cvt_pk_bf16_f32 v109, v114, v115
    v_cvt_pk_bf16_f32 v110, v116, v117
    v_cvt_pk_bf16_f32 v111, v118, v119
    v_and_b32 v112, v104, v152
    v_and_b32 v113, v105, v153
    v_and_b32 v114, v106, v154
    v_and_b32 v115, v107, v155
    v_and_b32 v116, v108, v156
    v_and_b32 v117, v109, v157
    v_and_b32 v118, v110, v158
    v_and_b32 v119, v111, v159
    v_xor_b32 v104, v104, v112
    v_xor_b32 v105, v105, v113
    v_xor_b32 v106, v106, v114
    v_xor_b32 v107, v107, v115
    v_xor_b32 v108, v108, v116
    v_xor_b32 v109, v109, v117
    v_xor_b32 v110, v110, v118
    v_xor_b32 v111, v111, v119
    v_exp_f32 v136, v136
    v_exp_f32 v137, v137
    v_mfma_f32_32x32x16_bf16 v[72:87], v[248:251], v[112:115], 0
    v_exp_f32 v138, v138
    v_exp_f32 v139, v139
    v_mfma_f32_32x32x16_bf16 v[72:87], v[252:255], v[116:119], v[72:87]
    v_exp_f32 v140, v140
    v_exp_f32 v141, v141
    v_mfma_f32_32x32x16_bf16 v[72:87], v[184:187], v[104:107], v[72:87]
    v_exp_f32 v142, v142
    v_exp_f32 v143, v143
    v_mfma_f32_32x32x16_bf16 v[72:87], v[188:191], v[108:111], v[72:87]
    v_exp_f32 v144, v144
    v_exp_f32 v145, v145
    v_mfma_f32_32x32x16_bf16 v[104:119], v[40:43], v[12:15], v[56:71]
    v_exp_f32 v146, v146
    v_exp_f32 v147, v147
    v_exp_f32 v148, v148
    v_exp_f32 v149, v149
    v_exp_f32 v150, v150
    v_exp_f32 v151, v151
    v_cvt_pk_bf16_f32 v136, v136, v137
    v_cvt_pk_bf16_f32 v137, v138, v139
    v_cvt_pk_bf16_f32 v138, v140, v141
    v_cvt_pk_bf16_f32 v139, v142, v143
    v_cvt_pk_bf16_f32 v140, v144, v145
    v_cvt_pk_bf16_f32 v141, v146, v147
    v_cvt_pk_bf16_f32 v142, v148, v149
    v_cvt_pk_bf16_f32 v143, v150, v151
    v_exp_f32 v120, v120
    v_exp_f32 v121, v121
    v_exp_f32 v122, v122
    v_exp_f32 v123, v123
    v_mfma_f32_32x32x16_bf16 v[72:87], v[240:243], v[136:139], v[72:87]
    v_exp_f32 v124, v124
    v_exp_f32 v125, v125
    v_exp_f32 v126, v126
    v_exp_f32 v127, v127
    v_mfma_f32_32x32x16_bf16 v[72:87], v[244:247], v[140:143], v[72:87]
    v_exp_f32 v128, v128
    v_exp_f32 v129, v129
    v_exp_f32 v130, v130
    v_exp_f32 v131, v131
    s_cmp_lg_u32 s27, 1
    s_nop 6
    s_cbranch_scc1 sw_103
    v_mov_b32 v56, 0xf149f2ca
    v_mov_b32 v57, 0xf149f2ca
    v_mov_b32 v58, 0xf149f2ca
    v_mov_b32 v59, 0xf149f2ca
    v_mov_b32 v60, 0xf149f2ca
    v_mov_b32 v61, 0xf149f2ca
    v_mov_b32 v62, 0xf149f2ca
    v_mov_b32 v63, 0xf149f2ca
    v_mov_b32 v64, 0xf149f2ca
    v_mov_b32 v65, 0xf149f2ca
    v_mov_b32 v66, 0xf149f2ca
    v_mov_b32 v67, 0xf149f2ca
    v_mov_b32 v68, 0xf149f2ca
    v_mov_b32 v69, 0xf149f2ca
    v_mov_b32 v70, 0xf149f2ca
    v_mov_b32 v71, 0xf149f2ca
    s_nop 1
sw_103:
    v_mfma_f32_32x32x16_bf16 v[136:151], v[36:39], v[12:15], v[56:71]
    v_exp_f32 v132, v132
    v_exp_f32 v133, v133
    v_exp_f32 v134, v134
    v_exp_f32 v135, v135
    v_cvt_pk_bf16_f32 v120, v120, v121
    v_cvt_pk_bf16_f32 v121, v122, v123
    v_cvt_pk_bf16_f32 v122, v124, v125
    v_cvt_pk_bf16_f32 v123, v126, v127
    v_cvt_pk_bf16_f32 v124, v128, v129
    v_cvt_pk_bf16_f32 v125, v130, v131
    v_cvt_pk_bf16_f32 v126, v132, v133
    v_cvt_pk_bf16_f32 v127, v134, v135
    v_exp_f32 v104, v104
    v_exp_f32 v105, v105
    v_exp_f32 v106, v106
    v_exp_f32 v107, v107
    v_mfma_f32_32x32x16_bf16 v[72:87], v[232:235], v[120:123], v[72:87]
    v_exp_f32 v108, v108
    v_exp_f32 v109, v109
    v_exp_f32 v110, v110
    v_exp_f32 v111, v111
    v_mfma_f32_32x32x16_bf16 v[72:87], v[236:239], v[124:127], v[72:87]
    v_exp_f32 v112, v112
    v_exp_f32 v113, v113
    v_exp_f32 v114, v114
    v_exp_f32 v115, v115
    v_mfma_f32_32x32x16_bf16 v[120:135], v[32:35], v[12:15], v[56:71]
    v_exp_f32 v116, v116
    v_exp_f32 v117, v117
    v_exp_f32 v118, v118
    v_exp_f32 v119, v119
    v_cvt_pk_bf16_f32 v104, v104, v105
    v_cvt_pk_bf16_f32 v105, v106, v107
    v_cvt_pk_bf16_f32 v106, v108, v109
    v_cvt_pk_bf16_f32 v107, v110, v111
    v_cvt_pk_bf16_f32 v108, v112, v113
    v_cvt_pk_bf16_f32 v109, v114, v115
    v_cvt_pk_bf16_f32 v110, v116, v117
    v_cvt_pk_bf16_f32 v111, v118, v119
    v_exp_f32 v136, v136
    v_exp_f32 v137, v137
    v_exp_f32 v138, v138
    v_exp_f32 v139, v139
    v_mfma_f32_32x32x16_bf16 v[72:87], v[224:227], v[104:107], v[72:87]
    v_exp_f32 v140, v140
    v_exp_f32 v141, v141
    v_exp_f32 v142, v142
    v_exp_f32 v143, v143
    v_mfma_f32_32x32x16_bf16 v[72:87], v[228:231], v[108:111], v[72:87]
    v_exp_f32 v144, v144
    v_exp_f32 v145, v145
    v_exp_f32 v146, v146
    v_exp_f32 v147, v147
    s_cmp_lg_u32 s27, 2
    s_nop 6
    s_cbranch_scc1 sw_104
    v_mov_b32 v56, 0xf149f2ca
    v_mov_b32 v57, 0xf149f2ca
    v_mov_b32 v58, 0xf149f2ca
    v_mov_b32 v59, 0xf149f2ca
    v_mov_b32 v60, 0xf149f2ca
    v_mov_b32 v61, 0xf149f2ca
    v_mov_b32 v62, 0xf149f2ca
    v_mov_b32 v63, 0xf149f2ca
    v_mov_b32 v64, 0xf149f2ca
    v_mov_b32 v65, 0xf149f2ca
    v_mov_b32 v66, 0xf149f2ca
    v_mov_b32 v67, 0xf149f2ca
    v_mov_b32 v68, 0xf149f2ca
    v_mov_b32 v69, 0xf149f2ca
    v_mov_b32 v70, 0xf149f2ca
    v_mov_b32 v71, 0xf149f2ca
    s_nop 1
sw_104:
    v_mfma_f32_32x32x16_bf16 v[104:119], v[28:31], v[12:15], v[56:71]
    v_exp_f32 v148, v148
    v_exp_f32 v149, v149
    v_exp_f32 v150, v150
    v_exp_f32 v151, v151
    v_cvt_pk_bf16_f32 v136, v136, v137
    v_cvt_pk_bf16_f32 v137, v138, v139
    v_cvt_pk_bf16_f32 v138, v140, v141
    v_cvt_pk_bf16_f32 v139, v142, v143
    v_cvt_pk_bf16_f32 v140, v144, v145
    v_cvt_pk_bf16_f32 v141, v146, v147
    v_cvt_pk_bf16_f32 v142, v148, v149
    v_cvt_pk_bf16_f32 v143, v150, v151
    v_exp_f32 v120, v120
    v_exp_f32 v121, v121
    v_exp_f32 v122, v122
    v_exp_f32 v123, v123
    v_mfma_f32_32x32x16_bf16 v[72:87], v[216:219], v[136:139], v[72:87]
    v_exp_f32 v124, v124
    v_exp_f32 v125, v125
    v_exp_f32 v126, v126
    v_exp_f32 v127, v127
    v_mfma_f32_32x32x16_bf16 v[72:87], v[220:223], v[140:143], v[72:87]
    v_exp_f32 v128, v128
    v_exp_f32 v129, v129
    v_exp_f32 v130, v130
    v_exp_f32 v131, v131
    v_mfma_f32_32x32x16_bf16 v[136:151], v[24:27], v[12:15], v[56:71]
    v_exp_f32 v132, v132
    v_exp_f32 v133, v133
    v_exp_f32 v134, v134
    v_exp_f32 v135, v135
    v_cvt_pk_bf16_f32 v120, v120, v121
    v_cvt_pk_bf16_f32 v121, v122, v123
    v_cvt_pk_bf16_f32 v122, v124, v125
    v_cvt_pk_bf16_f32 v123, v126, v127
    v_cvt_pk_bf16_f32 v124, v128, v129
    v_cvt_pk_bf16_f32 v125, v130, v131
    v_cvt_pk_bf16_f32 v126, v132, v133
    v_cvt_pk_bf16_f32 v127, v134, v135
    v_exp_f32 v104, v104
    v_exp_f32 v105, v105
    v_exp_f32 v106, v106
    v_exp_f32 v107, v107
    v_exp_f32 v108, v108
    v_mfma_f32_32x32x16_bf16 v[72:87], v[208:211], v[120:123], v[72:87]
    v_exp_f32 v109, v109
    v_exp_f32 v110, v110
    v_exp_f32 v111, v111
    v_exp_f32 v112, v112
    v_exp_f32 v113, v113
    v_mfma_f32_32x32x16_bf16 v[72:87], v[212:215], v[124:127], v[72:87]
    v_exp_f32 v114, v114
    v_exp_f32 v115, v115
    v_exp_f32 v116, v116
    v_exp_f32 v117, v117
    v_exp_f32 v118, v118
    v_exp_f32 v119, v119
    v_cvt_pk_bf16_f32 v104, v104, v105
    v_cvt_pk_bf16_f32 v105, v106, v107
    v_cvt_pk_bf16_f32 v106, v108, v109
    v_cvt_pk_bf16_f32 v107, v110, v111
    v_cvt_pk_bf16_f32 v108, v112, v113
    v_cvt_pk_bf16_f32 v109, v114, v115
    v_cvt_pk_bf16_f32 v110, v116, v117
    v_cvt_pk_bf16_f32 v111, v118, v119
    v_exp_f32 v136, v136
    v_exp_f32 v137, v137
    v_exp_f32 v138, v138
    v_exp_f32 v139, v139
    v_exp_f32 v140, v140
    v_mfma_f32_32x32x16_bf16 v[72:87], v[200:203], v[104:107], v[72:87]
    v_exp_f32 v141, v141
    v_exp_f32 v142, v142
    v_exp_f32 v143, v143
    v_exp_f32 v144, v144
    v_exp_f32 v145, v145
    v_mfma_f32_32x32x16_bf16 v[72:87], v[204:207], v[108:111], v[72:87]
    v_exp_f32 v146, v146
    v_exp_f32 v147, v147
    v_exp_f32 v148, v148
    v_exp_f32 v149, v149
    v_exp_f32 v150, v150
    v_exp_f32 v151, v151
    v_cvt_pk_bf16_f32 v136, v136, v137
    v_cvt_pk_bf16_f32 v137, v138, v139
    v_cvt_pk_bf16_f32 v138, v140, v141
    v_cvt_pk_bf16_f32 v139, v142, v143
    v_cvt_pk_bf16_f32 v140, v144, v145
    v_cvt_pk_bf16_f32 v141, v146, v147
    v_cvt_pk_bf16_f32 v142, v148, v149
    v_cvt_pk_bf16_f32 v143, v150, v151
    v_mfma_f32_32x32x16_bf16 v[72:87], v[192:195], v[136:139], v[72:87]
    s_nop 0
    v_mfma_f32_32x32x16_bf16 v[72:87], v[196:199], v[140:143], v[72:87]
    s_cmp_lg_u32 s31, 0
    s_nop 7
    s_nop 2
    s_cbranch_scc1 sf_105
    v_mov_b32 v160, 0x2b800000
    v_mov_b32 v161, 0x53800000
    v_med3_f32 v160, v80, v160, v161
    v_cmp_neq_f32 vcc, v160, v80
    s_nop 4
    s_cbranch_vccnz recurrent_scan__sliding_block__moe_arch_mod__prompt_kernel_max1
sf_105:
    v_mov_b32 v160, 0x2b800000
    v_mov_b32 v161, 0x53800000
    v_med3_f32 v160, v80, v160, v161
    v_cmp_neq_f32 vcc, v160, v80
    v_rcp_f32 v160, v80
    s_nop 0
    v_mul_f32 v72, v72, v160
    v_mul_f32 v73, v73, v160
    v_mul_f32 v74, v74, v160
    v_mul_f32 v75, v75, v160
    v_mul_f32 v76, v76, v160
    v_mul_f32 v77, v77, v160
    v_mul_f32 v78, v78, v160
    v_mul_f32 v79, v79, v160
    v_cvt_pk_bf16_f32 v164, v72, v73
    v_cvt_pk_bf16_f32 v165, v74, v75
    v_cvt_pk_bf16_f32 v166, v76, v77
    v_cvt_pk_bf16_f32 v167, v78, v79
    buffer_store_dwordx4 v[164:167], v168, s[40:43], s38 offen sc1
    s_nop 1
    s_branch recurrent_scan__sliding_block__moe_arch_mod__prompt_kernel_attn_done
recurrent_scan__sliding_block__moe_arch_mod__prompt_kernel_max0:
    v_mov_b32 v56, 0
    v_mov_b32 v57, 0
    v_mov_b32 v58, 0
    v_mov_b32 v59, 0
    v_mov_b32 v60, 0
    v_mov_b32 v61, 0
    v_mov_b32 v62, 0
    v_mov_b32 v63, 0
    v_mov_b32 v64, 0
    v_mov_b32 v65, 0
    v_mov_b32 v66, 0
    v_mov_b32 v67, 0
    v_mov_b32 v68, 0
    v_mov_b32 v69, 0
    v_mov_b32 v70, 0
    v_mov_b32 v71, 0
    s_nop 1
    v_mfma_f32_32x32x16_bf16 v[104:119], v[48:51], v[8:11], v[56:71]
    s_cmp_lt_u32 s27, 4
    s_nop 7
    s_nop 2
    s_cbranch_scc1 fi_107
    v_mfma_f32_32x32x16_bf16 v[120:135], v[16:19], v[8:11], v[56:71]
    s_nop 7
    s_nop 3
    s_branch fd_108
fi_107:
    v_mov_b32 v120, 0xf149f2ca
    v_mov_b32 v121, 0xf149f2ca
    v_mov_b32 v122, 0xf149f2ca
    v_mov_b32 v123, 0xf149f2ca
    v_mov_b32 v124, 0xf149f2ca
    v_mov_b32 v125, 0xf149f2ca
    v_mov_b32 v126, 0xf149f2ca
    v_mov_b32 v127, 0xf149f2ca
    v_mov_b32 v128, 0xf149f2ca
    v_mov_b32 v129, 0xf149f2ca
    v_mov_b32 v130, 0xf149f2ca
    v_mov_b32 v131, 0xf149f2ca
    v_mov_b32 v132, 0xf149f2ca
    v_mov_b32 v133, 0xf149f2ca
    v_mov_b32 v134, 0xf149f2ca
    v_mov_b32 v135, 0xf149f2ca
    s_nop 1
fd_108:
    v_cndmask_b32_e64 v104, v120, v104, s[44:45]
    v_cndmask_b32_e64 v105, v121, v105, s[46:47]
    v_cndmask_b32_e64 v106, v122, v106, s[48:49]
    v_cndmask_b32_e64 v107, v123, v107, s[50:51]
    v_cndmask_b32_e64 v108, v124, v108, s[52:53]
    v_cndmask_b32_e64 v109, v125, v109, s[54:55]
    v_cndmask_b32_e64 v110, v126, v110, s[56:57]
    v_cndmask_b32_e64 v111, v127, v111, s[58:59]
    v_cndmask_b32_e64 v112, v128, v112, s[60:61]
    v_cndmask_b32_e64 v113, v129, v113, s[62:63]
    v_cndmask_b32_e64 v114, v130, v114, s[64:65]
    v_cndmask_b32_e64 v115, v131, v115, s[66:67]
    v_cndmask_b32_e64 v116, v132, v116, s[68:69]
    v_cndmask_b32_e64 v117, v133, v117, s[70:71]
    v_cndmask_b32_e64 v118, v134, v118, s[72:73]
    v_cndmask_b32_e64 v119, v135, v119, s[74:75]
    v_mov_b32 v160, 0xf149f2ca
    v_max3_f32 v160, v104, v105, v160
    v_max3_f32 v160, v106, v107, v160
    v_max3_f32 v160, v108, v109, v160
    v_max3_f32 v160, v110, v111, v160
    v_max3_f32 v160, v112, v113, v160
    v_max3_f32 v160, v114, v115, v160
    v_max3_f32 v160, v116, v117, v160
    v_max3_f32 v160, v118, v119, v160
    s_cmp_lg_u32 s27, 0
    s_nop 0
    s_cbranch_scc1 sw_109
    v_mov_b32 v56, 0xf149f2ca
    v_mov_b32 v57, 0xf149f2ca
    v_mov_b32 v58, 0xf149f2ca
    v_mov_b32 v59, 0xf149f2ca
    v_mov_b32 v60, 0xf149f2ca
    v_mov_b32 v61, 0xf149f2ca
    v_mov_b32 v62, 0xf149f2ca
    v_mov_b32 v63, 0xf149f2ca
    v_mov_b32 v64, 0xf149f2ca
    v_mov_b32 v65, 0xf149f2ca
    v_mov_b32 v66, 0xf149f2ca
    v_mov_b32 v67, 0xf149f2ca
    v_mov_b32 v68, 0xf149f2ca
    v_mov_b32 v69, 0xf149f2ca
    v_mov_b32 v70, 0xf149f2ca
    v_mov_b32 v71, 0xf149f2ca
    s_nop 1
sw_109:
    v_mfma_f32_32x32x16_bf16 v[104:119], v[44:47], v[8:11], v[56:71]
    s_nop 7
    s_nop 3
    v_max3_f32 v160, v104, v105, v160
    v_max3_f32 v160, v106, v107, v160
    v_max3_f32 v160, v108, v109, v160
    v_max3_f32 v160, v110, v111, v160
    v_max3_f32 v160, v112, v113, v160
    v_max3_f32 v160, v114, v115, v160
    v_max3_f32 v160, v116, v117, v160
    v_max3_f32 v160, v118, v119, v160
    v_mfma_f32_32x32x16_bf16 v[104:119], v[40:43], v[8:11], v[56:71]
    s_nop 7
    s_nop 3
    v_max3_f32 v160, v104, v105, v160
    v_max3_f32 v160, v106, v107, v160
    v_max3_f32 v160, v108, v109, v160
    v_max3_f32 v160, v110, v111, v160
    v_max3_f32 v160, v112, v113, v160
    v_max3_f32 v160, v114, v115, v160
    v_max3_f32 v160, v116, v117, v160
    v_max3_f32 v160, v118, v119, v160
    s_cmp_lg_u32 s27, 1
    s_nop 0
    s_cbranch_scc1 sw_110
    v_mov_b32 v56, 0xf149f2ca
    v_mov_b32 v57, 0xf149f2ca
    v_mov_b32 v58, 0xf149f2ca
    v_mov_b32 v59, 0xf149f2ca
    v_mov_b32 v60, 0xf149f2ca
    v_mov_b32 v61, 0xf149f2ca
    v_mov_b32 v62, 0xf149f2ca
    v_mov_b32 v63, 0xf149f2ca
    v_mov_b32 v64, 0xf149f2ca
    v_mov_b32 v65, 0xf149f2ca
    v_mov_b32 v66, 0xf149f2ca
    v_mov_b32 v67, 0xf149f2ca
    v_mov_b32 v68, 0xf149f2ca
    v_mov_b32 v69, 0xf149f2ca
    v_mov_b32 v70, 0xf149f2ca
    v_mov_b32 v71, 0xf149f2ca
    s_nop 1
sw_110:
    v_mfma_f32_32x32x16_bf16 v[104:119], v[36:39], v[8:11], v[56:71]
    s_nop 7
    s_nop 3
    v_max3_f32 v160, v104, v105, v160
    v_max3_f32 v160, v106, v107, v160
    v_max3_f32 v160, v108, v109, v160
    v_max3_f32 v160, v110, v111, v160
    v_max3_f32 v160, v112, v113, v160
    v_max3_f32 v160, v114, v115, v160
    v_max3_f32 v160, v116, v117, v160
    v_max3_f32 v160, v118, v119, v160
    v_mfma_f32_32x32x16_bf16 v[104:119], v[32:35], v[8:11], v[56:71]
    s_nop 7
    s_nop 3
    v_max3_f32 v160, v104, v105, v160
    v_max3_f32 v160, v106, v107, v160
    v_max3_f32 v160, v108, v109, v160
    v_max3_f32 v160, v110, v111, v160
    v_max3_f32 v160, v112, v113, v160
    v_max3_f32 v160, v114, v115, v160
    v_max3_f32 v160, v116, v117, v160
    v_max3_f32 v160, v118, v119, v160
    s_cmp_lg_u32 s27, 2
    s_nop 0
    s_cbranch_scc1 sw_111
    v_mov_b32 v56, 0xf149f2ca
    v_mov_b32 v57, 0xf149f2ca
    v_mov_b32 v58, 0xf149f2ca
    v_mov_b32 v59, 0xf149f2ca
    v_mov_b32 v60, 0xf149f2ca
    v_mov_b32 v61, 0xf149f2ca
    v_mov_b32 v62, 0xf149f2ca
    v_mov_b32 v63, 0xf149f2ca
    v_mov_b32 v64, 0xf149f2ca
    v_mov_b32 v65, 0xf149f2ca
    v_mov_b32 v66, 0xf149f2ca
    v_mov_b32 v67, 0xf149f2ca
    v_mov_b32 v68, 0xf149f2ca
    v_mov_b32 v69, 0xf149f2ca
    v_mov_b32 v70, 0xf149f2ca
    v_mov_b32 v71, 0xf149f2ca
    s_nop 1
sw_111:
    v_mfma_f32_32x32x16_bf16 v[104:119], v[28:31], v[8:11], v[56:71]
    s_nop 7
    s_nop 3
    v_max3_f32 v160, v104, v105, v160
    v_max3_f32 v160, v106, v107, v160
    v_max3_f32 v160, v108, v109, v160
    v_max3_f32 v160, v110, v111, v160
    v_max3_f32 v160, v112, v113, v160
    v_max3_f32 v160, v114, v115, v160
    v_max3_f32 v160, v116, v117, v160
    v_max3_f32 v160, v118, v119, v160
    v_mfma_f32_32x32x16_bf16 v[104:119], v[24:27], v[8:11], v[56:71]
    s_nop 7
    s_nop 3
    v_max3_f32 v160, v104, v105, v160
    v_max3_f32 v160, v106, v107, v160
    v_max3_f32 v160, v108, v109, v160
    v_max3_f32 v160, v110, v111, v160
    v_max3_f32 v160, v112, v113, v160
    v_max3_f32 v160, v114, v115, v160
    v_max3_f32 v160, v116, v117, v160
    v_max3_f32 v160, v118, v119, v160
    s_cmp_lg_u32 s27, 3
    s_nop 0
    s_cbranch_scc1 sw_112
    v_mov_b32 v56, 0xf149f2ca
    v_mov_b32 v57, 0xf149f2ca
    v_mov_b32 v58, 0xf149f2ca
    v_mov_b32 v59, 0xf149f2ca
    v_mov_b32 v60, 0xf149f2ca
    v_mov_b32 v61, 0xf149f2ca
    v_mov_b32 v62, 0xf149f2ca
    v_mov_b32 v63, 0xf149f2ca
    v_mov_b32 v64, 0xf149f2ca
    v_mov_b32 v65, 0xf149f2ca
    v_mov_b32 v66, 0xf149f2ca
    v_mov_b32 v67, 0xf149f2ca
    v_mov_b32 v68, 0xf149f2ca
    v_mov_b32 v69, 0xf149f2ca
    v_mov_b32 v70, 0xf149f2ca
    v_mov_b32 v71, 0xf149f2ca
    s_nop 1
sw_112:
    v_mfma_f32_32x32x16_bf16 v[104:119], v[20:23], v[8:11], v[56:71]
    s_nop 7
    s_nop 3
    v_max3_f32 v160, v104, v105, v160
    v_max3_f32 v160, v106, v107, v160
    v_max3_f32 v160, v108, v109, v160
    v_max3_f32 v160, v110, v111, v160
    v_max3_f32 v160, v112, v113, v160
    v_max3_f32 v160, v114, v115, v160
    v_max3_f32 v160, v116, v117, v160
    v_max3_f32 v160, v118, v119, v160
    v_mov_b32 v161, v160
    s_nop 1
    v_permlane32_swap_b32 v160, v161
    v_max_f32 v160, v160, v161
    v_xor_b32 v171, 0x80000000, v160
    s_mov_b32 s31, 1
    s_nop 0
    s_branch recurrent_scan__sliding_block__moe_arch_mod__prompt_kernel_slow0
recurrent_scan__sliding_block__moe_arch_mod__prompt_kernel_max1:
    v_mov_b32 v56, 0
    v_mov_b32 v57, 0
    v_mov_b32 v58, 0
    v_mov_b32 v59, 0
    v_mov_b32 v60, 0
    v_mov_b32 v61, 0
    v_mov_b32 v62, 0
    v_mov_b32 v63, 0
    v_mov_b32 v64, 0
    v_mov_b32 v65, 0
    v_mov_b32 v66, 0
    v_mov_b32 v67, 0
    v_mov_b32 v68, 0
    v_mov_b32 v69, 0
    v_mov_b32 v70, 0
    v_mov_b32 v71, 0
    s_nop 1
    v_mfma_f32_32x32x16_bf16 v[104:119], v[52:55], v[12:15], v[56:71]
    s_cmp_lt_u32 s27, 4
    s_nop 7
    s_nop 2
    s_cbranch_scc1 fi_113
    v_mfma_f32_32x32x16_bf16 v[120:135], v[20:23], v[12:15], v[56:71]
    s_nop 7
    s_nop 3
    s_branch fd_114
fi_113:
    v_mov_b32 v120, 0xf149f2ca
    v_mov_b32 v121, 0xf149f2ca
    v_mov_b32 v122, 0xf149f2ca
    v_mov_b32 v123, 0xf149f2ca
    v_mov_b32 v124, 0xf149f2ca
    v_mov_b32 v125, 0xf149f2ca
    v_mov_b32 v126, 0xf149f2ca
    v_mov_b32 v127, 0xf149f2ca
    v_mov_b32 v128, 0xf149f2ca
    v_mov_b32 v129, 0xf149f2ca
    v_mov_b32 v130, 0xf149f2ca
    v_mov_b32 v131, 0xf149f2ca
    v_mov_b32 v132, 0xf149f2ca
    v_mov_b32 v133, 0xf149f2ca
    v_mov_b32 v134, 0xf149f2ca
    v_mov_b32 v135, 0xf149f2ca
    s_nop 1
fd_114:
    v_cndmask_b32_e64 v104, v120, v104, s[44:45]
    v_cndmask_b32_e64 v105, v121, v105, s[46:47]
    v_cndmask_b32_e64 v106, v122, v106, s[48:49]
    v_cndmask_b32_e64 v107, v123, v107, s[50:51]
    v_cndmask_b32_e64 v108, v124, v108, s[52:53]
    v_cndmask_b32_e64 v109, v125, v109, s[54:55]
    v_cndmask_b32_e64 v110, v126, v110, s[56:57]
    v_cndmask_b32_e64 v111, v127, v111, s[58:59]
    v_cndmask_b32_e64 v112, v128, v112, s[60:61]
    v_cndmask_b32_e64 v113, v129, v113, s[62:63]
    v_cndmask_b32_e64 v114, v130, v114, s[64:65]
    v_cndmask_b32_e64 v115, v131, v115, s[66:67]
    v_cndmask_b32_e64 v116, v132, v116, s[68:69]
    v_cndmask_b32_e64 v117, v133, v117, s[70:71]
    v_cndmask_b32_e64 v118, v134, v118, s[72:73]
    v_cndmask_b32_e64 v119, v135, v119, s[74:75]
    v_mov_b32 v160, 0xf149f2ca
    v_max3_f32 v160, v104, v105, v160
    v_max3_f32 v160, v106, v107, v160
    v_max3_f32 v160, v108, v109, v160
    v_max3_f32 v160, v110, v111, v160
    v_max3_f32 v160, v112, v113, v160
    v_max3_f32 v160, v114, v115, v160
    v_max3_f32 v160, v116, v117, v160
    v_max3_f32 v160, v118, v119, v160
    v_mfma_f32_32x32x16_bf16 v[104:119], v[48:51], v[12:15], v[56:71]
    s_nop 7
    s_nop 3
    v_max3_f32 v160, v104, v105, v160
    v_max3_f32 v160, v106, v107, v160
    v_max3_f32 v160, v108, v109, v160
    v_max3_f32 v160, v110, v111, v160
    v_max3_f32 v160, v112, v113, v160
    v_max3_f32 v160, v114, v115, v160
    v_max3_f32 v160, v116, v117, v160
    v_max3_f32 v160, v118, v119, v160
    s_cmp_lg_u32 s27, 0
    s_nop 0
    s_cbranch_scc1 sw_115
    v_mov_b32 v56, 0xf149f2ca
    v_mov_b32 v57, 0xf149f2ca
    v_mov_b32 v58, 0xf149f2ca
    v_mov_b32 v59, 0xf149f2ca
    v_mov_b32 v60, 0xf149f2ca
    v_mov_b32 v61, 0xf149f2ca
    v_mov_b32 v62, 0xf149f2ca
    v_mov_b32 v63, 0xf149f2ca
    v_mov_b32 v64, 0xf149f2ca
    v_mov_b32 v65, 0xf149f2ca
    v_mov_b32 v66, 0xf149f2ca
    v_mov_b32 v67, 0xf149f2ca
    v_mov_b32 v68, 0xf149f2ca
    v_mov_b32 v69, 0xf149f2ca
    v_mov_b32 v70, 0xf149f2ca
    v_mov_b32 v71, 0xf149f2ca
    s_nop 1
sw_115:
    v_mfma_f32_32x32x16_bf16 v[104:119], v[44:47], v[12:15], v[56:71]
    s_nop 7
    s_nop 3
    v_max3_f32 v160, v104, v105, v160
    v_max3_f32 v160, v106, v107, v160
    v_max3_f32 v160, v108, v109, v160
    v_max3_f32 v160, v110, v111, v160
    v_max3_f32 v160, v112, v113, v160
    v_max3_f32 v160, v114, v115, v160
    v_max3_f32 v160, v116, v117, v160
    v_max3_f32 v160, v118, v119, v160
    v_mfma_f32_32x32x16_bf16 v[104:119], v[40:43], v[12:15], v[56:71]
    s_nop 7
    s_nop 3
    v_max3_f32 v160, v104, v105, v160
    v_max3_f32 v160, v106, v107, v160
    v_max3_f32 v160, v108, v109, v160
    v_max3_f32 v160, v110, v111, v160
    v_max3_f32 v160, v112, v113, v160
    v_max3_f32 v160, v114, v115, v160
    v_max3_f32 v160, v116, v117, v160
    v_max3_f32 v160, v118, v119, v160
    s_cmp_lg_u32 s27, 1
    s_nop 0
    s_cbranch_scc1 sw_116
    v_mov_b32 v56, 0xf149f2ca
    v_mov_b32 v57, 0xf149f2ca
    v_mov_b32 v58, 0xf149f2ca
    v_mov_b32 v59, 0xf149f2ca
    v_mov_b32 v60, 0xf149f2ca
    v_mov_b32 v61, 0xf149f2ca
    v_mov_b32 v62, 0xf149f2ca
    v_mov_b32 v63, 0xf149f2ca
    v_mov_b32 v64, 0xf149f2ca
    v_mov_b32 v65, 0xf149f2ca
    v_mov_b32 v66, 0xf149f2ca
    v_mov_b32 v67, 0xf149f2ca
    v_mov_b32 v68, 0xf149f2ca
    v_mov_b32 v69, 0xf149f2ca
    v_mov_b32 v70, 0xf149f2ca
    v_mov_b32 v71, 0xf149f2ca
    s_nop 1
sw_116:
    v_mfma_f32_32x32x16_bf16 v[104:119], v[36:39], v[12:15], v[56:71]
    s_nop 7
    s_nop 3
    v_max3_f32 v160, v104, v105, v160
    v_max3_f32 v160, v106, v107, v160
    v_max3_f32 v160, v108, v109, v160
    v_max3_f32 v160, v110, v111, v160
    v_max3_f32 v160, v112, v113, v160
    v_max3_f32 v160, v114, v115, v160
    v_max3_f32 v160, v116, v117, v160
    v_max3_f32 v160, v118, v119, v160
    v_mfma_f32_32x32x16_bf16 v[104:119], v[32:35], v[12:15], v[56:71]
    s_nop 7
    s_nop 3
    v_max3_f32 v160, v104, v105, v160
    v_max3_f32 v160, v106, v107, v160
    v_max3_f32 v160, v108, v109, v160
    v_max3_f32 v160, v110, v111, v160
    v_max3_f32 v160, v112, v113, v160
    v_max3_f32 v160, v114, v115, v160
    v_max3_f32 v160, v116, v117, v160
    v_max3_f32 v160, v118, v119, v160
    s_cmp_lg_u32 s27, 2
    s_nop 0
    s_cbranch_scc1 sw_117
    v_mov_b32 v56, 0xf149f2ca
    v_mov_b32 v57, 0xf149f2ca
    v_mov_b32 v58, 0xf149f2ca
    v_mov_b32 v59, 0xf149f2ca
    v_mov_b32 v60, 0xf149f2ca
    v_mov_b32 v61, 0xf149f2ca
    v_mov_b32 v62, 0xf149f2ca
    v_mov_b32 v63, 0xf149f2ca
    v_mov_b32 v64, 0xf149f2ca
    v_mov_b32 v65, 0xf149f2ca
    v_mov_b32 v66, 0xf149f2ca
    v_mov_b32 v67, 0xf149f2ca
    v_mov_b32 v68, 0xf149f2ca
    v_mov_b32 v69, 0xf149f2ca
    v_mov_b32 v70, 0xf149f2ca
    v_mov_b32 v71, 0xf149f2ca
    s_nop 1
sw_117:
    v_mfma_f32_32x32x16_bf16 v[104:119], v[28:31], v[12:15], v[56:71]
    s_nop 7
    s_nop 3
    v_max3_f32 v160, v104, v105, v160
    v_max3_f32 v160, v106, v107, v160
    v_max3_f32 v160, v108, v109, v160
    v_max3_f32 v160, v110, v111, v160
    v_max3_f32 v160, v112, v113, v160
    v_max3_f32 v160, v114, v115, v160
    v_max3_f32 v160, v116, v117, v160
    v_max3_f32 v160, v118, v119, v160
    v_mfma_f32_32x32x16_bf16 v[104:119], v[24:27], v[12:15], v[56:71]
    s_nop 7
    s_nop 3
    v_max3_f32 v160, v104, v105, v160
    v_max3_f32 v160, v106, v107, v160
    v_max3_f32 v160, v108, v109, v160
    v_max3_f32 v160, v110, v111, v160
    v_max3_f32 v160, v112, v113, v160
    v_max3_f32 v160, v114, v115, v160
    v_max3_f32 v160, v116, v117, v160
    v_max3_f32 v160, v118, v119, v160
    v_mov_b32 v161, v160
    s_nop 1
    v_permlane32_swap_b32 v160, v161
    v_max_f32 v160, v160, v161
    v_xor_b32 v171, 0x80000000, v160
    s_mov_b32 s31, 1
    s_nop 0
    s_branch recurrent_scan__sliding_block__moe_arch_mod__prompt_kernel_slow1
text_end:
.section .rodata,"a"
.p2align 6
.amdhsa_kernel recurrent_scan__sliding_block__moe_arch_mod__prompt_kernel
  .amdhsa_next_free_vgpr 256
  .amdhsa_next_free_sgpr 102
  .amdhsa_accum_offset 256
  .amdhsa_group_segment_fixed_size 0
  .amdhsa_kernarg_size 88
  .amdhsa_user_sgpr_count 2
  .amdhsa_user_sgpr_kernarg_segment_ptr 1
  .amdhsa_system_sgpr_workgroup_id_x 1
.end_amdhsa_kernel
```
